```python
import torch

def _softmax(x, axis=-1):
    return torch.softmax(x, dim=axis)

def _gelu(x):
    return torch.nn.functional.gelu(x, approximate='tanh')

def _silu(x):
    return torch.nn.functional.silu(x)

def _sigmoid(x):
    return torch.sigmoid(x)

def _layernorm(x, axis=-1, eps=1e-05):
    m = x.mean(dim=axis, keepdim=True)
    v = x.var(dim=axis, keepdim=True, unbiased=False)
    return (x - m) / torch.sqrt(v + eps)

def _scatter_add(tgt, idx, src, axis=0):
    return tgt.clone().index_add_(axis, idx, src)

def _segment_sum(src, seg, n):
    out = torch.zeros((n,) + src.shape[1:], dtype=src.dtype)
    return out.index_add_(0, seg, src)

def _pad(x, pw):
    flat = tuple((v for pair in reversed(pw) for v in pair))
    return torch.nn.functional.pad(x, flat)
kernel_name = 'adaLN_cond__mha_block_cached__swiglu_ffn__decode'

def setup_inputs():

    _w = lambda a: (lambda t: t.to(torch.bfloat16) if t.is_floating_point() else t)(torch.as_tensor(a))

    def _A_setup():
        B, Sq, D = (8, 1, 512)
        H, Sk, Dh = (32, 4096, 128)
        return {'x': _w((lambda *s: torch.randn(*s, dtype=torch.bfloat16) * 0.1)(B, Sq, D)), 'k_cache': _w((lambda *s: torch.randn(*s, dtype=torch.bfloat16) * 0.8)(B, H, Sk, Dh)), 'v_cache': _w((lambda *s: torch.randn(*s, dtype=torch.bfloat16) * 1.6)(B, H, Sk, Dh)), 'wq': _w((lambda *s: torch.randn(*s, dtype=torch.bfloat16) * 0.8)(D, H * Dh) * D ** (-0.5)), 'wo': _w((lambda *s: torch.randn(*s, dtype=torch.bfloat16) * 1.6)(H * Dh, D) * (H * Dh) ** (-0.5))}
    _A_in = _A_setup()

    def _B_setup():
        B, S, D, F = (8, 1, 512, 1376)
        return {'x': _w((lambda *s: torch.randn(*s, dtype=torch.bfloat16) * 0.1)(B, S, D)), 'w_gate': _w((lambda *s: torch.randn(*s, dtype=torch.bfloat16) * 0.1)(D, F)), 'w_up': _w((lambda *s: torch.randn(*s, dtype=torch.bfloat16) * 0.1)(D, F)), 'w_down': _w((lambda *s: torch.randn(*s, dtype=torch.bfloat16) * 0.1)(F, D))}
    _B_in = _B_setup()
    return {'A_x': _A_in['x'], 'A_k_cache': _A_in['k_cache'], 'A_v_cache': _A_in['v_cache'], 'A_wq': _A_in['wq'], 'A_wo': _A_in['wo'], 'B_x': _B_in['x'], 'B_w_gate': _B_in['w_gate'], 'B_w_up': _B_in['w_up'], 'B_w_down': _B_in['w_down'], 'c': _w((lambda *s: torch.randn(*s, dtype=torch.bfloat16) * 0.8)(8, 512) * 8.0), 'w_mod': _w((lambda *s: torch.randn(*s, dtype=torch.bfloat16) * 0.8)(512, 6 * 512) * 512 ** (-0.5) * 8.0)}

def reference(A_x, A_k_cache, A_v_cache, A_wq, A_wo, B_x, B_w_gate, B_w_up, B_w_down, c, w_mod):

    def _A_ref(x, k_cache, v_cache, wq, wo):
        B, Sq, D = x.shape
        H, Dh = (32, 128)
        q = (lambda x, *d: x.permute(*d))((x @ wq).reshape(B, Sq, H, Dh), 0, 2, 1, 3)
        scores = torch.einsum('bhqd,bhkd->bhqk', q, k_cache) * Dh ** (-0.5)
        p = _softmax(scores, axis=-1)
        o = torch.einsum('bhqk,bhkd->bhqd', p, v_cache)
        return (lambda x, *d: x.permute(*d))(o, 0, 2, 1, 3).reshape(B, Sq, H * Dh) @ wo

    def _B_ref(x, w_gate, w_up, w_down):
        g = _silu(x @ w_gate)
        u = x @ w_up
        return g * u @ w_down
    x = A_x
    mod = (_silu(c) @ w_mod).reshape(c.shape[0], 6, 1, -1)
    sa, ca, ga, sb, cb, gb = (mod[:, 0].clone(), mod[:, 1].clone(), mod[:, 2].clone(), mod[:, 3].clone(), mod[:, 4].clone(), mod[:, 5].clone())
    h = _layernorm(x, axis=-1) * (1 + ca) + sa
    x = x + ga * _A_ref(h, A_k_cache, A_v_cache, A_wq, A_wo)
    h = _layernorm(x, axis=-1) * (1 + cb) + sb
    x = x + gb * _B_ref(h, B_w_gate, B_w_up, B_w_down)
    return x
```

```asm
; @launch grid=(256,1,1) block=(512,1,1) lds=131072
.amdgcn_target "amdgcn-amd-amdhsa--gfx950"
.text
.globl adaLN_cond__mha_block_cached__swiglu_ffn__decode_kernel
.p2align 8
.type adaLN_cond__mha_block_cached__swiglu_ffn__decode_kernel,@function
adaLN_cond__mha_block_cached__swiglu_ffn__decode_kernel:
  s_cmp_ge_u32 s2, 256
  s_cbranch_scc1 L_end
  s_load_dwordx16 s[4:19], s[0:1], 0
  s_load_dwordx8 s[20:27], s[0:1], 64
  s_load_dwordx4 s[28:31], s[0:1], 96
  s_mov_b64 s[100:101], -1
  v_lshrrev_b32 v1, 6, v0
  s_and_b32 s33, s2, 7
  v_readfirstlane_b32 s3, v1
  s_lshl_b32 s33, s33, 2
  s_lshr_b32 s32, s2, 3
  s_and_b32 s32, s32, 3
  s_add_u32 s33, s33, s32
  s_lshr_b32 s34, s2, 5
  s_lshl_b32 s35, s34, 5
  s_add_u32 s35, s35, s33
  v_and_b32 v1, 63, v0
  v_lshrrev_b32 v2, 4, v1
  v_and_b32 v3, 15, v1
  s_and_b32 s36, s3, 3
  s_cmp_ge_u32 s3, 4
  s_cbranch_scc1 L_helper
  v_bfe_u32 v10, v3, 2, 1
  v_and_b32 v11, 3, v3
  v_lshlrev_b32 v4, 10, v10
  v_bfe_u32 v10, v3, 3, 1
  v_lshl_or_b32 v4, v10, 15, v4
  v_lshl_add_u32 v4, v2, 6, v4
  v_lshl_add_u32 v4, v11, 4, v4
  s_and_b32 s37, s3, 1
  s_lshl_b32 s37, s37, 8
  s_lshr_b32 s42, s3, 1
  s_lshl_b32 s42, s42, 9
  s_or_b32 s42, s42, s37
  v_add_u32 v4, s42, v4
  v_lshlrev_b32 v5, 4, v3
  s_lshl_b32 s38, s35, 20
  s_lshr_b32 s39, s35, 12
  s_mov_b32 s46, 0x100000
  s_mov_b32 s47, 0x20000
  s_mov_b32 s50, 0x100000
  s_mov_b32 s51, 0x20000
  s_mov_b32 s52, 0
  s_lshr_b32 s53, s52, 12
  s_waitcnt lgkmcnt(0)
  s_add_u32 s44, s6, s38
  s_addc_u32 s45, s7, s39
  buffer_load_dwordx4 v[112:115], v4, s[44:47], s52 offen nt
  s_xor_b32 s52, s52, 0x800
  buffer_load_dwordx4 v[116:119], v4, s[44:47], s52 offen nt
  s_xor_b32 s52, s52, 0x1800
  buffer_load_dwordx4 v[120:123], v4, s[44:47], s52 offen nt
  s_xor_b32 s52, s52, 0x800
  buffer_load_dwordx4 v[124:127], v4, s[44:47], s52 offen nt
  s_xor_b32 s52, s52, 0x3800
  buffer_load_dwordx4 v[128:131], v4, s[44:47], s52 offen nt
  s_xor_b32 s52, s52, 0x800
  s_add_u32 s48, s8, s38
  s_addc_u32 s49, s9, s39
  v_lshlrev_b32 v6, 6, v3
  v_lshl_add_u32 v6, v2, 2, v6
  s_lshl_b32 s37, s3, 4
  v_add_u32 v6, s37, v6
  s_lshr_b32 s42, s42, 6
  v_mov_b32 v244, s42
  v_bfe_u32 v10, v2, 0, 1
  v_lshl_or_b32 v244, v10, 4, v244
  v_bfe_u32 v10, v2, 1, 1
  v_lshl_or_b32 v244, v10, 9, v244
  v_bfe_u32 v10, v3, 0, 1
  v_lshl_or_b32 v244, v10, 5, v244
  v_bfe_u32 v10, v3, 1, 1
  v_lshl_or_b32 v244, v10, 6, v244
  v_bfe_u32 v10, v3, 2, 1
  v_lshl_or_b32 v244, v10, 7, v244
  v_bfe_u32 v10, v3, 3, 1
  v_lshl_or_b32 v244, v10, 8, v244
  v_mov_b32 v7, 0xff800000
  v_mov_b32 v8, 0
  s_mov_b32 s70, 0x3fb8aa3b
  v_mov_b32 v10, 0xffff
  v_mov_b32 v11, 0xffff0000
  v_cmp_eq_u32 vcc, 0, v3
  v_cmp_eq_u32 s[40:41], 1, v3
  s_nop 1
  v_cndmask_b32 v240, 0, v10, vcc
  v_cndmask_b32 v240, v240, v11, s[40:41]
  v_cmp_eq_u32 vcc, 2, v3
  v_cmp_eq_u32 s[40:41], 3, v3
  s_nop 1
  v_cndmask_b32 v241, 0, v10, vcc
  v_cndmask_b32 v241, v241, v11, s[40:41]
  v_cmp_eq_u32 vcc, 4, v3
  v_cmp_eq_u32 s[40:41], 5, v3
  s_nop 1
  v_cndmask_b32 v242, 0, v10, vcc
  v_cndmask_b32 v242, v242, v11, s[40:41]
  v_cmp_eq_u32 vcc, 6, v3
  v_cmp_eq_u32 s[40:41], 7, v3
  s_nop 1
  v_cndmask_b32 v243, 0, v10, vcc
  v_cndmask_b32 v243, v243, v11, s[40:41]
  v_and_b32 v11, 3, v3
  v_cmp_eq_u32 s[54:55], 0, v11
  v_cmp_eq_u32 s[56:57], 1, v11
  v_cmp_eq_u32 s[58:59], 2, v11
  v_cmp_eq_u32 s[60:61], 3, v11
  v_lshrrev_b32 v10, 2, v3
  v_lshl_add_u32 v10, v2, 2, v10
  v_lshlrev_b32 v10, 4, v10
  s_barrier
  s_waitcnt vmcnt(4)
  buffer_load_dwordx4 v[132:135], v4, s[44:47], s52 offen nt
  s_xor_b32 s52, s52, 0x1800
  s_waitcnt vmcnt(4)
  buffer_load_dwordx4 v[136:139], v4, s[44:47], s52 offen nt
  s_xor_b32 s52, s52, 0x800
  s_waitcnt vmcnt(4)
  buffer_load_dwordx4 v[140:143], v4, s[44:47], s52 offen nt
  s_xor_b32 s52, s52, 0x7800
  s_waitcnt vmcnt(4)
  buffer_load_dwordx4 v[144:147], v4, s[44:47], s52 offen nt
  s_xor_b32 s52, s52, 0x800
  s_waitcnt vmcnt(4)
  buffer_load_dwordx4 v[148:151], v4, s[44:47], s52 offen nt
  s_xor_b32 s52, s52, 0x1800
  s_waitcnt vmcnt(4)
  buffer_load_dwordx4 v[152:155], v4, s[44:47], s52 offen nt
  s_xor_b32 s52, s52, 0x800
  s_waitcnt vmcnt(4)
  buffer_load_dwordx4 v[156:159], v4, s[44:47], s52 offen nt
  s_xor_b32 s52, s52, 0x3800
  s_waitcnt vmcnt(4)
  buffer_load_dwordx4 v[160:163], v4, s[44:47], s52 offen nt
  s_xor_b32 s52, s52, 0x800
  s_waitcnt vmcnt(4)
  buffer_load_dwordx4 v[164:167], v4, s[44:47], s52 offen nt
  s_xor_b32 s52, s52, 0x1800
  s_waitcnt vmcnt(4)
  buffer_load_dwordx4 v[168:171], v4, s[44:47], s52 offen nt
  s_xor_b32 s52, s52, 0x800
  s_waitcnt vmcnt(4)
  buffer_load_dwordx4 v[172:175], v4, s[44:47], s52 offen nt
  s_xor_b32 s52, s52, 0x47800
  s_waitcnt vmcnt(4)
  buffer_load_dwordx4 v[176:179], v4, s[44:47], s52 offen nt
  s_xor_b32 s52, s52, 0x800
  s_waitcnt vmcnt(4)
  buffer_load_dwordx4 v[180:183], v4, s[44:47], s52 offen nt
  s_xor_b32 s52, s52, 0x1800
  s_waitcnt vmcnt(4)
  buffer_load_dwordx4 v[184:187], v4, s[44:47], s52 offen nt
  s_xor_b32 s52, s52, 0x800
  s_waitcnt vmcnt(4)
  buffer_load_dwordx4 v[188:191], v4, s[44:47], s52 offen nt
  s_xor_b32 s52, s52, 0x3800
  s_waitcnt vmcnt(4)
  buffer_load_dwordx4 v[192:195], v4, s[44:47], s52 offen nt
  s_xor_b32 s52, s52, 0x800
  s_waitcnt vmcnt(4)
  buffer_load_dwordx4 v[196:199], v4, s[44:47], s52 offen nt
  s_xor_b32 s52, s52, 0x1800
  s_waitcnt vmcnt(4)
  buffer_load_dwordx4 v[200:203], v4, s[44:47], s52 offen nt
  s_xor_b32 s52, s52, 0x800
  s_waitcnt vmcnt(4)
  buffer_load_dwordx4 v[204:207], v4, s[44:47], s52 offen nt
  s_xor_b32 s52, s52, 0x7800
  s_waitcnt vmcnt(4)
  buffer_load_dwordx4 v[208:211], v4, s[44:47], s52 offen nt
  s_xor_b32 s52, s52, 0x800
  s_waitcnt vmcnt(4)
  buffer_load_dwordx4 v[212:215], v4, s[44:47], s52 offen nt
  s_xor_b32 s52, s52, 0x1800
  s_waitcnt vmcnt(4)
  buffer_load_dwordx4 v[216:219], v4, s[44:47], s52 offen nt
  s_xor_b32 s52, s52, 0x800
  s_waitcnt vmcnt(4)
  buffer_load_dwordx4 v[220:223], v4, s[44:47], s52 offen nt
  s_xor_b32 s52, s52, 0x3800
  s_waitcnt vmcnt(4)
  buffer_load_dwordx4 v[224:227], v4, s[44:47], s52 offen nt
  s_xor_b32 s52, s52, 0x800
  s_waitcnt vmcnt(4)
  buffer_load_dwordx4 v[228:231], v4, s[44:47], s52 offen nt
  s_xor_b32 s52, s52, 0x1800
  s_waitcnt vmcnt(4)
  buffer_load_dwordx4 v[232:235], v4, s[44:47], s52 offen nt
  s_xor_b32 s52, s52, 0x800
  s_waitcnt vmcnt(4)
  buffer_load_dwordx4 v[236:239], v4, s[44:47], s52 offen nt
  s_xor_b32 s52, s52, 0x57800
  s_waitcnt vmcnt(4)
  buffer_load_dwordx4 v[48:51], v4, s[44:47], s52 offen nt
  s_xor_b32 s52, s52, 0x800
  s_waitcnt vmcnt(4)
  buffer_load_dwordx4 v[52:55], v4, s[44:47], s52 offen nt
  s_xor_b32 s52, s52, 0x1800
  s_waitcnt vmcnt(4)
  buffer_load_dwordx4 v[56:59], v4, s[44:47], s52 offen nt
  s_xor_b32 s52, s52, 0x800
  s_waitcnt vmcnt(4)
  buffer_load_dwordx4 v[60:63], v4, s[44:47], s52 offen nt
  s_xor_b32 s52, s52, 0x3800
  s_waitcnt vmcnt(4)
  buffer_load_dwordx4 v[64:67], v4, s[44:47], s52 offen nt
  s_xor_b32 s52, s52, 0x800
  s_waitcnt vmcnt(4)
  buffer_load_dwordx4 v[68:71], v4, s[44:47], s52 offen nt
  s_xor_b32 s52, s52, 0x1800
  s_waitcnt vmcnt(4)
  buffer_load_dwordx4 v[72:75], v4, s[44:47], s52 offen nt
  s_xor_b32 s52, s52, 0x800
  s_waitcnt vmcnt(4)
  buffer_load_dwordx4 v[76:79], v4, s[44:47], s52 offen nt
  s_xor_b32 s52, s52, 0x7800
  s_waitcnt vmcnt(4)
  buffer_load_dwordx4 v[80:83], v4, s[44:47], s52 offen nt
  s_xor_b32 s52, s52, 0x800
  s_waitcnt vmcnt(4)
  buffer_load_dwordx4 v[84:87], v4, s[44:47], s52 offen nt
  s_xor_b32 s52, s52, 0x1800
  s_waitcnt vmcnt(4)
  buffer_load_dwordx4 v[88:91], v4, s[44:47], s52 offen nt
  s_xor_b32 s52, s52, 0x800
  s_waitcnt vmcnt(4)
  buffer_load_dwordx4 v[92:95], v4, s[44:47], s52 offen nt
  s_xor_b32 s52, s52, 0x3800
  s_waitcnt vmcnt(4)
  buffer_load_dwordx4 v[96:99], v4, s[44:47], s52 offen nt
  s_xor_b32 s52, s52, 0x800
  s_waitcnt vmcnt(4)
  buffer_load_dwordx4 v[100:103], v4, s[44:47], s52 offen nt
  s_xor_b32 s52, s52, 0x1800
  s_waitcnt vmcnt(4)
  buffer_load_dwordx4 v[104:107], v4, s[44:47], s52 offen nt
  s_xor_b32 s52, s52, 0x800
  s_waitcnt vmcnt(4)
  buffer_load_dwordx4 v[108:111], v4, s[44:47], s52 offen nt
  s_xor_b32 s52, s52, 0x47800
  s_barrier
  ds_read_b128 v[28:31], v10 offset:26624
  s_waitcnt lgkmcnt(0)
  v_cndmask_b32 v12, 0, v28, s[54:55]
  v_cndmask_b32 v13, 0, v29, s[54:55]
  v_cndmask_b32 v14, 0, v30, s[54:55]
  v_cndmask_b32 v15, 0, v31, s[54:55]
  v_cndmask_b32 v16, 0, v28, s[56:57]
  v_cndmask_b32 v17, 0, v29, s[56:57]
  v_cndmask_b32 v18, 0, v30, s[56:57]
  v_cndmask_b32 v19, 0, v31, s[56:57]
  v_cndmask_b32 v20, 0, v28, s[58:59]
  v_cndmask_b32 v21, 0, v29, s[58:59]
  v_cndmask_b32 v22, 0, v30, s[58:59]
  v_cndmask_b32 v23, 0, v31, s[58:59]
  v_cndmask_b32 v24, 0, v28, s[60:61]
  v_cndmask_b32 v25, 0, v29, s[60:61]
  v_cndmask_b32 v26, 0, v30, s[60:61]
  v_cndmask_b32 v27, 0, v31, s[60:61]
  s_mul_i32 s40, s53, 0x01010101
  s_xor_b32 s56, s40, 0x50104000
  s_xor_b32 s57, s40, 0x70306020
  s_xor_b32 s60, s40, 0xd090c080
  s_xor_b32 s61, s40, 0xf0b0e0a0
  s_lshl_b32 s53, s53, 6
  s_nop 0
  v_mfma_f32_16x16x32_bf16 v[28:31], v[112:115], v[12:15], 0
  s_waitcnt vmcnt(4)
  buffer_load_dwordx4 v[112:115], v4, s[44:47], s52 offen nt
  s_xor_b32 s52, s52, 0x800
  v_mfma_f32_16x16x32_bf16 v[28:31], v[116:119], v[16:19], v[28:31]
  s_nop 0
  v_mfma_f32_16x16x32_bf16 v[28:31], v[120:123], v[20:23], v[28:31]
  s_nop 0
  v_mfma_f32_16x16x32_bf16 v[28:31], v[124:127], v[24:27], v[28:31]
  s_waitcnt vmcnt(4)
  buffer_load_dwordx4 v[124:127], v4, s[44:47], s52 offen nt
  s_xor_b32 s52, s52, 0x1800
  v_mfma_f32_16x16x32_bf16 v[32:35], v[128:131], v[12:15], 0
  s_nop 0
  v_mfma_f32_16x16x32_bf16 v[32:35], v[132:135], v[16:19], v[32:35]
  s_waitcnt vmcnt(4)
  buffer_load_dwordx4 v[132:135], v4, s[44:47], s52 offen nt
  s_xor_b32 s52, s52, 0x800
  v_mfma_f32_16x16x32_bf16 v[32:35], v[136:139], v[20:23], v[32:35]
  s_nop 0
  v_mfma_f32_16x16x32_bf16 v[32:35], v[140:143], v[24:27], v[32:35]
  v_mov_b32_dpp v44, v28 quad_perm:[0,1,2,3] row_mask:0xf bank_mask:0x1
  v_mov_b32_dpp v45, v29 row_ror:12 row_mask:0xf bank_mask:0x1
  v_mov_b32_dpp v46, v30 row_ror:8 row_mask:0xf bank_mask:0x1
  v_mov_b32_dpp v47, v31 row_ror:4 row_mask:0xf bank_mask:0x1
  s_nop 0
  v_mfma_f32_16x16x32_bf16 v[36:39], v[144:147], v[12:15], 0
  s_waitcnt vmcnt(4)
  buffer_load_dwordx4 v[144:147], v4, s[44:47], s52 offen nt
  s_xor_b32 s52, s52, 0x3800
  v_mfma_f32_16x16x32_bf16 v[36:39], v[148:151], v[16:19], v[36:39]
  s_nop 0
  v_mfma_f32_16x16x32_bf16 v[36:39], v[152:155], v[20:23], v[36:39]
  s_nop 0
  v_mfma_f32_16x16x32_bf16 v[36:39], v[156:159], v[24:27], v[36:39]
  v_mov_b32_dpp v44, v32 row_ror:4 row_mask:0xf bank_mask:0x2
  v_mov_b32_dpp v45, v33 quad_perm:[0,1,2,3] row_mask:0xf bank_mask:0x2
  v_mov_b32_dpp v46, v34 row_ror:12 row_mask:0xf bank_mask:0x2
  v_mov_b32_dpp v47, v35 row_ror:8 row_mask:0xf bank_mask:0x2
  s_waitcnt vmcnt(4)
  buffer_load_dwordx4 v[156:159], v4, s[44:47], s52 offen nt
  s_xor_b32 s52, s52, 0x800
  v_mfma_f32_16x16x32_bf16 v[40:43], v[160:163], v[12:15], 0
  s_nop 0
  v_mfma_f32_16x16x32_bf16 v[40:43], v[164:167], v[16:19], v[40:43]
  s_waitcnt vmcnt(4)
  buffer_load_dwordx4 v[164:167], v4, s[44:47], s52 offen nt
  s_xor_b32 s52, s52, 0x1800
  v_mfma_f32_16x16x32_bf16 v[40:43], v[168:171], v[20:23], v[40:43]
  s_nop 0
  v_mfma_f32_16x16x32_bf16 v[40:43], v[172:175], v[24:27], v[40:43]
  v_mov_b32_dpp v44, v36 row_ror:8 row_mask:0xf bank_mask:0x4
  v_mov_b32_dpp v45, v37 row_ror:4 row_mask:0xf bank_mask:0x4
  v_mov_b32_dpp v46, v38 quad_perm:[0,1,2,3] row_mask:0xf bank_mask:0x4
  v_mov_b32_dpp v47, v39 row_ror:12 row_mask:0xf bank_mask:0x4
  s_xor_b32 s54, s53, 0x0
  s_nop 0
  v_mfma_f32_16x16x32_bf16 v[28:31], v[176:179], v[12:15], 0
  s_waitcnt vmcnt(4)
  buffer_load_dwordx4 v[176:179], v4, s[44:47], s52 offen nt
  s_xor_b32 s52, s52, 0x800
  v_mfma_f32_16x16x32_bf16 v[28:31], v[180:183], v[16:19], v[28:31]
  s_nop 0
  v_mfma_f32_16x16x32_bf16 v[28:31], v[184:187], v[20:23], v[28:31]
  s_nop 0
  v_mfma_f32_16x16x32_bf16 v[28:31], v[188:191], v[24:27], v[28:31]
  v_mov_b32_dpp v44, v40 row_ror:12 row_mask:0xf bank_mask:0x8
  v_mov_b32_dpp v45, v41 row_ror:8 row_mask:0xf bank_mask:0x8
  v_mov_b32_dpp v46, v42 row_ror:4 row_mask:0xf bank_mask:0x8
  v_mov_b32_dpp v47, v43 quad_perm:[0,1,2,3] row_mask:0xf bank_mask:0x8
  v_add_f32 v10, v44, v45
  v_add_f32 v11, v46, v47
  v_add_f32 v10, v10, v11
  v_cvt_pk_bf16_f32 v10, v10, v10
  v_and_b32 v10, 0xffff0000, v10
  v_mul_f32 v10, 0x3db504f3, v10
  v_cvt_pk_bf16_f32 v10, v10, v10
  v_and_b32 v10, 0xffff0000, v10
  v_max_f32 v7, v7, v10
  v_xad_u32 v10, v244, s54, v10
  ds_write_b32 v6, v10
  v_add_u32 v6, 1024, v6
  s_waitcnt vmcnt(4)
  buffer_load_dwordx4 v[188:191], v4, s[44:47], s52 offen nt
  s_xor_b32 s52, s52, 0x7800
  v_mfma_f32_16x16x32_bf16 v[32:35], v[192:195], v[12:15], 0
  s_nop 0
  v_mfma_f32_16x16x32_bf16 v[32:35], v[196:199], v[16:19], v[32:35]
  s_waitcnt vmcnt(4)
  buffer_load_dwordx4 v[196:199], v4, s[44:47], s52 offen nt
  s_xor_b32 s52, s52, 0x800
  v_mfma_f32_16x16x32_bf16 v[32:35], v[200:203], v[20:23], v[32:35]
  s_nop 0
  v_mfma_f32_16x16x32_bf16 v[32:35], v[204:207], v[24:27], v[32:35]
  v_mov_b32_dpp v44, v28 quad_perm:[0,1,2,3] row_mask:0xf bank_mask:0x1
  v_mov_b32_dpp v45, v29 row_ror:12 row_mask:0xf bank_mask:0x1
  v_mov_b32_dpp v46, v30 row_ror:8 row_mask:0xf bank_mask:0x1
  v_mov_b32_dpp v47, v31 row_ror:4 row_mask:0xf bank_mask:0x1
  s_nop 0
  v_mfma_f32_16x16x32_bf16 v[36:39], v[208:211], v[12:15], 0
  s_waitcnt vmcnt(4)
  buffer_load_dwordx4 v[208:211], v4, s[44:47], s52 offen nt
  s_xor_b32 s52, s52, 0x1800
  v_mfma_f32_16x16x32_bf16 v[36:39], v[212:215], v[16:19], v[36:39]
  s_nop 0
  v_mfma_f32_16x16x32_bf16 v[36:39], v[216:219], v[20:23], v[36:39]
  s_nop 0
  v_mfma_f32_16x16x32_bf16 v[36:39], v[220:223], v[24:27], v[36:39]
  v_mov_b32_dpp v44, v32 row_ror:4 row_mask:0xf bank_mask:0x2
  v_mov_b32_dpp v45, v33 quad_perm:[0,1,2,3] row_mask:0xf bank_mask:0x2
  v_mov_b32_dpp v46, v34 row_ror:12 row_mask:0xf bank_mask:0x2
  v_mov_b32_dpp v47, v35 row_ror:8 row_mask:0xf bank_mask:0x2
  s_waitcnt vmcnt(4)
  buffer_load_dwordx4 v[220:223], v4, s[44:47], s52 offen nt
  s_xor_b32 s52, s52, 0x800
  v_mfma_f32_16x16x32_bf16 v[40:43], v[224:227], v[12:15], 0
  s_nop 0
  v_mfma_f32_16x16x32_bf16 v[40:43], v[228:231], v[16:19], v[40:43]
  s_waitcnt vmcnt(4)
  buffer_load_dwordx4 v[228:231], v4, s[44:47], s52 offen nt
  s_xor_b32 s52, s52, 0x3800
  v_mfma_f32_16x16x32_bf16 v[40:43], v[232:235], v[20:23], v[40:43]
  s_nop 0
  v_mfma_f32_16x16x32_bf16 v[40:43], v[236:239], v[24:27], v[40:43]
  v_mov_b32_dpp v44, v36 row_ror:8 row_mask:0xf bank_mask:0x4
  v_mov_b32_dpp v45, v37 row_ror:4 row_mask:0xf bank_mask:0x4
  v_mov_b32_dpp v46, v38 quad_perm:[0,1,2,3] row_mask:0xf bank_mask:0x4
  v_mov_b32_dpp v47, v39 row_ror:12 row_mask:0xf bank_mask:0x4
  s_xor_b32 s54, s53, 0x1000
  s_nop 0
  v_mfma_f32_16x16x32_bf16 v[28:31], v[48:51], v[12:15], 0
  s_waitcnt vmcnt(4)
  buffer_load_dwordx4 v[236:239], v4, s[44:47], s52 offen nt
  s_xor_b32 s52, s52, 0x800
  v_mfma_f32_16x16x32_bf16 v[28:31], v[52:55], v[16:19], v[28:31]
  s_nop 0
  v_mfma_f32_16x16x32_bf16 v[28:31], v[56:59], v[20:23], v[28:31]
  s_nop 0
  v_mfma_f32_16x16x32_bf16 v[28:31], v[60:63], v[24:27], v[28:31]
  v_mov_b32_dpp v44, v40 row_ror:12 row_mask:0xf bank_mask:0x8
  v_mov_b32_dpp v45, v41 row_ror:8 row_mask:0xf bank_mask:0x8
  v_mov_b32_dpp v46, v42 row_ror:4 row_mask:0xf bank_mask:0x8
  v_mov_b32_dpp v47, v43 quad_perm:[0,1,2,3] row_mask:0xf bank_mask:0x8
  v_add_f32 v10, v44, v45
  v_add_f32 v11, v46, v47
  v_add_f32 v10, v10, v11
  v_cvt_pk_bf16_f32 v10, v10, v10
  v_and_b32 v10, 0xffff0000, v10
  v_mul_f32 v10, 0x3db504f3, v10
  v_cvt_pk_bf16_f32 v10, v10, v10
  v_and_b32 v10, 0xffff0000, v10
  v_max_f32 v7, v7, v10
  v_xad_u32 v10, v244, s54, v10
  ds_write_b32 v6, v10
  v_add_u32 v6, 1024, v6
  s_waitcnt vmcnt(4)
  buffer_load_dwordx4 v[232:235], v4, s[44:47], s52 offen nt
  s_xor_b32 s52, s52, 0x1800
  v_mfma_f32_16x16x32_bf16 v[32:35], v[64:67], v[12:15], 0
  s_nop 0
  v_mfma_f32_16x16x32_bf16 v[32:35], v[68:71], v[16:19], v[32:35]
  s_waitcnt vmcnt(4)
  buffer_load_dwordx4 v[224:227], v4, s[44:47], s52 offen nt
  s_xor_b32 s52, s52, 0x800
  v_mfma_f32_16x16x32_bf16 v[32:35], v[72:75], v[20:23], v[32:35]
  s_nop 0
  v_mfma_f32_16x16x32_bf16 v[32:35], v[76:79], v[24:27], v[32:35]
  v_mov_b32_dpp v44, v28 quad_perm:[0,1,2,3] row_mask:0xf bank_mask:0x1
  v_mov_b32_dpp v45, v29 row_ror:12 row_mask:0xf bank_mask:0x1
  v_mov_b32_dpp v46, v30 row_ror:8 row_mask:0xf bank_mask:0x1
  v_mov_b32_dpp v47, v31 row_ror:4 row_mask:0xf bank_mask:0x1
  s_nop 0
  v_mfma_f32_16x16x32_bf16 v[36:39], v[80:83], v[12:15], 0
  s_waitcnt vmcnt(4)
  buffer_load_dwordx4 v[216:219], v4, s[44:47], s52 offen nt
  s_xor_b32 s52, s52, 0x77800
  v_mfma_f32_16x16x32_bf16 v[36:39], v[84:87], v[16:19], v[36:39]
  s_nop 0
  v_mfma_f32_16x16x32_bf16 v[36:39], v[88:91], v[20:23], v[36:39]
  s_nop 0
  v_mfma_f32_16x16x32_bf16 v[36:39], v[92:95], v[24:27], v[36:39]
  v_mov_b32_dpp v44, v32 row_ror:4 row_mask:0xf bank_mask:0x2
  v_mov_b32_dpp v45, v33 quad_perm:[0,1,2,3] row_mask:0xf bank_mask:0x2
  v_mov_b32_dpp v46, v34 row_ror:12 row_mask:0xf bank_mask:0x2
  v_mov_b32_dpp v47, v35 row_ror:8 row_mask:0xf bank_mask:0x2
  s_waitcnt vmcnt(4)
  buffer_load_dwordx4 v[48:51], v4, s[44:47], s52 offen nt
  s_xor_b32 s52, s52, 0x800
  v_mfma_f32_16x16x32_bf16 v[40:43], v[96:99], v[12:15], 0
  s_nop 0
  v_mfma_f32_16x16x32_bf16 v[40:43], v[100:103], v[16:19], v[40:43]
  s_waitcnt vmcnt(4)
  buffer_load_dwordx4 v[52:55], v4, s[44:47], s52 offen nt
  s_xor_b32 s52, s52, 0x1800
  v_mfma_f32_16x16x32_bf16 v[40:43], v[104:107], v[20:23], v[40:43]
  s_nop 0
  v_mfma_f32_16x16x32_bf16 v[40:43], v[108:111], v[24:27], v[40:43]
  v_mov_b32_dpp v44, v36 row_ror:8 row_mask:0xf bank_mask:0x4
  v_mov_b32_dpp v45, v37 row_ror:4 row_mask:0xf bank_mask:0x4
  v_mov_b32_dpp v46, v38 quad_perm:[0,1,2,3] row_mask:0xf bank_mask:0x4
  v_mov_b32_dpp v47, v39 row_ror:12 row_mask:0xf bank_mask:0x4
  s_xor_b32 s54, s53, 0x400
  s_nop 0
  v_mfma_f32_16x16x32_bf16 v[28:31], v[112:115], v[12:15], 0
  s_waitcnt vmcnt(4)
  buffer_load_dwordx4 v[56:59], v4, s[44:47], s52 offen nt
  s_xor_b32 s52, s52, 0x800
  v_mfma_f32_16x16x32_bf16 v[28:31], v[124:127], v[16:19], v[28:31]
  s_nop 0
  v_mfma_f32_16x16x32_bf16 v[28:31], v[132:135], v[20:23], v[28:31]
  s_nop 0
  v_mfma_f32_16x16x32_bf16 v[28:31], v[144:147], v[24:27], v[28:31]
  v_mov_b32_dpp v44, v40 row_ror:12 row_mask:0xf bank_mask:0x8
  v_mov_b32_dpp v45, v41 row_ror:8 row_mask:0xf bank_mask:0x8
  v_mov_b32_dpp v46, v42 row_ror:4 row_mask:0xf bank_mask:0x8
  v_mov_b32_dpp v47, v43 quad_perm:[0,1,2,3] row_mask:0xf bank_mask:0x8
  v_add_f32 v10, v44, v45
  v_add_f32 v11, v46, v47
  v_add_f32 v10, v10, v11
  v_cvt_pk_bf16_f32 v10, v10, v10
  v_and_b32 v10, 0xffff0000, v10
  v_mul_f32 v10, 0x3db504f3, v10
  v_cvt_pk_bf16_f32 v10, v10, v10
  v_and_b32 v10, 0xffff0000, v10
  v_max_f32 v7, v7, v10
  v_xad_u32 v10, v244, s54, v10
  ds_write_b32 v6, v10
  v_add_u32 v6, 1024, v6
  s_waitcnt vmcnt(4)
  buffer_load_dwordx4 v[60:63], v4, s[44:47], s52 offen nt
  s_xor_b32 s52, s52, 0x3800
  v_mfma_f32_16x16x32_bf16 v[32:35], v[156:159], v[12:15], 0
  s_nop 0
  v_mfma_f32_16x16x32_bf16 v[32:35], v[164:167], v[16:19], v[32:35]
  s_waitcnt vmcnt(4)
  buffer_load_dwordx4 v[64:67], v4, s[44:47], s52 offen nt
  s_xor_b32 s52, s52, 0x800
  v_mfma_f32_16x16x32_bf16 v[32:35], v[176:179], v[20:23], v[32:35]
  s_nop 0
  v_mfma_f32_16x16x32_bf16 v[32:35], v[188:191], v[24:27], v[32:35]
  v_mov_b32_dpp v44, v28 quad_perm:[0,1,2,3] row_mask:0xf bank_mask:0x1
  v_mov_b32_dpp v45, v29 row_ror:12 row_mask:0xf bank_mask:0x1
  v_mov_b32_dpp v46, v30 row_ror:8 row_mask:0xf bank_mask:0x1
  v_mov_b32_dpp v47, v31 row_ror:4 row_mask:0xf bank_mask:0x1
  s_nop 0
  v_mfma_f32_16x16x32_bf16 v[36:39], v[196:199], v[12:15], 0
  s_waitcnt vmcnt(4)
  buffer_load_dwordx4 v[68:71], v4, s[44:47], s52 offen nt
  s_xor_b32 s52, s52, 0x1800
  v_mfma_f32_16x16x32_bf16 v[36:39], v[208:211], v[16:19], v[36:39]
  s_nop 0
  v_mfma_f32_16x16x32_bf16 v[36:39], v[220:223], v[20:23], v[36:39]
  s_nop 0
  v_mfma_f32_16x16x32_bf16 v[36:39], v[228:231], v[24:27], v[36:39]
  v_mov_b32_dpp v44, v32 row_ror:4 row_mask:0xf bank_mask:0x2
  v_mov_b32_dpp v45, v33 quad_perm:[0,1,2,3] row_mask:0xf bank_mask:0x2
  v_mov_b32_dpp v46, v34 row_ror:12 row_mask:0xf bank_mask:0x2
  v_mov_b32_dpp v47, v35 row_ror:8 row_mask:0xf bank_mask:0x2
  s_waitcnt vmcnt(4)
  buffer_load_dwordx4 v[72:75], v4, s[44:47], s52 offen nt
  s_xor_b32 s52, s52, 0x800
  v_mfma_f32_16x16x32_bf16 v[40:43], v[236:239], v[12:15], 0
  s_nop 0
  v_mfma_f32_16x16x32_bf16 v[40:43], v[232:235], v[16:19], v[40:43]
  s_waitcnt vmcnt(4)
  buffer_load_dwordx4 v[76:79], v4, s[44:47], s52 offen nt
  s_xor_b32 s52, s52, 0x7800
  v_mfma_f32_16x16x32_bf16 v[40:43], v[224:227], v[20:23], v[40:43]
  s_nop 0
  v_mfma_f32_16x16x32_bf16 v[40:43], v[216:219], v[24:27], v[40:43]
  v_mov_b32_dpp v44, v36 row_ror:8 row_mask:0xf bank_mask:0x4
  v_mov_b32_dpp v45, v37 row_ror:4 row_mask:0xf bank_mask:0x4
  v_mov_b32_dpp v46, v38 quad_perm:[0,1,2,3] row_mask:0xf bank_mask:0x4
  v_mov_b32_dpp v47, v39 row_ror:12 row_mask:0xf bank_mask:0x4
  s_xor_b32 s54, s53, 0x1400
  s_xor_b32 s55, s53, 0x800
  s_waitcnt lgkmcnt(0)
  v_mov_b32 v10, 26896
  v_mov_b32 v11, 1
  s_mov_b64 exec, 1
  ds_add_u32 v10, v11
  s_mov_b64 exec, -1
  v_mov_b32 v176, 26880
  v_mov_b32 v177, 27024
  s_lshl_b32 s40, s3, 2
  s_add_u32 s41, s40, 26912
  v_mov_b32 v180, s41
  s_add_u32 s41, s40, 24576
  v_lshl_add_u32 v181, v1, 4, s41
  v_and_b32 v185, 1023, v6
  v_add_u32 v185, 43008, v185
  s_mov_b32 s92, 0
  s_mov_b32 s62, 4
  s_mov_b32 s63, 22272
  s_cmp_lt_u32 s2, 96
  s_cselect_b32 s63, 22280, s63
  s_cmp_lt_u32 s2, 32
  s_cselect_b32 s63, 22283, s63
L_kloop:
  s_and_b32 s40, s63, 0xff
  s_cmp_lt_u32 s62, s40
  s_cselect_b32 s40, 8, 12
  s_lshr_b32 s41, s63, s40
  s_and_b32 s41, s41, 15
  s_add_u32 s62, s62, 1
  s_cmp_lt_u32 s41, 5
  s_cbranch_scc0 L_mt1
  s_cmp_lt_u32 s41, 2
  s_cbranch_scc0 L_mt2
  s_cmp_lt_u32 s41, 1
  s_cbranch_scc1 L_km0
  s_branch L_km1
L_mt2:
  s_cmp_lt_u32 s41, 3
  s_cbranch_scc1 L_km2
  s_cmp_lt_u32 s41, 4
  s_cbranch_scc1 L_km3
  s_branch L_km4
L_mt1:
  s_cmp_lt_u32 s41, 7
  s_cbranch_scc0 L_mt6
  s_cmp_lt_u32 s41, 6
  s_cbranch_scc1 L_km5
  s_branch L_km6
L_mt6:
  s_cmp_lt_u32 s41, 8
  s_cbranch_scc1 L_km7
  s_cmp_lt_u32 s41, 9
  s_cbranch_scc1 L_km8
  s_branch L_km9
L_km0:
  s_memrealtime s[74:75]
  s_waitcnt vmcnt(1)
  buffer_load_dwordx4 v[80:83], v4, s[44:47], s52 offen nt
  s_xor_b32 s52, s52, 0x800
  v_mfma_f32_16x16x32_bf16 v[28:31], v[48:51], v[12:15], 0
  s_waitcnt vmcnt(1)
  buffer_load_dwordx4 v[84:87], v4, s[44:47], s52 offen nt
  s_xor_b32 s52, s52, 0x1800
  v_mfma_f32_16x16x32_bf16 v[28:31], v[52:55], v[16:19], v[28:31]
  s_waitcnt vmcnt(1)
  buffer_load_dwordx4 v[88:91], v4, s[44:47], s52 offen nt
  s_xor_b32 s52, s52, 0x800
  v_mfma_f32_16x16x32_bf16 v[28:31], v[56:59], v[20:23], v[28:31]
  s_waitcnt vmcnt(1)
  buffer_load_dwordx4 v[92:95], v4, s[44:47], s52 offen nt
  s_xor_b32 s52, s52, 0x3800
  v_mfma_f32_16x16x32_bf16 v[28:31], v[60:63], v[24:27], v[28:31]
  v_mov_b32_dpp v44, v40 row_ror:12 row_mask:0xf bank_mask:0x8
  v_mov_b32_dpp v45, v41 row_ror:8 row_mask:0xf bank_mask:0x8
  v_mov_b32_dpp v46, v42 row_ror:4 row_mask:0xf bank_mask:0x8
  v_mov_b32_dpp v47, v43 quad_perm:[0,1,2,3] row_mask:0xf bank_mask:0x8
  v_add_f32 v10, v44, v45
  v_add_f32 v11, v46, v47
  v_add_f32 v10, v10, v11
  v_cvt_pk_bf16_f32 v10, v10, v10
  v_and_b32 v10, 0xffff0000, v10
  v_mul_f32 v10, 0x3db504f3, v10
  v_cvt_pk_bf16_f32 v10, v10, v10
  v_and_b32 v10, 0xffff0000, v10
  v_max_f32 v7, v7, v10
  v_xad_u32 v10, v244, s54, v10
  ds_write_b32 v6, v10
  v_add_u32 v6, 1024, v6
  s_mov_b32 s54, s55
  s_cmp_lt_u32 s62, 8
  s_cselect_b64 s[58:59], s[56:57], s[60:61]
  s_waitcnt vmcnt(2)
  buffer_load_dwordx4 v[96:99], v4, s[44:47], s52 offen nt
  s_xor_b32 s52, s52, 0x800
  v_mfma_f32_16x16x32_bf16 v[32:35], v[64:67], v[12:15], 0
  s_lshl_b32 s55, s62, 3
  s_lshr_b64 s[58:59], s[58:59], s55
  s_and_b32 s58, s58, 0xff
  s_lshl_b32 s55, s58, 6
  s_waitcnt vmcnt(2)
  buffer_load_dwordx4 v[100:103], v4, s[44:47], s52 offen nt
  s_xor_b32 s52, s52, 0x1800
  v_mfma_f32_16x16x32_bf16 v[32:35], v[68:71], v[16:19], v[32:35]
  s_waitcnt lgkmcnt(0)
  s_andn2_b32 s74, s74, 15
  s_add_u32 s41, s41, 1
  s_or_b32 s74, s74, s41
  v_mov_b32 v182, s74
  v_mov_b32 v178, s62
  ds_write_b32 v181, v7
  s_mov_b64 exec, 1
  ds_write_b32 v177, v182
  ds_write_b32 v180, v178
  s_mov_b64 exec, -1
  v_add_u32 v177, 4, v177
  s_waitcnt vmcnt(2)
  buffer_load_dwordx4 v[104:107], v4, s[44:47], s52 offen nt
  s_xor_b32 s52, s52, 0x800
  v_mfma_f32_16x16x32_bf16 v[32:35], v[72:75], v[20:23], v[32:35]
  s_waitcnt vmcnt(2)
  buffer_load_dwordx4 v[108:111], v4, s[44:47], s52 offen nt
  s_lshl_b32 s52, s55, 6
  v_mfma_f32_16x16x32_bf16 v[32:35], v[76:79], v[24:27], v[32:35]
  v_mov_b32_dpp v44, v28 quad_perm:[0,1,2,3] row_mask:0xf bank_mask:0x1
  v_mov_b32_dpp v45, v29 row_ror:12 row_mask:0xf bank_mask:0x1
  v_mov_b32_dpp v46, v30 row_ror:8 row_mask:0xf bank_mask:0x1
  v_mov_b32_dpp v47, v31 row_ror:4 row_mask:0xf bank_mask:0x1
  s_waitcnt vmcnt(1)
  buffer_load_dwordx4 v[48:51], v4, s[44:47], s52 offen nt
  s_xor_b32 s52, s52, 0x800
  v_mfma_f32_16x16x32_bf16 v[36:39], v[80:83], v[12:15], 0
  s_waitcnt vmcnt(1)
  buffer_load_dwordx4 v[52:55], v4, s[44:47], s52 offen nt
  s_xor_b32 s52, s52, 0x1800
  v_mfma_f32_16x16x32_bf16 v[36:39], v[84:87], v[16:19], v[36:39]
  s_waitcnt vmcnt(1)
  buffer_load_dwordx4 v[56:59], v4, s[44:47], s52 offen nt
  s_xor_b32 s52, s52, 0x800
  v_mfma_f32_16x16x32_bf16 v[36:39], v[88:91], v[20:23], v[36:39]
  s_waitcnt vmcnt(1)
  buffer_load_dwordx4 v[60:63], v4, s[44:47], s52 offen nt
  s_xor_b32 s52, s52, 0x3800
  v_mfma_f32_16x16x32_bf16 v[36:39], v[92:95], v[24:27], v[36:39]
  v_mov_b32_dpp v44, v32 row_ror:4 row_mask:0xf bank_mask:0x2
  v_mov_b32_dpp v45, v33 quad_perm:[0,1,2,3] row_mask:0xf bank_mask:0x2
  v_mov_b32_dpp v46, v34 row_ror:12 row_mask:0xf bank_mask:0x2
  v_mov_b32_dpp v47, v35 row_ror:8 row_mask:0xf bank_mask:0x2
  ds_read_b64 v[178:179], v176 offset:48
  s_waitcnt vmcnt(2)
  buffer_load_dwordx4 v[64:67], v4, s[44:47], s52 offen nt
  s_xor_b32 s52, s52, 0x800
  v_mfma_f32_16x16x32_bf16 v[40:43], v[96:99], v[12:15], 0
  s_waitcnt vmcnt(2)
  buffer_load_dwordx4 v[68:71], v4, s[44:47], s52 offen nt
  s_xor_b32 s52, s52, 0x1800
  v_mfma_f32_16x16x32_bf16 v[40:43], v[100:103], v[16:19], v[40:43]
  s_waitcnt lgkmcnt(0)
  v_readfirstlane_b32 s40, v178
  v_readfirstlane_b32 s92, v179
  s_waitcnt vmcnt(2)
  buffer_load_dwordx4 v[72:75], v4, s[44:47], s52 offen nt
  s_xor_b32 s52, s52, 0x800
  v_mfma_f32_16x16x32_bf16 v[40:43], v[104:107], v[20:23], v[40:43]
  s_cmp_lg_u32 s40, 0
  s_cselect_b32 s63, s40, s63
  s_waitcnt vmcnt(2)
  buffer_load_dwordx4 v[76:79], v4, s[44:47], s52 offen nt
  s_xor_b32 s52, s52, 0x7800
  v_mfma_f32_16x16x32_bf16 v[40:43], v[108:111], v[24:27], v[40:43]
  v_mov_b32_dpp v44, v36 row_ror:8 row_mask:0xf bank_mask:0x4
  v_mov_b32_dpp v45, v37 row_ror:4 row_mask:0xf bank_mask:0x4
  v_mov_b32_dpp v46, v38 quad_perm:[0,1,2,3] row_mask:0xf bank_mask:0x4
  v_mov_b32_dpp v47, v39 row_ror:12 row_mask:0xf bank_mask:0x4
  s_cmp_lt_u32 s62, 15
  s_cbranch_scc1 L_kloop
  s_branch L_kdone
L_km1:
  s_memrealtime s[74:75]
  s_waitcnt vmcnt(2)
  buffer_load_dwordx4 v[80:83], v4, s[44:47], s52 offen nt
  s_xor_b32 s52, s52, 0x800
  v_mfma_f32_16x16x32_bf16 v[28:31], v[48:51], v[12:15], 0
  s_waitcnt vmcnt(2)
  buffer_load_dwordx4 v[84:87], v4, s[44:47], s52 offen nt
  s_xor_b32 s52, s52, 0x1800
  v_mfma_f32_16x16x32_bf16 v[28:31], v[52:55], v[16:19], v[28:31]
  s_waitcnt vmcnt(2)
  buffer_load_dwordx4 v[88:91], v4, s[44:47], s52 offen nt
  s_xor_b32 s52, s52, 0x800
  v_mfma_f32_16x16x32_bf16 v[28:31], v[56:59], v[20:23], v[28:31]
  s_waitcnt vmcnt(2)
  buffer_load_dwordx4 v[92:95], v4, s[44:47], s52 offen nt
  s_xor_b32 s52, s52, 0x3800
  v_mfma_f32_16x16x32_bf16 v[28:31], v[60:63], v[24:27], v[28:31]
  v_mov_b32_dpp v44, v40 row_ror:12 row_mask:0xf bank_mask:0x8
  v_mov_b32_dpp v45, v41 row_ror:8 row_mask:0xf bank_mask:0x8
  v_mov_b32_dpp v46, v42 row_ror:4 row_mask:0xf bank_mask:0x8
  v_mov_b32_dpp v47, v43 quad_perm:[0,1,2,3] row_mask:0xf bank_mask:0x8
  v_add_f32 v10, v44, v45
  v_add_f32 v11, v46, v47
  v_add_f32 v10, v10, v11
  v_cvt_pk_bf16_f32 v10, v10, v10
  v_and_b32 v10, 0xffff0000, v10
  v_mul_f32 v10, 0x3db504f3, v10
  v_cvt_pk_bf16_f32 v10, v10, v10
  v_and_b32 v10, 0xffff0000, v10
  v_max_f32 v7, v7, v10
  v_xad_u32 v10, v244, s54, v10
  ds_write_b32 v6, v10
  v_add_u32 v6, 1024, v6
  s_mov_b32 s54, s55
  s_cmp_lt_u32 s62, 8
  s_cselect_b64 s[58:59], s[56:57], s[60:61]
  s_waitcnt vmcnt(2)
  buffer_load_dwordx4 v[96:99], v4, s[44:47], s52 offen nt
  s_xor_b32 s52, s52, 0x800
  v_mfma_f32_16x16x32_bf16 v[32:35], v[64:67], v[12:15], 0
  s_lshl_b32 s55, s62, 3
  s_lshr_b64 s[58:59], s[58:59], s55
  s_and_b32 s58, s58, 0xff
  s_lshl_b32 s55, s58, 6
  s_waitcnt vmcnt(2)
  buffer_load_dwordx4 v[100:103], v4, s[44:47], s52 offen nt
  s_xor_b32 s52, s52, 0x1800
  v_mfma_f32_16x16x32_bf16 v[32:35], v[68:71], v[16:19], v[32:35]
  s_waitcnt lgkmcnt(0)
  s_andn2_b32 s74, s74, 15
  s_add_u32 s41, s41, 1
  s_or_b32 s74, s74, s41
  v_mov_b32 v182, s74
  v_mov_b32 v178, s62
  ds_write_b32 v181, v7
  s_mov_b64 exec, 1
  ds_write_b32 v177, v182
  ds_write_b32 v180, v178
  s_mov_b64 exec, -1
  v_add_u32 v177, 4, v177
  s_waitcnt vmcnt(2)
  buffer_load_dwordx4 v[104:107], v4, s[44:47], s52 offen nt
  s_xor_b32 s52, s52, 0x800
  v_mfma_f32_16x16x32_bf16 v[32:35], v[72:75], v[20:23], v[32:35]
  s_waitcnt vmcnt(2)
  buffer_load_dwordx4 v[108:111], v4, s[44:47], s52 offen nt
  s_lshl_b32 s52, s55, 6
  v_mfma_f32_16x16x32_bf16 v[32:35], v[76:79], v[24:27], v[32:35]
  v_mov_b32_dpp v44, v28 quad_perm:[0,1,2,3] row_mask:0xf bank_mask:0x1
  v_mov_b32_dpp v45, v29 row_ror:12 row_mask:0xf bank_mask:0x1
  v_mov_b32_dpp v46, v30 row_ror:8 row_mask:0xf bank_mask:0x1
  v_mov_b32_dpp v47, v31 row_ror:4 row_mask:0xf bank_mask:0x1
  s_waitcnt vmcnt(2)
  buffer_load_dwordx4 v[48:51], v4, s[44:47], s52 offen nt
  s_xor_b32 s52, s52, 0x800
  v_mfma_f32_16x16x32_bf16 v[36:39], v[80:83], v[12:15], 0
  s_waitcnt vmcnt(2)
  buffer_load_dwordx4 v[52:55], v4, s[44:47], s52 offen nt
  s_xor_b32 s52, s52, 0x1800
  v_mfma_f32_16x16x32_bf16 v[36:39], v[84:87], v[16:19], v[36:39]
  s_waitcnt vmcnt(2)
  buffer_load_dwordx4 v[56:59], v4, s[44:47], s52 offen nt
  s_xor_b32 s52, s52, 0x800
  v_mfma_f32_16x16x32_bf16 v[36:39], v[88:91], v[20:23], v[36:39]
  s_waitcnt vmcnt(2)
  buffer_load_dwordx4 v[60:63], v4, s[44:47], s52 offen nt
  s_xor_b32 s52, s52, 0x3800
  v_mfma_f32_16x16x32_bf16 v[36:39], v[92:95], v[24:27], v[36:39]
  v_mov_b32_dpp v44, v32 row_ror:4 row_mask:0xf bank_mask:0x2
  v_mov_b32_dpp v45, v33 quad_perm:[0,1,2,3] row_mask:0xf bank_mask:0x2
  v_mov_b32_dpp v46, v34 row_ror:12 row_mask:0xf bank_mask:0x2
  v_mov_b32_dpp v47, v35 row_ror:8 row_mask:0xf bank_mask:0x2
  ds_read_b64 v[178:179], v176 offset:48
  s_waitcnt vmcnt(2)
  buffer_load_dwordx4 v[64:67], v4, s[44:47], s52 offen nt
  s_xor_b32 s52, s52, 0x800
  v_mfma_f32_16x16x32_bf16 v[40:43], v[96:99], v[12:15], 0
  s_waitcnt vmcnt(2)
  buffer_load_dwordx4 v[68:71], v4, s[44:47], s52 offen nt
  s_xor_b32 s52, s52, 0x1800
  v_mfma_f32_16x16x32_bf16 v[40:43], v[100:103], v[16:19], v[40:43]
  s_waitcnt lgkmcnt(0)
  v_readfirstlane_b32 s40, v178
  v_readfirstlane_b32 s92, v179
  s_waitcnt vmcnt(2)
  buffer_load_dwordx4 v[72:75], v4, s[44:47], s52 offen nt
  s_xor_b32 s52, s52, 0x800
  v_mfma_f32_16x16x32_bf16 v[40:43], v[104:107], v[20:23], v[40:43]
  s_cmp_lg_u32 s40, 0
  s_cselect_b32 s63, s40, s63
  s_waitcnt vmcnt(2)
  buffer_load_dwordx4 v[76:79], v4, s[44:47], s52 offen nt
  s_xor_b32 s52, s52, 0x7800
  v_mfma_f32_16x16x32_bf16 v[40:43], v[108:111], v[24:27], v[40:43]
  v_mov_b32_dpp v44, v36 row_ror:8 row_mask:0xf bank_mask:0x4
  v_mov_b32_dpp v45, v37 row_ror:4 row_mask:0xf bank_mask:0x4
  v_mov_b32_dpp v46, v38 quad_perm:[0,1,2,3] row_mask:0xf bank_mask:0x4
  v_mov_b32_dpp v47, v39 row_ror:12 row_mask:0xf bank_mask:0x4
  s_cmp_lt_u32 s62, 15
  s_cbranch_scc1 L_kloop
  s_branch L_kdone
L_km2:
  s_memrealtime s[74:75]
  s_waitcnt vmcnt(2)
  buffer_load_dwordx4 v[80:83], v4, s[44:47], s52 offen nt
  s_xor_b32 s52, s52, 0x800
  v_mfma_f32_16x16x32_bf16 v[28:31], v[48:51], v[12:15], 0
  s_waitcnt vmcnt(2)
  buffer_load_dwordx4 v[84:87], v4, s[44:47], s52 offen nt
  s_xor_b32 s52, s52, 0x1800
  v_mfma_f32_16x16x32_bf16 v[28:31], v[52:55], v[16:19], v[28:31]
  s_waitcnt vmcnt(2)
  buffer_load_dwordx4 v[88:91], v4, s[44:47], s52 offen nt
  s_xor_b32 s52, s52, 0x800
  v_mfma_f32_16x16x32_bf16 v[28:31], v[56:59], v[20:23], v[28:31]
  s_waitcnt vmcnt(2)
  buffer_load_dwordx4 v[92:95], v4, s[44:47], s52 offen nt
  s_xor_b32 s52, s52, 0x3800
  v_mfma_f32_16x16x32_bf16 v[28:31], v[60:63], v[24:27], v[28:31]
  v_mov_b32_dpp v44, v40 row_ror:12 row_mask:0xf bank_mask:0x8
  v_mov_b32_dpp v45, v41 row_ror:8 row_mask:0xf bank_mask:0x8
  v_mov_b32_dpp v46, v42 row_ror:4 row_mask:0xf bank_mask:0x8
  v_mov_b32_dpp v47, v43 quad_perm:[0,1,2,3] row_mask:0xf bank_mask:0x8
  v_add_f32 v10, v44, v45
  v_add_f32 v11, v46, v47
  v_add_f32 v10, v10, v11
  v_cvt_pk_bf16_f32 v10, v10, v10
  v_and_b32 v10, 0xffff0000, v10
  v_mul_f32 v10, 0x3db504f3, v10
  v_cvt_pk_bf16_f32 v10, v10, v10
  v_and_b32 v10, 0xffff0000, v10
  v_max_f32 v7, v7, v10
  v_xad_u32 v10, v244, s54, v10
  ds_write_b32 v6, v10
  v_add_u32 v6, 1024, v6
  s_mov_b32 s54, s55
  s_cmp_lt_u32 s62, 8
  s_cselect_b64 s[58:59], s[56:57], s[60:61]
  s_waitcnt vmcnt(3)
  buffer_load_dwordx4 v[96:99], v4, s[44:47], s52 offen nt
  s_xor_b32 s52, s52, 0x800
  v_mfma_f32_16x16x32_bf16 v[32:35], v[64:67], v[12:15], 0
  s_lshl_b32 s55, s62, 3
  s_lshr_b64 s[58:59], s[58:59], s55
  s_and_b32 s58, s58, 0xff
  s_lshl_b32 s55, s58, 6
  s_waitcnt vmcnt(3)
  buffer_load_dwordx4 v[100:103], v4, s[44:47], s52 offen nt
  s_xor_b32 s52, s52, 0x1800
  v_mfma_f32_16x16x32_bf16 v[32:35], v[68:71], v[16:19], v[32:35]
  s_waitcnt lgkmcnt(0)
  s_andn2_b32 s74, s74, 15
  s_add_u32 s41, s41, 1
  s_or_b32 s74, s74, s41
  v_mov_b32 v182, s74
  v_mov_b32 v178, s62
  ds_write_b32 v181, v7
  s_mov_b64 exec, 1
  ds_write_b32 v177, v182
  ds_write_b32 v180, v178
  s_mov_b64 exec, -1
  v_add_u32 v177, 4, v177
  s_waitcnt vmcnt(3)
  buffer_load_dwordx4 v[104:107], v4, s[44:47], s52 offen nt
  s_xor_b32 s52, s52, 0x800
  v_mfma_f32_16x16x32_bf16 v[32:35], v[72:75], v[20:23], v[32:35]
  s_waitcnt vmcnt(3)
  buffer_load_dwordx4 v[108:111], v4, s[44:47], s52 offen nt
  s_lshl_b32 s52, s55, 6
  v_mfma_f32_16x16x32_bf16 v[32:35], v[76:79], v[24:27], v[32:35]
  v_mov_b32_dpp v44, v28 quad_perm:[0,1,2,3] row_mask:0xf bank_mask:0x1
  v_mov_b32_dpp v45, v29 row_ror:12 row_mask:0xf bank_mask:0x1
  v_mov_b32_dpp v46, v30 row_ror:8 row_mask:0xf bank_mask:0x1
  v_mov_b32_dpp v47, v31 row_ror:4 row_mask:0xf bank_mask:0x1
  s_waitcnt vmcnt(2)
  buffer_load_dwordx4 v[48:51], v4, s[44:47], s52 offen nt
  s_xor_b32 s52, s52, 0x800
  v_mfma_f32_16x16x32_bf16 v[36:39], v[80:83], v[12:15], 0
  s_waitcnt vmcnt(2)
  buffer_load_dwordx4 v[52:55], v4, s[44:47], s52 offen nt
  s_xor_b32 s52, s52, 0x1800
  v_mfma_f32_16x16x32_bf16 v[36:39], v[84:87], v[16:19], v[36:39]
  s_waitcnt vmcnt(2)
  buffer_load_dwordx4 v[56:59], v4, s[44:47], s52 offen nt
  s_xor_b32 s52, s52, 0x800
  v_mfma_f32_16x16x32_bf16 v[36:39], v[88:91], v[20:23], v[36:39]
  s_waitcnt vmcnt(2)
  buffer_load_dwordx4 v[60:63], v4, s[44:47], s52 offen nt
  s_xor_b32 s52, s52, 0x3800
  v_mfma_f32_16x16x32_bf16 v[36:39], v[92:95], v[24:27], v[36:39]
  v_mov_b32_dpp v44, v32 row_ror:4 row_mask:0xf bank_mask:0x2
  v_mov_b32_dpp v45, v33 quad_perm:[0,1,2,3] row_mask:0xf bank_mask:0x2
  v_mov_b32_dpp v46, v34 row_ror:12 row_mask:0xf bank_mask:0x2
  v_mov_b32_dpp v47, v35 row_ror:8 row_mask:0xf bank_mask:0x2
  ds_read_b64 v[178:179], v176 offset:48
  s_waitcnt vmcnt(3)
  buffer_load_dwordx4 v[64:67], v4, s[44:47], s52 offen nt
  s_xor_b32 s52, s52, 0x800
  v_mfma_f32_16x16x32_bf16 v[40:43], v[96:99], v[12:15], 0
  s_waitcnt vmcnt(3)
  buffer_load_dwordx4 v[68:71], v4, s[44:47], s52 offen nt
  s_xor_b32 s52, s52, 0x1800
  v_mfma_f32_16x16x32_bf16 v[40:43], v[100:103], v[16:19], v[40:43]
  s_waitcnt lgkmcnt(0)
  v_readfirstlane_b32 s40, v178
  v_readfirstlane_b32 s92, v179
  s_waitcnt vmcnt(3)
  buffer_load_dwordx4 v[72:75], v4, s[44:47], s52 offen nt
  s_xor_b32 s52, s52, 0x800
  v_mfma_f32_16x16x32_bf16 v[40:43], v[104:107], v[20:23], v[40:43]
  s_cmp_lg_u32 s40, 0
  s_cselect_b32 s63, s40, s63
  s_waitcnt vmcnt(3)
  buffer_load_dwordx4 v[76:79], v4, s[44:47], s52 offen nt
  s_xor_b32 s52, s52, 0x7800
  v_mfma_f32_16x16x32_bf16 v[40:43], v[108:111], v[24:27], v[40:43]
  v_mov_b32_dpp v44, v36 row_ror:8 row_mask:0xf bank_mask:0x4
  v_mov_b32_dpp v45, v37 row_ror:4 row_mask:0xf bank_mask:0x4
  v_mov_b32_dpp v46, v38 quad_perm:[0,1,2,3] row_mask:0xf bank_mask:0x4
  v_mov_b32_dpp v47, v39 row_ror:12 row_mask:0xf bank_mask:0x4
  s_cmp_lt_u32 s62, 15
  s_cbranch_scc1 L_kloop
  s_branch L_kdone
L_km3:
  s_memrealtime s[74:75]
  s_waitcnt vmcnt(3)
  buffer_load_dwordx4 v[80:83], v4, s[44:47], s52 offen nt
  s_xor_b32 s52, s52, 0x800
  v_mfma_f32_16x16x32_bf16 v[28:31], v[48:51], v[12:15], 0
  s_waitcnt vmcnt(3)
  buffer_load_dwordx4 v[84:87], v4, s[44:47], s52 offen nt
  s_xor_b32 s52, s52, 0x1800
  v_mfma_f32_16x16x32_bf16 v[28:31], v[52:55], v[16:19], v[28:31]
  s_waitcnt vmcnt(3)
  buffer_load_dwordx4 v[88:91], v4, s[44:47], s52 offen nt
  s_xor_b32 s52, s52, 0x800
  v_mfma_f32_16x16x32_bf16 v[28:31], v[56:59], v[20:23], v[28:31]
  s_waitcnt vmcnt(3)
  buffer_load_dwordx4 v[92:95], v4, s[44:47], s52 offen nt
  s_xor_b32 s52, s52, 0x3800
  v_mfma_f32_16x16x32_bf16 v[28:31], v[60:63], v[24:27], v[28:31]
  v_mov_b32_dpp v44, v40 row_ror:12 row_mask:0xf bank_mask:0x8
  v_mov_b32_dpp v45, v41 row_ror:8 row_mask:0xf bank_mask:0x8
  v_mov_b32_dpp v46, v42 row_ror:4 row_mask:0xf bank_mask:0x8
  v_mov_b32_dpp v47, v43 quad_perm:[0,1,2,3] row_mask:0xf bank_mask:0x8
  v_add_f32 v10, v44, v45
  v_add_f32 v11, v46, v47
  v_add_f32 v10, v10, v11
  v_cvt_pk_bf16_f32 v10, v10, v10
  v_and_b32 v10, 0xffff0000, v10
  v_mul_f32 v10, 0x3db504f3, v10
  v_cvt_pk_bf16_f32 v10, v10, v10
  v_and_b32 v10, 0xffff0000, v10
  v_max_f32 v7, v7, v10
  v_xad_u32 v10, v244, s54, v10
  ds_write_b32 v6, v10
  v_add_u32 v6, 1024, v6
  s_mov_b32 s54, s55
  s_cmp_lt_u32 s62, 8
  s_cselect_b64 s[58:59], s[56:57], s[60:61]
  s_waitcnt vmcnt(3)
  buffer_load_dwordx4 v[96:99], v4, s[44:47], s52 offen nt
  s_xor_b32 s52, s52, 0x800
  v_mfma_f32_16x16x32_bf16 v[32:35], v[64:67], v[12:15], 0
  s_lshl_b32 s55, s62, 3
  s_lshr_b64 s[58:59], s[58:59], s55
  s_and_b32 s58, s58, 0xff
  s_lshl_b32 s55, s58, 6
  s_waitcnt vmcnt(3)
  buffer_load_dwordx4 v[100:103], v4, s[44:47], s52 offen nt
  s_xor_b32 s52, s52, 0x1800
  v_mfma_f32_16x16x32_bf16 v[32:35], v[68:71], v[16:19], v[32:35]
  s_waitcnt lgkmcnt(0)
  s_andn2_b32 s74, s74, 15
  s_add_u32 s41, s41, 1
  s_or_b32 s74, s74, s41
  v_mov_b32 v182, s74
  v_mov_b32 v178, s62
  ds_write_b32 v181, v7
  s_mov_b64 exec, 1
  ds_write_b32 v177, v182
  ds_write_b32 v180, v178
  s_mov_b64 exec, -1
  v_add_u32 v177, 4, v177
  s_waitcnt vmcnt(3)
  buffer_load_dwordx4 v[104:107], v4, s[44:47], s52 offen nt
  s_xor_b32 s52, s52, 0x800
  v_mfma_f32_16x16x32_bf16 v[32:35], v[72:75], v[20:23], v[32:35]
  s_waitcnt vmcnt(3)
  buffer_load_dwordx4 v[108:111], v4, s[44:47], s52 offen nt
  s_lshl_b32 s52, s55, 6
  v_mfma_f32_16x16x32_bf16 v[32:35], v[76:79], v[24:27], v[32:35]
  v_mov_b32_dpp v44, v28 quad_perm:[0,1,2,3] row_mask:0xf bank_mask:0x1
  v_mov_b32_dpp v45, v29 row_ror:12 row_mask:0xf bank_mask:0x1
  v_mov_b32_dpp v46, v30 row_ror:8 row_mask:0xf bank_mask:0x1
  v_mov_b32_dpp v47, v31 row_ror:4 row_mask:0xf bank_mask:0x1
  s_waitcnt vmcnt(3)
  buffer_load_dwordx4 v[48:51], v4, s[44:47], s52 offen nt
  s_xor_b32 s52, s52, 0x800
  v_mfma_f32_16x16x32_bf16 v[36:39], v[80:83], v[12:15], 0
  s_waitcnt vmcnt(3)
  buffer_load_dwordx4 v[52:55], v4, s[44:47], s52 offen nt
  s_xor_b32 s52, s52, 0x1800
  v_mfma_f32_16x16x32_bf16 v[36:39], v[84:87], v[16:19], v[36:39]
  s_waitcnt vmcnt(3)
  buffer_load_dwordx4 v[56:59], v4, s[44:47], s52 offen nt
  s_xor_b32 s52, s52, 0x800
  v_mfma_f32_16x16x32_bf16 v[36:39], v[88:91], v[20:23], v[36:39]
  s_waitcnt vmcnt(3)
  buffer_load_dwordx4 v[60:63], v4, s[44:47], s52 offen nt
  s_xor_b32 s52, s52, 0x3800
  v_mfma_f32_16x16x32_bf16 v[36:39], v[92:95], v[24:27], v[36:39]
  v_mov_b32_dpp v44, v32 row_ror:4 row_mask:0xf bank_mask:0x2
  v_mov_b32_dpp v45, v33 quad_perm:[0,1,2,3] row_mask:0xf bank_mask:0x2
  v_mov_b32_dpp v46, v34 row_ror:12 row_mask:0xf bank_mask:0x2
  v_mov_b32_dpp v47, v35 row_ror:8 row_mask:0xf bank_mask:0x2
  ds_read_b64 v[178:179], v176 offset:48
  s_waitcnt vmcnt(3)
  buffer_load_dwordx4 v[64:67], v4, s[44:47], s52 offen nt
  s_xor_b32 s52, s52, 0x800
  v_mfma_f32_16x16x32_bf16 v[40:43], v[96:99], v[12:15], 0
  s_waitcnt vmcnt(3)
  buffer_load_dwordx4 v[68:71], v4, s[44:47], s52 offen nt
  s_xor_b32 s52, s52, 0x1800
  v_mfma_f32_16x16x32_bf16 v[40:43], v[100:103], v[16:19], v[40:43]
  s_waitcnt lgkmcnt(0)
  v_readfirstlane_b32 s40, v178
  v_readfirstlane_b32 s92, v179
  s_waitcnt vmcnt(3)
  buffer_load_dwordx4 v[72:75], v4, s[44:47], s52 offen nt
  s_xor_b32 s52, s52, 0x800
  v_mfma_f32_16x16x32_bf16 v[40:43], v[104:107], v[20:23], v[40:43]
  s_cmp_lg_u32 s40, 0
  s_cselect_b32 s63, s40, s63
  s_waitcnt vmcnt(3)
  buffer_load_dwordx4 v[76:79], v4, s[44:47], s52 offen nt
  s_xor_b32 s52, s52, 0x7800
  v_mfma_f32_16x16x32_bf16 v[40:43], v[108:111], v[24:27], v[40:43]
  v_mov_b32_dpp v44, v36 row_ror:8 row_mask:0xf bank_mask:0x4
  v_mov_b32_dpp v45, v37 row_ror:4 row_mask:0xf bank_mask:0x4
  v_mov_b32_dpp v46, v38 quad_perm:[0,1,2,3] row_mask:0xf bank_mask:0x4
  v_mov_b32_dpp v47, v39 row_ror:12 row_mask:0xf bank_mask:0x4
  s_cmp_lt_u32 s62, 15
  s_cbranch_scc1 L_kloop
  s_branch L_kdone
L_km4:
  s_memrealtime s[74:75]
  s_waitcnt vmcnt(3)
  buffer_load_dwordx4 v[80:83], v4, s[44:47], s52 offen nt
  s_xor_b32 s52, s52, 0x800
  v_mfma_f32_16x16x32_bf16 v[28:31], v[48:51], v[12:15], 0
  s_waitcnt vmcnt(3)
  buffer_load_dwordx4 v[84:87], v4, s[44:47], s52 offen nt
  s_xor_b32 s52, s52, 0x1800
  v_mfma_f32_16x16x32_bf16 v[28:31], v[52:55], v[16:19], v[28:31]
  s_waitcnt vmcnt(3)
  buffer_load_dwordx4 v[88:91], v4, s[44:47], s52 offen nt
  s_xor_b32 s52, s52, 0x800
  v_mfma_f32_16x16x32_bf16 v[28:31], v[56:59], v[20:23], v[28:31]
  s_waitcnt vmcnt(3)
  buffer_load_dwordx4 v[92:95], v4, s[44:47], s52 offen nt
  s_xor_b32 s52, s52, 0x3800
  v_mfma_f32_16x16x32_bf16 v[28:31], v[60:63], v[24:27], v[28:31]
  v_mov_b32_dpp v44, v40 row_ror:12 row_mask:0xf bank_mask:0x8
  v_mov_b32_dpp v45, v41 row_ror:8 row_mask:0xf bank_mask:0x8
  v_mov_b32_dpp v46, v42 row_ror:4 row_mask:0xf bank_mask:0x8
  v_mov_b32_dpp v47, v43 quad_perm:[0,1,2,3] row_mask:0xf bank_mask:0x8
  v_add_f32 v10, v44, v45
  v_add_f32 v11, v46, v47
  v_add_f32 v10, v10, v11
  v_cvt_pk_bf16_f32 v10, v10, v10
  v_and_b32 v10, 0xffff0000, v10
  v_mul_f32 v10, 0x3db504f3, v10
  v_cvt_pk_bf16_f32 v10, v10, v10
  v_and_b32 v10, 0xffff0000, v10
  v_max_f32 v7, v7, v10
  v_xad_u32 v10, v244, s54, v10
  ds_write_b32 v6, v10
  v_add_u32 v6, 1024, v6
  s_mov_b32 s54, s55
  s_cmp_lt_u32 s62, 8
  s_cselect_b64 s[58:59], s[56:57], s[60:61]
  s_waitcnt vmcnt(4)
  buffer_load_dwordx4 v[96:99], v4, s[44:47], s52 offen nt
  s_xor_b32 s52, s52, 0x800
  v_mfma_f32_16x16x32_bf16 v[32:35], v[64:67], v[12:15], 0
  s_lshl_b32 s55, s62, 3
  s_lshr_b64 s[58:59], s[58:59], s55
  s_and_b32 s58, s58, 0xff
  s_lshl_b32 s55, s58, 6
  s_waitcnt vmcnt(4)
  buffer_load_dwordx4 v[100:103], v4, s[44:47], s52 offen nt
  s_xor_b32 s52, s52, 0x1800
  v_mfma_f32_16x16x32_bf16 v[32:35], v[68:71], v[16:19], v[32:35]
  s_waitcnt lgkmcnt(0)
  s_andn2_b32 s74, s74, 15
  s_add_u32 s41, s41, 1
  s_or_b32 s74, s74, s41
  v_mov_b32 v182, s74
  v_mov_b32 v178, s62
  ds_write_b32 v181, v7
  s_mov_b64 exec, 1
  ds_write_b32 v177, v182
  ds_write_b32 v180, v178
  s_mov_b64 exec, -1
  v_add_u32 v177, 4, v177
  s_waitcnt vmcnt(4)
  buffer_load_dwordx4 v[104:107], v4, s[44:47], s52 offen nt
  s_xor_b32 s52, s52, 0x800
  v_mfma_f32_16x16x32_bf16 v[32:35], v[72:75], v[20:23], v[32:35]
  s_waitcnt vmcnt(4)
  buffer_load_dwordx4 v[108:111], v4, s[44:47], s52 offen nt
  s_lshl_b32 s52, s55, 6
  v_mfma_f32_16x16x32_bf16 v[32:35], v[76:79], v[24:27], v[32:35]
  v_mov_b32_dpp v44, v28 quad_perm:[0,1,2,3] row_mask:0xf bank_mask:0x1
  v_mov_b32_dpp v45, v29 row_ror:12 row_mask:0xf bank_mask:0x1
  v_mov_b32_dpp v46, v30 row_ror:8 row_mask:0xf bank_mask:0x1
  v_mov_b32_dpp v47, v31 row_ror:4 row_mask:0xf bank_mask:0x1
  s_waitcnt vmcnt(3)
  buffer_load_dwordx4 v[48:51], v4, s[44:47], s52 offen nt
  s_xor_b32 s52, s52, 0x800
  v_mfma_f32_16x16x32_bf16 v[36:39], v[80:83], v[12:15], 0
  s_waitcnt vmcnt(3)
  buffer_load_dwordx4 v[52:55], v4, s[44:47], s52 offen nt
  s_xor_b32 s52, s52, 0x1800
  v_mfma_f32_16x16x32_bf16 v[36:39], v[84:87], v[16:19], v[36:39]
  s_waitcnt vmcnt(3)
  buffer_load_dwordx4 v[56:59], v4, s[44:47], s52 offen nt
  s_xor_b32 s52, s52, 0x800
  v_mfma_f32_16x16x32_bf16 v[36:39], v[88:91], v[20:23], v[36:39]
  s_waitcnt vmcnt(3)
  buffer_load_dwordx4 v[60:63], v4, s[44:47], s52 offen nt
  s_xor_b32 s52, s52, 0x3800
  v_mfma_f32_16x16x32_bf16 v[36:39], v[92:95], v[24:27], v[36:39]
  v_mov_b32_dpp v44, v32 row_ror:4 row_mask:0xf bank_mask:0x2
  v_mov_b32_dpp v45, v33 quad_perm:[0,1,2,3] row_mask:0xf bank_mask:0x2
  v_mov_b32_dpp v46, v34 row_ror:12 row_mask:0xf bank_mask:0x2
  v_mov_b32_dpp v47, v35 row_ror:8 row_mask:0xf bank_mask:0x2
  ds_read_b64 v[178:179], v176 offset:48
  s_waitcnt vmcnt(4)
  buffer_load_dwordx4 v[64:67], v4, s[44:47], s52 offen nt
  s_xor_b32 s52, s52, 0x800
  v_mfma_f32_16x16x32_bf16 v[40:43], v[96:99], v[12:15], 0
  s_waitcnt vmcnt(4)
  buffer_load_dwordx4 v[68:71], v4, s[44:47], s52 offen nt
  s_xor_b32 s52, s52, 0x1800
  v_mfma_f32_16x16x32_bf16 v[40:43], v[100:103], v[16:19], v[40:43]
  s_waitcnt lgkmcnt(0)
  v_readfirstlane_b32 s40, v178
  v_readfirstlane_b32 s92, v179
  s_waitcnt vmcnt(4)
  buffer_load_dwordx4 v[72:75], v4, s[44:47], s52 offen nt
  s_xor_b32 s52, s52, 0x800
  v_mfma_f32_16x16x32_bf16 v[40:43], v[104:107], v[20:23], v[40:43]
  s_cmp_lg_u32 s40, 0
  s_cselect_b32 s63, s40, s63
  s_waitcnt vmcnt(4)
  buffer_load_dwordx4 v[76:79], v4, s[44:47], s52 offen nt
  s_xor_b32 s52, s52, 0x7800
  v_mfma_f32_16x16x32_bf16 v[40:43], v[108:111], v[24:27], v[40:43]
  v_mov_b32_dpp v44, v36 row_ror:8 row_mask:0xf bank_mask:0x4
  v_mov_b32_dpp v45, v37 row_ror:4 row_mask:0xf bank_mask:0x4
  v_mov_b32_dpp v46, v38 quad_perm:[0,1,2,3] row_mask:0xf bank_mask:0x4
  v_mov_b32_dpp v47, v39 row_ror:12 row_mask:0xf bank_mask:0x4
  s_cmp_lt_u32 s62, 15
  s_cbranch_scc1 L_kloop
  s_branch L_kdone
L_km5:
  s_memrealtime s[74:75]
  s_waitcnt vmcnt(4)
  buffer_load_dwordx4 v[80:83], v4, s[44:47], s52 offen nt
  s_xor_b32 s52, s52, 0x800
  v_mfma_f32_16x16x32_bf16 v[28:31], v[48:51], v[12:15], 0
  s_waitcnt vmcnt(4)
  buffer_load_dwordx4 v[84:87], v4, s[44:47], s52 offen nt
  s_xor_b32 s52, s52, 0x1800
  v_mfma_f32_16x16x32_bf16 v[28:31], v[52:55], v[16:19], v[28:31]
  s_waitcnt vmcnt(4)
  buffer_load_dwordx4 v[88:91], v4, s[44:47], s52 offen nt
  s_xor_b32 s52, s52, 0x800
  v_mfma_f32_16x16x32_bf16 v[28:31], v[56:59], v[20:23], v[28:31]
  s_waitcnt vmcnt(4)
  buffer_load_dwordx4 v[92:95], v4, s[44:47], s52 offen nt
  s_xor_b32 s52, s52, 0x3800
  v_mfma_f32_16x16x32_bf16 v[28:31], v[60:63], v[24:27], v[28:31]
  v_mov_b32_dpp v44, v40 row_ror:12 row_mask:0xf bank_mask:0x8
  v_mov_b32_dpp v45, v41 row_ror:8 row_mask:0xf bank_mask:0x8
  v_mov_b32_dpp v46, v42 row_ror:4 row_mask:0xf bank_mask:0x8
  v_mov_b32_dpp v47, v43 quad_perm:[0,1,2,3] row_mask:0xf bank_mask:0x8
  v_add_f32 v10, v44, v45
  v_add_f32 v11, v46, v47
  v_add_f32 v10, v10, v11
  v_cvt_pk_bf16_f32 v10, v10, v10
  v_and_b32 v10, 0xffff0000, v10
  v_mul_f32 v10, 0x3db504f3, v10
  v_cvt_pk_bf16_f32 v10, v10, v10
  v_and_b32 v10, 0xffff0000, v10
  v_max_f32 v7, v7, v10
  v_xad_u32 v10, v244, s54, v10
  ds_write_b32 v6, v10
  v_add_u32 v6, 1024, v6
  s_mov_b32 s54, s55
  s_cmp_lt_u32 s62, 8
  s_cselect_b64 s[58:59], s[56:57], s[60:61]
  s_waitcnt vmcnt(4)
  buffer_load_dwordx4 v[96:99], v4, s[44:47], s52 offen nt
  s_xor_b32 s52, s52, 0x800
  v_mfma_f32_16x16x32_bf16 v[32:35], v[64:67], v[12:15], 0
  s_lshl_b32 s55, s62, 3
  s_lshr_b64 s[58:59], s[58:59], s55
  s_and_b32 s58, s58, 0xff
  s_lshl_b32 s55, s58, 6
  s_waitcnt vmcnt(4)
  buffer_load_dwordx4 v[100:103], v4, s[44:47], s52 offen nt
  s_xor_b32 s52, s52, 0x1800
  v_mfma_f32_16x16x32_bf16 v[32:35], v[68:71], v[16:19], v[32:35]
  s_waitcnt lgkmcnt(0)
  s_andn2_b32 s74, s74, 15
  s_add_u32 s41, s41, 1
  s_or_b32 s74, s74, s41
  v_mov_b32 v182, s74
  v_mov_b32 v178, s62
  ds_write_b32 v181, v7
  s_mov_b64 exec, 1
  ds_write_b32 v177, v182
  ds_write_b32 v180, v178
  s_mov_b64 exec, -1
  v_add_u32 v177, 4, v177
  s_waitcnt vmcnt(4)
  buffer_load_dwordx4 v[104:107], v4, s[44:47], s52 offen nt
  s_xor_b32 s52, s52, 0x800
  v_mfma_f32_16x16x32_bf16 v[32:35], v[72:75], v[20:23], v[32:35]
  s_waitcnt vmcnt(4)
  buffer_load_dwordx4 v[108:111], v4, s[44:47], s52 offen nt
  s_lshl_b32 s52, s55, 6
  v_mfma_f32_16x16x32_bf16 v[32:35], v[76:79], v[24:27], v[32:35]
  v_mov_b32_dpp v44, v28 quad_perm:[0,1,2,3] row_mask:0xf bank_mask:0x1
  v_mov_b32_dpp v45, v29 row_ror:12 row_mask:0xf bank_mask:0x1
  v_mov_b32_dpp v46, v30 row_ror:8 row_mask:0xf bank_mask:0x1
  v_mov_b32_dpp v47, v31 row_ror:4 row_mask:0xf bank_mask:0x1
  s_waitcnt vmcnt(4)
  buffer_load_dwordx4 v[48:51], v4, s[44:47], s52 offen nt
  s_xor_b32 s52, s52, 0x800
  v_mfma_f32_16x16x32_bf16 v[36:39], v[80:83], v[12:15], 0
  s_waitcnt vmcnt(4)
  buffer_load_dwordx4 v[52:55], v4, s[44:47], s52 offen nt
  s_xor_b32 s52, s52, 0x1800
  v_mfma_f32_16x16x32_bf16 v[36:39], v[84:87], v[16:19], v[36:39]
  s_waitcnt vmcnt(4)
  buffer_load_dwordx4 v[56:59], v4, s[44:47], s52 offen nt
  s_xor_b32 s52, s52, 0x800
  v_mfma_f32_16x16x32_bf16 v[36:39], v[88:91], v[20:23], v[36:39]
  s_waitcnt vmcnt(4)
  buffer_load_dwordx4 v[60:63], v4, s[44:47], s52 offen nt
  s_xor_b32 s52, s52, 0x3800
  v_mfma_f32_16x16x32_bf16 v[36:39], v[92:95], v[24:27], v[36:39]
  v_mov_b32_dpp v44, v32 row_ror:4 row_mask:0xf bank_mask:0x2
  v_mov_b32_dpp v45, v33 quad_perm:[0,1,2,3] row_mask:0xf bank_mask:0x2
  v_mov_b32_dpp v46, v34 row_ror:12 row_mask:0xf bank_mask:0x2
  v_mov_b32_dpp v47, v35 row_ror:8 row_mask:0xf bank_mask:0x2
  ds_read_b64 v[178:179], v176 offset:48
  s_waitcnt vmcnt(4)
  buffer_load_dwordx4 v[64:67], v4, s[44:47], s52 offen nt
  s_xor_b32 s52, s52, 0x800
  v_mfma_f32_16x16x32_bf16 v[40:43], v[96:99], v[12:15], 0
  s_waitcnt vmcnt(4)
  buffer_load_dwordx4 v[68:71], v4, s[44:47], s52 offen nt
  s_xor_b32 s52, s52, 0x1800
  v_mfma_f32_16x16x32_bf16 v[40:43], v[100:103], v[16:19], v[40:43]
  s_waitcnt lgkmcnt(0)
  v_readfirstlane_b32 s40, v178
  v_readfirstlane_b32 s92, v179
  s_waitcnt vmcnt(4)
  buffer_load_dwordx4 v[72:75], v4, s[44:47], s52 offen nt
  s_xor_b32 s52, s52, 0x800
  v_mfma_f32_16x16x32_bf16 v[40:43], v[104:107], v[20:23], v[40:43]
  s_cmp_lg_u32 s40, 0
  s_cselect_b32 s63, s40, s63
  s_waitcnt vmcnt(4)
  buffer_load_dwordx4 v[76:79], v4, s[44:47], s52 offen nt
  s_xor_b32 s52, s52, 0x7800
  v_mfma_f32_16x16x32_bf16 v[40:43], v[108:111], v[24:27], v[40:43]
  v_mov_b32_dpp v44, v36 row_ror:8 row_mask:0xf bank_mask:0x4
  v_mov_b32_dpp v45, v37 row_ror:4 row_mask:0xf bank_mask:0x4
  v_mov_b32_dpp v46, v38 quad_perm:[0,1,2,3] row_mask:0xf bank_mask:0x4
  v_mov_b32_dpp v47, v39 row_ror:12 row_mask:0xf bank_mask:0x4
  s_cmp_lt_u32 s62, 15
  s_cbranch_scc1 L_kloop
  s_branch L_kdone
L_km6:
  s_memrealtime s[74:75]
  s_waitcnt vmcnt(4)
  buffer_load_dwordx4 v[80:83], v4, s[44:47], s52 offen nt
  s_xor_b32 s52, s52, 0x800
  v_mfma_f32_16x16x32_bf16 v[28:31], v[48:51], v[12:15], 0
  s_waitcnt vmcnt(4)
  buffer_load_dwordx4 v[84:87], v4, s[44:47], s52 offen nt
  s_xor_b32 s52, s52, 0x1800
  v_mfma_f32_16x16x32_bf16 v[28:31], v[52:55], v[16:19], v[28:31]
  s_waitcnt vmcnt(4)
  buffer_load_dwordx4 v[88:91], v4, s[44:47], s52 offen nt
  s_xor_b32 s52, s52, 0x800
  v_mfma_f32_16x16x32_bf16 v[28:31], v[56:59], v[20:23], v[28:31]
  s_waitcnt vmcnt(4)
  buffer_load_dwordx4 v[92:95], v4, s[44:47], s52 offen nt
  s_xor_b32 s52, s52, 0x3800
  v_mfma_f32_16x16x32_bf16 v[28:31], v[60:63], v[24:27], v[28:31]
  v_mov_b32_dpp v44, v40 row_ror:12 row_mask:0xf bank_mask:0x8
  v_mov_b32_dpp v45, v41 row_ror:8 row_mask:0xf bank_mask:0x8
  v_mov_b32_dpp v46, v42 row_ror:4 row_mask:0xf bank_mask:0x8
  v_mov_b32_dpp v47, v43 quad_perm:[0,1,2,3] row_mask:0xf bank_mask:0x8
  v_add_f32 v10, v44, v45
  v_add_f32 v11, v46, v47
  v_add_f32 v10, v10, v11
  v_cvt_pk_bf16_f32 v10, v10, v10
  v_and_b32 v10, 0xffff0000, v10
  v_mul_f32 v10, 0x3db504f3, v10
  v_cvt_pk_bf16_f32 v10, v10, v10
  v_and_b32 v10, 0xffff0000, v10
  v_max_f32 v7, v7, v10
  v_xad_u32 v10, v244, s54, v10
  ds_write_b32 v6, v10
  v_add_u32 v6, 1024, v6
  s_mov_b32 s54, s55
  s_cmp_lt_u32 s62, 8
  s_cselect_b64 s[58:59], s[56:57], s[60:61]
  s_waitcnt vmcnt(5)
  buffer_load_dwordx4 v[96:99], v4, s[44:47], s52 offen nt
  s_xor_b32 s52, s52, 0x800
  v_mfma_f32_16x16x32_bf16 v[32:35], v[64:67], v[12:15], 0
  s_lshl_b32 s55, s62, 3
  s_lshr_b64 s[58:59], s[58:59], s55
  s_and_b32 s58, s58, 0xff
  s_lshl_b32 s55, s58, 6
  s_waitcnt vmcnt(5)
  buffer_load_dwordx4 v[100:103], v4, s[44:47], s52 offen nt
  s_xor_b32 s52, s52, 0x1800
  v_mfma_f32_16x16x32_bf16 v[32:35], v[68:71], v[16:19], v[32:35]
  s_waitcnt lgkmcnt(0)
  s_andn2_b32 s74, s74, 15
  s_add_u32 s41, s41, 1
  s_or_b32 s74, s74, s41
  v_mov_b32 v182, s74
  v_mov_b32 v178, s62
  ds_write_b32 v181, v7
  s_mov_b64 exec, 1
  ds_write_b32 v177, v182
  ds_write_b32 v180, v178
  s_mov_b64 exec, -1
  v_add_u32 v177, 4, v177
  s_waitcnt vmcnt(5)
  buffer_load_dwordx4 v[104:107], v4, s[44:47], s52 offen nt
  s_xor_b32 s52, s52, 0x800
  v_mfma_f32_16x16x32_bf16 v[32:35], v[72:75], v[20:23], v[32:35]
  s_waitcnt vmcnt(5)
  buffer_load_dwordx4 v[108:111], v4, s[44:47], s52 offen nt
  s_lshl_b32 s52, s55, 6
  v_mfma_f32_16x16x32_bf16 v[32:35], v[76:79], v[24:27], v[32:35]
  v_mov_b32_dpp v44, v28 quad_perm:[0,1,2,3] row_mask:0xf bank_mask:0x1
  v_mov_b32_dpp v45, v29 row_ror:12 row_mask:0xf bank_mask:0x1
  v_mov_b32_dpp v46, v30 row_ror:8 row_mask:0xf bank_mask:0x1
  v_mov_b32_dpp v47, v31 row_ror:4 row_mask:0xf bank_mask:0x1
  s_waitcnt vmcnt(4)
  buffer_load_dwordx4 v[48:51], v4, s[44:47], s52 offen nt
  s_xor_b32 s52, s52, 0x800
  v_mfma_f32_16x16x32_bf16 v[36:39], v[80:83], v[12:15], 0
  s_waitcnt vmcnt(4)
  buffer_load_dwordx4 v[52:55], v4, s[44:47], s52 offen nt
  s_xor_b32 s52, s52, 0x1800
  v_mfma_f32_16x16x32_bf16 v[36:39], v[84:87], v[16:19], v[36:39]
  s_waitcnt vmcnt(4)
  buffer_load_dwordx4 v[56:59], v4, s[44:47], s52 offen nt
  s_xor_b32 s52, s52, 0x800
  v_mfma_f32_16x16x32_bf16 v[36:39], v[88:91], v[20:23], v[36:39]
  s_waitcnt vmcnt(4)
  buffer_load_dwordx4 v[60:63], v4, s[44:47], s52 offen nt
  s_xor_b32 s52, s52, 0x3800
  v_mfma_f32_16x16x32_bf16 v[36:39], v[92:95], v[24:27], v[36:39]
  v_mov_b32_dpp v44, v32 row_ror:4 row_mask:0xf bank_mask:0x2
  v_mov_b32_dpp v45, v33 quad_perm:[0,1,2,3] row_mask:0xf bank_mask:0x2
  v_mov_b32_dpp v46, v34 row_ror:12 row_mask:0xf bank_mask:0x2
  v_mov_b32_dpp v47, v35 row_ror:8 row_mask:0xf bank_mask:0x2
  ds_read_b64 v[178:179], v176 offset:48
  s_waitcnt vmcnt(5)
  buffer_load_dwordx4 v[64:67], v4, s[44:47], s52 offen nt
  s_xor_b32 s52, s52, 0x800
  v_mfma_f32_16x16x32_bf16 v[40:43], v[96:99], v[12:15], 0
  s_waitcnt vmcnt(5)
  buffer_load_dwordx4 v[68:71], v4, s[44:47], s52 offen nt
  s_xor_b32 s52, s52, 0x1800
  v_mfma_f32_16x16x32_bf16 v[40:43], v[100:103], v[16:19], v[40:43]
  s_waitcnt lgkmcnt(0)
  v_readfirstlane_b32 s40, v178
  v_readfirstlane_b32 s92, v179
  s_waitcnt vmcnt(5)
  buffer_load_dwordx4 v[72:75], v4, s[44:47], s52 offen nt
  s_xor_b32 s52, s52, 0x800
  v_mfma_f32_16x16x32_bf16 v[40:43], v[104:107], v[20:23], v[40:43]
  s_cmp_lg_u32 s40, 0
  s_cselect_b32 s63, s40, s63
  s_waitcnt vmcnt(5)
  buffer_load_dwordx4 v[76:79], v4, s[44:47], s52 offen nt
  s_xor_b32 s52, s52, 0x7800
  v_mfma_f32_16x16x32_bf16 v[40:43], v[108:111], v[24:27], v[40:43]
  v_mov_b32_dpp v44, v36 row_ror:8 row_mask:0xf bank_mask:0x4
  v_mov_b32_dpp v45, v37 row_ror:4 row_mask:0xf bank_mask:0x4
  v_mov_b32_dpp v46, v38 quad_perm:[0,1,2,3] row_mask:0xf bank_mask:0x4
  v_mov_b32_dpp v47, v39 row_ror:12 row_mask:0xf bank_mask:0x4
  s_cmp_lt_u32 s62, 15
  s_cbranch_scc1 L_kloop
  s_branch L_kdone
L_km7:
  s_memrealtime s[74:75]
  s_waitcnt vmcnt(5)
  buffer_load_dwordx4 v[80:83], v4, s[44:47], s52 offen nt
  s_xor_b32 s52, s52, 0x800
  v_mfma_f32_16x16x32_bf16 v[28:31], v[48:51], v[12:15], 0
  s_waitcnt vmcnt(5)
  buffer_load_dwordx4 v[84:87], v4, s[44:47], s52 offen nt
  s_xor_b32 s52, s52, 0x1800
  v_mfma_f32_16x16x32_bf16 v[28:31], v[52:55], v[16:19], v[28:31]
  s_waitcnt vmcnt(5)
  buffer_load_dwordx4 v[88:91], v4, s[44:47], s52 offen nt
  s_xor_b32 s52, s52, 0x800
  v_mfma_f32_16x16x32_bf16 v[28:31], v[56:59], v[20:23], v[28:31]
  s_waitcnt vmcnt(5)
  buffer_load_dwordx4 v[92:95], v4, s[44:47], s52 offen nt
  s_xor_b32 s52, s52, 0x3800
  v_mfma_f32_16x16x32_bf16 v[28:31], v[60:63], v[24:27], v[28:31]
  v_mov_b32_dpp v44, v40 row_ror:12 row_mask:0xf bank_mask:0x8
  v_mov_b32_dpp v45, v41 row_ror:8 row_mask:0xf bank_mask:0x8
  v_mov_b32_dpp v46, v42 row_ror:4 row_mask:0xf bank_mask:0x8
  v_mov_b32_dpp v47, v43 quad_perm:[0,1,2,3] row_mask:0xf bank_mask:0x8
  v_add_f32 v10, v44, v45
  v_add_f32 v11, v46, v47
  v_add_f32 v10, v10, v11
  v_cvt_pk_bf16_f32 v10, v10, v10
  v_and_b32 v10, 0xffff0000, v10
  v_mul_f32 v10, 0x3db504f3, v10
  v_cvt_pk_bf16_f32 v10, v10, v10
  v_and_b32 v10, 0xffff0000, v10
  v_max_f32 v7, v7, v10
  v_xad_u32 v10, v244, s54, v10
  ds_write_b32 v6, v10
  v_add_u32 v6, 1024, v6
  s_mov_b32 s54, s55
  s_cmp_lt_u32 s62, 8
  s_cselect_b64 s[58:59], s[56:57], s[60:61]
  s_waitcnt vmcnt(5)
  buffer_load_dwordx4 v[96:99], v4, s[44:47], s52 offen nt
  s_xor_b32 s52, s52, 0x800
  v_mfma_f32_16x16x32_bf16 v[32:35], v[64:67], v[12:15], 0
  s_lshl_b32 s55, s62, 3
  s_lshr_b64 s[58:59], s[58:59], s55
  s_and_b32 s58, s58, 0xff
  s_lshl_b32 s55, s58, 6
  s_waitcnt vmcnt(5)
  buffer_load_dwordx4 v[100:103], v4, s[44:47], s52 offen nt
  s_xor_b32 s52, s52, 0x1800
  v_mfma_f32_16x16x32_bf16 v[32:35], v[68:71], v[16:19], v[32:35]
  s_waitcnt lgkmcnt(0)
  s_andn2_b32 s74, s74, 15
  s_add_u32 s41, s41, 1
  s_or_b32 s74, s74, s41
  v_mov_b32 v182, s74
  v_mov_b32 v178, s62
  ds_write_b32 v181, v7
  s_mov_b64 exec, 1
  ds_write_b32 v177, v182
  ds_write_b32 v180, v178
  s_mov_b64 exec, -1
  v_add_u32 v177, 4, v177
  s_waitcnt vmcnt(5)
  buffer_load_dwordx4 v[104:107], v4, s[44:47], s52 offen nt
  s_xor_b32 s52, s52, 0x800
  v_mfma_f32_16x16x32_bf16 v[32:35], v[72:75], v[20:23], v[32:35]
  s_waitcnt vmcnt(5)
  buffer_load_dwordx4 v[108:111], v4, s[44:47], s52 offen nt
  s_lshl_b32 s52, s55, 6
  v_mfma_f32_16x16x32_bf16 v[32:35], v[76:79], v[24:27], v[32:35]
  v_mov_b32_dpp v44, v28 quad_perm:[0,1,2,3] row_mask:0xf bank_mask:0x1
  v_mov_b32_dpp v45, v29 row_ror:12 row_mask:0xf bank_mask:0x1
  v_mov_b32_dpp v46, v30 row_ror:8 row_mask:0xf bank_mask:0x1
  v_mov_b32_dpp v47, v31 row_ror:4 row_mask:0xf bank_mask:0x1
  s_waitcnt vmcnt(5)
  buffer_load_dwordx4 v[48:51], v4, s[44:47], s52 offen nt
  s_xor_b32 s52, s52, 0x800
  v_mfma_f32_16x16x32_bf16 v[36:39], v[80:83], v[12:15], 0
  s_waitcnt vmcnt(5)
  buffer_load_dwordx4 v[52:55], v4, s[44:47], s52 offen nt
  s_xor_b32 s52, s52, 0x1800
  v_mfma_f32_16x16x32_bf16 v[36:39], v[84:87], v[16:19], v[36:39]
  s_waitcnt vmcnt(5)
  buffer_load_dwordx4 v[56:59], v4, s[44:47], s52 offen nt
  s_xor_b32 s52, s52, 0x800
  v_mfma_f32_16x16x32_bf16 v[36:39], v[88:91], v[20:23], v[36:39]
  s_waitcnt vmcnt(5)
  buffer_load_dwordx4 v[60:63], v4, s[44:47], s52 offen nt
  s_xor_b32 s52, s52, 0x3800
  v_mfma_f32_16x16x32_bf16 v[36:39], v[92:95], v[24:27], v[36:39]
  v_mov_b32_dpp v44, v32 row_ror:4 row_mask:0xf bank_mask:0x2
  v_mov_b32_dpp v45, v33 quad_perm:[0,1,2,3] row_mask:0xf bank_mask:0x2
  v_mov_b32_dpp v46, v34 row_ror:12 row_mask:0xf bank_mask:0x2
  v_mov_b32_dpp v47, v35 row_ror:8 row_mask:0xf bank_mask:0x2
  ds_read_b64 v[178:179], v176 offset:48
  s_waitcnt vmcnt(5)
  buffer_load_dwordx4 v[64:67], v4, s[44:47], s52 offen nt
  s_xor_b32 s52, s52, 0x800
  v_mfma_f32_16x16x32_bf16 v[40:43], v[96:99], v[12:15], 0
  s_waitcnt vmcnt(5)
  buffer_load_dwordx4 v[68:71], v4, s[44:47], s52 offen nt
  s_xor_b32 s52, s52, 0x1800
  v_mfma_f32_16x16x32_bf16 v[40:43], v[100:103], v[16:19], v[40:43]
  s_waitcnt lgkmcnt(0)
  v_readfirstlane_b32 s40, v178
  v_readfirstlane_b32 s92, v179
  s_waitcnt vmcnt(5)
  buffer_load_dwordx4 v[72:75], v4, s[44:47], s52 offen nt
  s_xor_b32 s52, s52, 0x800
  v_mfma_f32_16x16x32_bf16 v[40:43], v[104:107], v[20:23], v[40:43]
  s_cmp_lg_u32 s40, 0
  s_cselect_b32 s63, s40, s63
  s_waitcnt vmcnt(5)
  buffer_load_dwordx4 v[76:79], v4, s[44:47], s52 offen nt
  s_xor_b32 s52, s52, 0x7800
  v_mfma_f32_16x16x32_bf16 v[40:43], v[108:111], v[24:27], v[40:43]
  v_mov_b32_dpp v44, v36 row_ror:8 row_mask:0xf bank_mask:0x4
  v_mov_b32_dpp v45, v37 row_ror:4 row_mask:0xf bank_mask:0x4
  v_mov_b32_dpp v46, v38 quad_perm:[0,1,2,3] row_mask:0xf bank_mask:0x4
  v_mov_b32_dpp v47, v39 row_ror:12 row_mask:0xf bank_mask:0x4
  s_cmp_lt_u32 s62, 15
  s_cbranch_scc1 L_kloop
  s_branch L_kdone
L_km8:
  s_memrealtime s[74:75]
  s_waitcnt vmcnt(6)
  buffer_load_dwordx4 v[80:83], v4, s[44:47], s52 offen nt
  s_xor_b32 s52, s52, 0x800
  v_mfma_f32_16x16x32_bf16 v[28:31], v[48:51], v[12:15], 0
  s_waitcnt vmcnt(6)
  buffer_load_dwordx4 v[84:87], v4, s[44:47], s52 offen nt
  s_xor_b32 s52, s52, 0x1800
  v_mfma_f32_16x16x32_bf16 v[28:31], v[52:55], v[16:19], v[28:31]
  s_waitcnt vmcnt(6)
  buffer_load_dwordx4 v[88:91], v4, s[44:47], s52 offen nt
  s_xor_b32 s52, s52, 0x800
  v_mfma_f32_16x16x32_bf16 v[28:31], v[56:59], v[20:23], v[28:31]
  s_waitcnt vmcnt(6)
  buffer_load_dwordx4 v[92:95], v4, s[44:47], s52 offen nt
  s_xor_b32 s52, s52, 0x3800
  v_mfma_f32_16x16x32_bf16 v[28:31], v[60:63], v[24:27], v[28:31]
  v_mov_b32_dpp v44, v40 row_ror:12 row_mask:0xf bank_mask:0x8
  v_mov_b32_dpp v45, v41 row_ror:8 row_mask:0xf bank_mask:0x8
  v_mov_b32_dpp v46, v42 row_ror:4 row_mask:0xf bank_mask:0x8
  v_mov_b32_dpp v47, v43 quad_perm:[0,1,2,3] row_mask:0xf bank_mask:0x8
  v_add_f32 v10, v44, v45
  v_add_f32 v11, v46, v47
  v_add_f32 v10, v10, v11
  v_cvt_pk_bf16_f32 v10, v10, v10
  v_and_b32 v10, 0xffff0000, v10
  v_mul_f32 v10, 0x3db504f3, v10
  v_cvt_pk_bf16_f32 v10, v10, v10
  v_and_b32 v10, 0xffff0000, v10
  v_max_f32 v7, v7, v10
  v_xad_u32 v10, v244, s54, v10
  ds_write_b32 v6, v10
  v_add_u32 v6, 1024, v6
  s_mov_b32 s54, s55
  s_cmp_lt_u32 s62, 8
  s_cselect_b64 s[58:59], s[56:57], s[60:61]
  s_waitcnt vmcnt(6)
  buffer_load_dwordx4 v[96:99], v4, s[44:47], s52 offen nt
  s_xor_b32 s52, s52, 0x800
  v_mfma_f32_16x16x32_bf16 v[32:35], v[64:67], v[12:15], 0
  s_lshl_b32 s55, s62, 3
  s_lshr_b64 s[58:59], s[58:59], s55
  s_and_b32 s58, s58, 0xff
  s_lshl_b32 s55, s58, 6
  s_waitcnt vmcnt(6)
  buffer_load_dwordx4 v[100:103], v4, s[44:47], s52 offen nt
  s_xor_b32 s52, s52, 0x1800
  v_mfma_f32_16x16x32_bf16 v[32:35], v[68:71], v[16:19], v[32:35]
  s_waitcnt lgkmcnt(0)
  s_andn2_b32 s74, s74, 15
  s_add_u32 s41, s41, 1
  s_or_b32 s74, s74, s41
  v_mov_b32 v182, s74
  v_mov_b32 v178, s62
  ds_write_b32 v181, v7
  s_mov_b64 exec, 1
  ds_write_b32 v177, v182
  ds_write_b32 v180, v178
  s_mov_b64 exec, -1
  v_add_u32 v177, 4, v177
  s_waitcnt vmcnt(6)
  buffer_load_dwordx4 v[104:107], v4, s[44:47], s52 offen nt
  s_xor_b32 s52, s52, 0x800
  v_mfma_f32_16x16x32_bf16 v[32:35], v[72:75], v[20:23], v[32:35]
  s_waitcnt vmcnt(6)
  buffer_load_dwordx4 v[108:111], v4, s[44:47], s52 offen nt
  s_lshl_b32 s52, s55, 6
  v_mfma_f32_16x16x32_bf16 v[32:35], v[76:79], v[24:27], v[32:35]
  v_mov_b32_dpp v44, v28 quad_perm:[0,1,2,3] row_mask:0xf bank_mask:0x1
  v_mov_b32_dpp v45, v29 row_ror:12 row_mask:0xf bank_mask:0x1
  v_mov_b32_dpp v46, v30 row_ror:8 row_mask:0xf bank_mask:0x1
  v_mov_b32_dpp v47, v31 row_ror:4 row_mask:0xf bank_mask:0x1
  s_waitcnt vmcnt(6)
  buffer_load_dwordx4 v[48:51], v4, s[44:47], s52 offen nt
  s_xor_b32 s52, s52, 0x800
  v_mfma_f32_16x16x32_bf16 v[36:39], v[80:83], v[12:15], 0
  s_waitcnt vmcnt(6)
  buffer_load_dwordx4 v[52:55], v4, s[44:47], s52 offen nt
  s_xor_b32 s52, s52, 0x1800
  v_mfma_f32_16x16x32_bf16 v[36:39], v[84:87], v[16:19], v[36:39]
  s_waitcnt vmcnt(6)
  buffer_load_dwordx4 v[56:59], v4, s[44:47], s52 offen nt
  s_xor_b32 s52, s52, 0x800
  v_mfma_f32_16x16x32_bf16 v[36:39], v[88:91], v[20:23], v[36:39]
  s_waitcnt vmcnt(6)
  buffer_load_dwordx4 v[60:63], v4, s[44:47], s52 offen nt
  s_xor_b32 s52, s52, 0x3800
  v_mfma_f32_16x16x32_bf16 v[36:39], v[92:95], v[24:27], v[36:39]
  v_mov_b32_dpp v44, v32 row_ror:4 row_mask:0xf bank_mask:0x2
  v_mov_b32_dpp v45, v33 quad_perm:[0,1,2,3] row_mask:0xf bank_mask:0x2
  v_mov_b32_dpp v46, v34 row_ror:12 row_mask:0xf bank_mask:0x2
  v_mov_b32_dpp v47, v35 row_ror:8 row_mask:0xf bank_mask:0x2
  ds_read_b64 v[178:179], v176 offset:48
  s_waitcnt vmcnt(6)
  buffer_load_dwordx4 v[64:67], v4, s[44:47], s52 offen nt
  s_xor_b32 s52, s52, 0x800
  v_mfma_f32_16x16x32_bf16 v[40:43], v[96:99], v[12:15], 0
  s_waitcnt vmcnt(6)
  buffer_load_dwordx4 v[68:71], v4, s[44:47], s52 offen nt
  s_xor_b32 s52, s52, 0x1800
  v_mfma_f32_16x16x32_bf16 v[40:43], v[100:103], v[16:19], v[40:43]
  s_waitcnt lgkmcnt(0)
  v_readfirstlane_b32 s40, v178
  v_readfirstlane_b32 s92, v179
  s_waitcnt vmcnt(6)
  buffer_load_dwordx4 v[72:75], v4, s[44:47], s52 offen nt
  s_xor_b32 s52, s52, 0x800
  v_mfma_f32_16x16x32_bf16 v[40:43], v[104:107], v[20:23], v[40:43]
  s_cmp_lg_u32 s40, 0
  s_cselect_b32 s63, s40, s63
  s_waitcnt vmcnt(6)
  buffer_load_dwordx4 v[76:79], v4, s[44:47], s52 offen nt
  s_xor_b32 s52, s52, 0x7800
  v_mfma_f32_16x16x32_bf16 v[40:43], v[108:111], v[24:27], v[40:43]
  v_mov_b32_dpp v44, v36 row_ror:8 row_mask:0xf bank_mask:0x4
  v_mov_b32_dpp v45, v37 row_ror:4 row_mask:0xf bank_mask:0x4
  v_mov_b32_dpp v46, v38 quad_perm:[0,1,2,3] row_mask:0xf bank_mask:0x4
  v_mov_b32_dpp v47, v39 row_ror:12 row_mask:0xf bank_mask:0x4
  s_cmp_lt_u32 s62, 15
  s_cbranch_scc1 L_kloop
  s_branch L_kdone
L_km9:
  s_memrealtime s[74:75]
  s_waitcnt vmcnt(7)
  buffer_load_dwordx4 v[80:83], v4, s[44:47], s52 offen nt
  s_xor_b32 s52, s52, 0x800
  v_mfma_f32_16x16x32_bf16 v[28:31], v[48:51], v[12:15], 0
  s_waitcnt vmcnt(7)
  buffer_load_dwordx4 v[84:87], v4, s[44:47], s52 offen nt
  s_xor_b32 s52, s52, 0x1800
  v_mfma_f32_16x16x32_bf16 v[28:31], v[52:55], v[16:19], v[28:31]
  s_waitcnt vmcnt(7)
  buffer_load_dwordx4 v[88:91], v4, s[44:47], s52 offen nt
  s_xor_b32 s52, s52, 0x800
  v_mfma_f32_16x16x32_bf16 v[28:31], v[56:59], v[20:23], v[28:31]
  s_waitcnt vmcnt(7)
  buffer_load_dwordx4 v[92:95], v4, s[44:47], s52 offen nt
  s_xor_b32 s52, s52, 0x3800
  v_mfma_f32_16x16x32_bf16 v[28:31], v[60:63], v[24:27], v[28:31]
  v_mov_b32_dpp v44, v40 row_ror:12 row_mask:0xf bank_mask:0x8
  v_mov_b32_dpp v45, v41 row_ror:8 row_mask:0xf bank_mask:0x8
  v_mov_b32_dpp v46, v42 row_ror:4 row_mask:0xf bank_mask:0x8
  v_mov_b32_dpp v47, v43 quad_perm:[0,1,2,3] row_mask:0xf bank_mask:0x8
  v_add_f32 v10, v44, v45
  v_add_f32 v11, v46, v47
  v_add_f32 v10, v10, v11
  v_cvt_pk_bf16_f32 v10, v10, v10
  v_and_b32 v10, 0xffff0000, v10
  v_mul_f32 v10, 0x3db504f3, v10
  v_cvt_pk_bf16_f32 v10, v10, v10
  v_and_b32 v10, 0xffff0000, v10
  v_max_f32 v7, v7, v10
  v_xad_u32 v10, v244, s54, v10
  ds_write_b32 v6, v10
  v_add_u32 v6, 1024, v6
  s_mov_b32 s54, s55
  s_cmp_lt_u32 s62, 8
  s_cselect_b64 s[58:59], s[56:57], s[60:61]
  s_waitcnt vmcnt(7)
  buffer_load_dwordx4 v[96:99], v4, s[44:47], s52 offen nt
  s_xor_b32 s52, s52, 0x800
  v_mfma_f32_16x16x32_bf16 v[32:35], v[64:67], v[12:15], 0
  s_lshl_b32 s55, s62, 3
  s_lshr_b64 s[58:59], s[58:59], s55
  s_and_b32 s58, s58, 0xff
  s_lshl_b32 s55, s58, 6
  s_waitcnt vmcnt(7)
  buffer_load_dwordx4 v[100:103], v4, s[44:47], s52 offen nt
  s_xor_b32 s52, s52, 0x1800
  v_mfma_f32_16x16x32_bf16 v[32:35], v[68:71], v[16:19], v[32:35]
  s_waitcnt lgkmcnt(0)
  s_andn2_b32 s74, s74, 15
  s_add_u32 s41, s41, 1
  s_or_b32 s74, s74, s41
  v_mov_b32 v182, s74
  v_mov_b32 v178, s62
  ds_write_b32 v181, v7
  s_mov_b64 exec, 1
  ds_write_b32 v177, v182
  ds_write_b32 v180, v178
  s_mov_b64 exec, -1
  v_add_u32 v177, 4, v177
  s_waitcnt vmcnt(7)
  buffer_load_dwordx4 v[104:107], v4, s[44:47], s52 offen nt
  s_xor_b32 s52, s52, 0x800
  v_mfma_f32_16x16x32_bf16 v[32:35], v[72:75], v[20:23], v[32:35]
  s_waitcnt vmcnt(7)
  buffer_load_dwordx4 v[108:111], v4, s[44:47], s52 offen nt
  s_lshl_b32 s52, s55, 6
  v_mfma_f32_16x16x32_bf16 v[32:35], v[76:79], v[24:27], v[32:35]
  v_mov_b32_dpp v44, v28 quad_perm:[0,1,2,3] row_mask:0xf bank_mask:0x1
  v_mov_b32_dpp v45, v29 row_ror:12 row_mask:0xf bank_mask:0x1
  v_mov_b32_dpp v46, v30 row_ror:8 row_mask:0xf bank_mask:0x1
  v_mov_b32_dpp v47, v31 row_ror:4 row_mask:0xf bank_mask:0x1
  s_waitcnt vmcnt(7)
  buffer_load_dwordx4 v[48:51], v4, s[44:47], s52 offen nt
  s_xor_b32 s52, s52, 0x800
  v_mfma_f32_16x16x32_bf16 v[36:39], v[80:83], v[12:15], 0
  s_waitcnt vmcnt(7)
  buffer_load_dwordx4 v[52:55], v4, s[44:47], s52 offen nt
  s_xor_b32 s52, s52, 0x1800
  v_mfma_f32_16x16x32_bf16 v[36:39], v[84:87], v[16:19], v[36:39]
  s_waitcnt vmcnt(7)
  buffer_load_dwordx4 v[56:59], v4, s[44:47], s52 offen nt
  s_xor_b32 s52, s52, 0x800
  v_mfma_f32_16x16x32_bf16 v[36:39], v[88:91], v[20:23], v[36:39]
  s_waitcnt vmcnt(7)
  buffer_load_dwordx4 v[60:63], v4, s[44:47], s52 offen nt
  s_xor_b32 s52, s52, 0x3800
  v_mfma_f32_16x16x32_bf16 v[36:39], v[92:95], v[24:27], v[36:39]
  v_mov_b32_dpp v44, v32 row_ror:4 row_mask:0xf bank_mask:0x2
  v_mov_b32_dpp v45, v33 quad_perm:[0,1,2,3] row_mask:0xf bank_mask:0x2
  v_mov_b32_dpp v46, v34 row_ror:12 row_mask:0xf bank_mask:0x2
  v_mov_b32_dpp v47, v35 row_ror:8 row_mask:0xf bank_mask:0x2
  ds_read_b64 v[178:179], v176 offset:48
  s_waitcnt vmcnt(7)
  buffer_load_dwordx4 v[64:67], v4, s[44:47], s52 offen nt
  s_xor_b32 s52, s52, 0x800
  v_mfma_f32_16x16x32_bf16 v[40:43], v[96:99], v[12:15], 0
  s_waitcnt vmcnt(7)
  buffer_load_dwordx4 v[68:71], v4, s[44:47], s52 offen nt
  s_xor_b32 s52, s52, 0x1800
  v_mfma_f32_16x16x32_bf16 v[40:43], v[100:103], v[16:19], v[40:43]
  s_waitcnt lgkmcnt(0)
  v_readfirstlane_b32 s40, v178
  v_readfirstlane_b32 s92, v179
  s_waitcnt vmcnt(7)
  buffer_load_dwordx4 v[72:75], v4, s[44:47], s52 offen nt
  s_xor_b32 s52, s52, 0x800
  v_mfma_f32_16x16x32_bf16 v[40:43], v[104:107], v[20:23], v[40:43]
  s_cmp_lg_u32 s40, 0
  s_cselect_b32 s63, s40, s63
  s_waitcnt vmcnt(7)
  buffer_load_dwordx4 v[76:79], v4, s[44:47], s52 offen nt
  s_xor_b32 s52, s52, 0x7800
  v_mfma_f32_16x16x32_bf16 v[40:43], v[108:111], v[24:27], v[40:43]
  v_mov_b32_dpp v44, v36 row_ror:8 row_mask:0xf bank_mask:0x4
  v_mov_b32_dpp v45, v37 row_ror:4 row_mask:0xf bank_mask:0x4
  v_mov_b32_dpp v46, v38 quad_perm:[0,1,2,3] row_mask:0xf bank_mask:0x4
  v_mov_b32_dpp v47, v39 row_ror:12 row_mask:0xf bank_mask:0x4
  s_cmp_lt_u32 s62, 15
  s_cbranch_scc1 L_kloop
L_kdone:
L_tloop:
  s_and_b32 s40, s63, 0xff
  s_cmp_lt_u32 s62, s40
  s_cselect_b32 s40, 8, 12
  s_lshr_b32 s41, s63, s40
  s_and_b32 s41, s41, 15
  s_add_u32 s62, s62, 1
  s_cmp_lt_u32 s41, 5
  s_cbranch_scc0 L_mt10
  s_cmp_lt_u32 s41, 2
  s_cbranch_scc0 L_mt11
  s_cmp_lt_u32 s41, 1
  s_cbranch_scc1 L_tm0
  s_branch L_tm1
L_mt11:
  s_cmp_lt_u32 s41, 3
  s_cbranch_scc1 L_tm2
  s_cmp_lt_u32 s41, 4
  s_cbranch_scc1 L_tm3
  s_branch L_tm4
L_mt10:
  s_cmp_lt_u32 s41, 7
  s_cbranch_scc0 L_mt15
  s_cmp_lt_u32 s41, 6
  s_cbranch_scc1 L_tm5
  s_branch L_tm6
L_mt15:
  s_cmp_lt_u32 s41, 8
  s_cbranch_scc1 L_tm7
  s_cmp_lt_u32 s41, 9
  s_cbranch_scc1 L_tm8
  s_branch L_tm9
L_tm0:
  s_memrealtime s[74:75]
  s_waitcnt vmcnt(1)
  buffer_load_dwordx4 v[80:83], v4, s[44:47], s52 offen nt
  s_xor_b32 s52, s52, 0x800
  v_mfma_f32_16x16x32_bf16 v[28:31], v[48:51], v[12:15], 0
  s_waitcnt vmcnt(1)
  buffer_load_dwordx4 v[84:87], v4, s[44:47], s52 offen nt
  s_xor_b32 s52, s52, 0x1800
  v_mfma_f32_16x16x32_bf16 v[28:31], v[52:55], v[16:19], v[28:31]
  s_waitcnt vmcnt(1)
  buffer_load_dwordx4 v[88:91], v4, s[44:47], s52 offen nt
  s_xor_b32 s52, s52, 0x800
  v_mfma_f32_16x16x32_bf16 v[28:31], v[56:59], v[20:23], v[28:31]
  s_waitcnt vmcnt(1)
  buffer_load_dwordx4 v[92:95], v4, s[44:47], s52 offen nt
  s_xor_b32 s52, s52, 0x3800
  v_mfma_f32_16x16x32_bf16 v[28:31], v[60:63], v[24:27], v[28:31]
  v_mov_b32_dpp v44, v40 row_ror:12 row_mask:0xf bank_mask:0x8
  v_mov_b32_dpp v45, v41 row_ror:8 row_mask:0xf bank_mask:0x8
  v_mov_b32_dpp v46, v42 row_ror:4 row_mask:0xf bank_mask:0x8
  v_mov_b32_dpp v47, v43 quad_perm:[0,1,2,3] row_mask:0xf bank_mask:0x8
  v_add_f32 v10, v44, v45
  v_add_f32 v11, v46, v47
  v_add_f32 v10, v10, v11
  v_cvt_pk_bf16_f32 v10, v10, v10
  v_and_b32 v10, 0xffff0000, v10
  v_mul_f32 v10, 0x3db504f3, v10
  v_cvt_pk_bf16_f32 v10, v10, v10
  v_and_b32 v10, 0xffff0000, v10
  v_max_f32 v7, v7, v10
  v_xad_u32 v10, v244, s54, v10
  ds_write_b32 v6, v10
  v_add_u32 v6, 1024, v6
  s_mov_b32 s54, s55
  s_cmp_lt_u32 s62, 8
  s_cselect_b64 s[58:59], s[56:57], s[60:61]
  s_waitcnt vmcnt(2)
  buffer_load_dwordx4 v[96:99], v4, s[44:47], s52 offen nt
  s_xor_b32 s52, s52, 0x800
  v_mfma_f32_16x16x32_bf16 v[32:35], v[64:67], v[12:15], 0
  s_lshl_b32 s55, s62, 3
  s_lshr_b64 s[58:59], s[58:59], s55
  s_and_b32 s58, s58, 0xff
  s_lshl_b32 s55, s58, 6
  s_mov_b32 s71, 0x200000
L_ls20:
  s_cmp_gt_u32 s92, 16
  s_cbranch_scc1 L_l0ok19
  ds_read_b32 v178, v176 offset:52
  s_sub_u32 s71, s71, 1
  s_cbranch_scc1 L_l0ok19
  s_waitcnt lgkmcnt(0)
  v_readfirstlane_b32 s92, v178
  s_branch L_ls20
L_l0ok19:
  ds_read_b32 v254, v185
  s_waitcnt vmcnt(2)
  buffer_load_dwordx4 v[100:103], v4, s[44:47], s52 offen nt
  s_xor_b32 s52, s52, 0x1800
  v_mfma_f32_16x16x32_bf16 v[32:35], v[68:71], v[16:19], v[32:35]
  s_waitcnt lgkmcnt(0)
  s_andn2_b32 s74, s74, 15
  s_add_u32 s41, s41, 1
  s_or_b32 s74, s74, s41
  v_mov_b32 v182, s74
  v_mov_b32 v178, s62
  ds_write_b32 v181, v7
  s_mov_b64 exec, 1
  ds_write_b32 v177, v182
  ds_write_b32 v180, v178
  s_mov_b64 exec, -1
  v_add_u32 v177, 4, v177
  s_waitcnt vmcnt(2)
  buffer_load_dwordx4 v[104:107], v4, s[44:47], s52 offen nt
  s_xor_b32 s52, s52, 0x800
  v_mfma_f32_16x16x32_bf16 v[32:35], v[72:75], v[20:23], v[32:35]
  s_waitcnt vmcnt(2)
  buffer_load_dwordx4 v[108:111], v4, s[44:47], s52 offen nt
  s_lshl_b32 s52, s55, 6
  s_waitcnt lgkmcnt(0)
  v_and_b32 v9, 0xffff, v254
  v_lshlrev_b32 v9, 6, v9
  v_mfma_f32_16x16x32_bf16 v[32:35], v[76:79], v[24:27], v[32:35]
  v_mov_b32_dpp v44, v28 quad_perm:[0,1,2,3] row_mask:0xf bank_mask:0x1
  v_mov_b32_dpp v45, v29 row_ror:12 row_mask:0xf bank_mask:0x1
  v_mov_b32_dpp v46, v30 row_ror:8 row_mask:0xf bank_mask:0x1
  v_mov_b32_dpp v47, v31 row_ror:4 row_mask:0xf bank_mask:0x1
  v_add_u32_dpp v183, v9, v5 row_newbcast:0 row_mask:0xf bank_mask:0xf
  s_waitcnt vmcnt(1)
  buffer_load_dwordx4 v[48:51], v183, s[48:51], 0 offen nt
  v_mfma_f32_16x16x32_bf16 v[36:39], v[80:83], v[12:15], 0
  v_add_u32_dpp v184, v9, v5 row_newbcast:1 row_mask:0xf bank_mask:0xf
  s_waitcnt vmcnt(1)
  buffer_load_dwordx4 v[52:55], v184, s[48:51], 0 offen nt
  v_mfma_f32_16x16x32_bf16 v[36:39], v[84:87], v[16:19], v[36:39]
  v_add_u32_dpp v183, v9, v5 row_newbcast:2 row_mask:0xf bank_mask:0xf
  s_waitcnt vmcnt(1)
  buffer_load_dwordx4 v[56:59], v183, s[48:51], 0 offen nt
  v_mfma_f32_16x16x32_bf16 v[36:39], v[88:91], v[20:23], v[36:39]
  v_add_u32_dpp v184, v9, v5 row_newbcast:3 row_mask:0xf bank_mask:0xf
  s_waitcnt vmcnt(1)
  buffer_load_dwordx4 v[60:63], v184, s[48:51], 0 offen nt
  v_mfma_f32_16x16x32_bf16 v[36:39], v[92:95], v[24:27], v[36:39]
  v_mov_b32_dpp v44, v32 row_ror:4 row_mask:0xf bank_mask:0x2
  v_mov_b32_dpp v45, v33 quad_perm:[0,1,2,3] row_mask:0xf bank_mask:0x2
  v_mov_b32_dpp v46, v34 row_ror:12 row_mask:0xf bank_mask:0x2
  v_mov_b32_dpp v47, v35 row_ror:8 row_mask:0xf bank_mask:0x2
  ds_read_b64 v[178:179], v176 offset:48
  v_add_u32_dpp v183, v9, v5 row_newbcast:4 row_mask:0xf bank_mask:0xf
  s_waitcnt vmcnt(2)
  buffer_load_dwordx4 v[64:67], v183, s[48:51], 0 offen nt
  v_mfma_f32_16x16x32_bf16 v[40:43], v[96:99], v[12:15], 0
  v_add_u32_dpp v184, v9, v5 row_newbcast:5 row_mask:0xf bank_mask:0xf
  s_waitcnt vmcnt(2)
  buffer_load_dwordx4 v[68:71], v184, s[48:51], 0 offen nt
  v_mfma_f32_16x16x32_bf16 v[40:43], v[100:103], v[16:19], v[40:43]
  s_waitcnt lgkmcnt(0)
  v_readfirstlane_b32 s40, v178
  v_readfirstlane_b32 s92, v179
  v_add_u32_dpp v183, v9, v5 row_newbcast:6 row_mask:0xf bank_mask:0xf
  s_waitcnt vmcnt(2)
  buffer_load_dwordx4 v[72:75], v183, s[48:51], 0 offen nt
  v_mfma_f32_16x16x32_bf16 v[40:43], v[104:107], v[20:23], v[40:43]
  s_cmp_lg_u32 s40, 0
  s_cselect_b32 s63, s40, s63
  v_add_u32_dpp v184, v9, v5 row_newbcast:7 row_mask:0xf bank_mask:0xf
  s_waitcnt vmcnt(2)
  buffer_load_dwordx4 v[76:79], v184, s[48:51], 0 offen nt
  v_mfma_f32_16x16x32_bf16 v[40:43], v[108:111], v[24:27], v[40:43]
  v_mov_b32_dpp v44, v36 row_ror:8 row_mask:0xf bank_mask:0x4
  v_mov_b32_dpp v45, v37 row_ror:4 row_mask:0xf bank_mask:0x4
  v_mov_b32_dpp v46, v38 quad_perm:[0,1,2,3] row_mask:0xf bank_mask:0x4
  v_mov_b32_dpp v47, v39 row_ror:12 row_mask:0xf bank_mask:0x4
  v_mov_b32 v28, 0
  v_mov_b32 v29, 0
  v_mov_b32 v30, 0
  v_mov_b32 v31, 0
  v_add_u32_dpp v183, v9, v5 row_newbcast:8 row_mask:0xf bank_mask:0xf
  s_waitcnt vmcnt(1)
  buffer_load_dwordx4 v[80:83], v183, s[48:51], 0 offen nt
  s_nop 1
  v_mov_b32_dpp v44, v40 row_ror:12 row_mask:0xf bank_mask:0x8
  v_mov_b32_dpp v45, v41 row_ror:8 row_mask:0xf bank_mask:0x8
  v_mov_b32_dpp v46, v42 row_ror:4 row_mask:0xf bank_mask:0x8
  v_mov_b32_dpp v47, v43 quad_perm:[0,1,2,3] row_mask:0xf bank_mask:0x8
  v_add_f32 v10, v44, v45
  v_add_f32 v11, v46, v47
  v_add_f32 v10, v10, v11
  v_cvt_pk_bf16_f32 v10, v10, v10
  v_and_b32 v10, 0xffff0000, v10
  v_mul_f32 v10, 0x3db504f3, v10
  v_cvt_pk_bf16_f32 v10, v10, v10
  v_and_b32 v10, 0xffff0000, v10
  v_max_f32 v7, v7, v10
  v_xad_u32 v10, v244, s54, v10
  ds_write_b32 v6, v10
  v_add_u32 v6, 1024, v6
  v_mov_b32 v178, 17
  ds_write_b32 v181, v7
  s_mov_b64 exec, 1
  ds_write_b32 v180, v178
  s_mov_b64 exec, -1
  v_add_u32_dpp v184, v9, v5 row_newbcast:9 row_mask:0xf bank_mask:0xf
  s_waitcnt vmcnt(1)
  buffer_load_dwordx4 v[84:87], v184, s[48:51], 0 offen nt
  v_add_u32_dpp v183, v9, v5 row_newbcast:10 row_mask:0xf bank_mask:0xf
  s_waitcnt vmcnt(1)
  buffer_load_dwordx4 v[88:91], v183, s[48:51], 0 offen nt
  v_add_u32_dpp v184, v9, v5 row_newbcast:11 row_mask:0xf bank_mask:0xf
  s_waitcnt vmcnt(1)
  buffer_load_dwordx4 v[92:95], v184, s[48:51], 0 offen nt
  s_branch L_tdone
L_tm1:
  s_memrealtime s[74:75]
  s_waitcnt vmcnt(2)
  buffer_load_dwordx4 v[80:83], v4, s[44:47], s52 offen nt
  s_xor_b32 s52, s52, 0x800
  v_mfma_f32_16x16x32_bf16 v[28:31], v[48:51], v[12:15], 0
  s_waitcnt vmcnt(2)
  buffer_load_dwordx4 v[84:87], v4, s[44:47], s52 offen nt
  s_xor_b32 s52, s52, 0x1800
  v_mfma_f32_16x16x32_bf16 v[28:31], v[52:55], v[16:19], v[28:31]
  s_waitcnt vmcnt(2)
  buffer_load_dwordx4 v[88:91], v4, s[44:47], s52 offen nt
  s_xor_b32 s52, s52, 0x800
  v_mfma_f32_16x16x32_bf16 v[28:31], v[56:59], v[20:23], v[28:31]
  s_waitcnt vmcnt(2)
  buffer_load_dwordx4 v[92:95], v4, s[44:47], s52 offen nt
  s_xor_b32 s52, s52, 0x3800
  v_mfma_f32_16x16x32_bf16 v[28:31], v[60:63], v[24:27], v[28:31]
  v_mov_b32_dpp v44, v40 row_ror:12 row_mask:0xf bank_mask:0x8
  v_mov_b32_dpp v45, v41 row_ror:8 row_mask:0xf bank_mask:0x8
  v_mov_b32_dpp v46, v42 row_ror:4 row_mask:0xf bank_mask:0x8
  v_mov_b32_dpp v47, v43 quad_perm:[0,1,2,3] row_mask:0xf bank_mask:0x8
  v_add_f32 v10, v44, v45
  v_add_f32 v11, v46, v47
  v_add_f32 v10, v10, v11
  v_cvt_pk_bf16_f32 v10, v10, v10
  v_and_b32 v10, 0xffff0000, v10
  v_mul_f32 v10, 0x3db504f3, v10
  v_cvt_pk_bf16_f32 v10, v10, v10
  v_and_b32 v10, 0xffff0000, v10
  v_max_f32 v7, v7, v10
  v_xad_u32 v10, v244, s54, v10
  ds_write_b32 v6, v10
  v_add_u32 v6, 1024, v6
  s_mov_b32 s54, s55
  s_cmp_lt_u32 s62, 8
  s_cselect_b64 s[58:59], s[56:57], s[60:61]
  s_waitcnt vmcnt(2)
  buffer_load_dwordx4 v[96:99], v4, s[44:47], s52 offen nt
  s_xor_b32 s52, s52, 0x800
  v_mfma_f32_16x16x32_bf16 v[32:35], v[64:67], v[12:15], 0
  s_lshl_b32 s55, s62, 3
  s_lshr_b64 s[58:59], s[58:59], s55
  s_and_b32 s58, s58, 0xff
  s_lshl_b32 s55, s58, 6
  s_mov_b32 s71, 0x200000
L_ls22:
  s_cmp_gt_u32 s92, 16
  s_cbranch_scc1 L_l0ok21
  ds_read_b32 v178, v176 offset:52
  s_sub_u32 s71, s71, 1
  s_cbranch_scc1 L_l0ok21
  s_waitcnt lgkmcnt(0)
  v_readfirstlane_b32 s92, v178
  s_branch L_ls22
L_l0ok21:
  ds_read_b32 v254, v185
  s_waitcnt vmcnt(2)
  buffer_load_dwordx4 v[100:103], v4, s[44:47], s52 offen nt
  s_xor_b32 s52, s52, 0x1800
  v_mfma_f32_16x16x32_bf16 v[32:35], v[68:71], v[16:19], v[32:35]
  s_waitcnt lgkmcnt(0)
  s_andn2_b32 s74, s74, 15
  s_add_u32 s41, s41, 1
  s_or_b32 s74, s74, s41
  v_mov_b32 v182, s74
  v_mov_b32 v178, s62
  ds_write_b32 v181, v7
  s_mov_b64 exec, 1
  ds_write_b32 v177, v182
  ds_write_b32 v180, v178
  s_mov_b64 exec, -1
  v_add_u32 v177, 4, v177
  s_waitcnt vmcnt(2)
  buffer_load_dwordx4 v[104:107], v4, s[44:47], s52 offen nt
  s_xor_b32 s52, s52, 0x800
  v_mfma_f32_16x16x32_bf16 v[32:35], v[72:75], v[20:23], v[32:35]
  s_waitcnt vmcnt(2)
  buffer_load_dwordx4 v[108:111], v4, s[44:47], s52 offen nt
  s_lshl_b32 s52, s55, 6
  s_waitcnt lgkmcnt(0)
  v_and_b32 v9, 0xffff, v254
  v_lshlrev_b32 v9, 6, v9
  v_mfma_f32_16x16x32_bf16 v[32:35], v[76:79], v[24:27], v[32:35]
  v_mov_b32_dpp v44, v28 quad_perm:[0,1,2,3] row_mask:0xf bank_mask:0x1
  v_mov_b32_dpp v45, v29 row_ror:12 row_mask:0xf bank_mask:0x1
  v_mov_b32_dpp v46, v30 row_ror:8 row_mask:0xf bank_mask:0x1
  v_mov_b32_dpp v47, v31 row_ror:4 row_mask:0xf bank_mask:0x1
  v_add_u32_dpp v183, v9, v5 row_newbcast:0 row_mask:0xf bank_mask:0xf
  s_waitcnt vmcnt(2)
  buffer_load_dwordx4 v[48:51], v183, s[48:51], 0 offen nt
  v_mfma_f32_16x16x32_bf16 v[36:39], v[80:83], v[12:15], 0
  v_add_u32_dpp v184, v9, v5 row_newbcast:1 row_mask:0xf bank_mask:0xf
  s_waitcnt vmcnt(2)
  buffer_load_dwordx4 v[52:55], v184, s[48:51], 0 offen nt
  v_mfma_f32_16x16x32_bf16 v[36:39], v[84:87], v[16:19], v[36:39]
  v_add_u32_dpp v183, v9, v5 row_newbcast:2 row_mask:0xf bank_mask:0xf
  s_waitcnt vmcnt(2)
  buffer_load_dwordx4 v[56:59], v183, s[48:51], 0 offen nt
  v_mfma_f32_16x16x32_bf16 v[36:39], v[88:91], v[20:23], v[36:39]
  v_add_u32_dpp v184, v9, v5 row_newbcast:3 row_mask:0xf bank_mask:0xf
  s_waitcnt vmcnt(2)
  buffer_load_dwordx4 v[60:63], v184, s[48:51], 0 offen nt
  v_mfma_f32_16x16x32_bf16 v[36:39], v[92:95], v[24:27], v[36:39]
  v_mov_b32_dpp v44, v32 row_ror:4 row_mask:0xf bank_mask:0x2
  v_mov_b32_dpp v45, v33 quad_perm:[0,1,2,3] row_mask:0xf bank_mask:0x2
  v_mov_b32_dpp v46, v34 row_ror:12 row_mask:0xf bank_mask:0x2
  v_mov_b32_dpp v47, v35 row_ror:8 row_mask:0xf bank_mask:0x2
  ds_read_b64 v[178:179], v176 offset:48
  v_add_u32_dpp v183, v9, v5 row_newbcast:4 row_mask:0xf bank_mask:0xf
  s_waitcnt vmcnt(2)
  buffer_load_dwordx4 v[64:67], v183, s[48:51], 0 offen nt
  v_mfma_f32_16x16x32_bf16 v[40:43], v[96:99], v[12:15], 0
  v_add_u32_dpp v184, v9, v5 row_newbcast:5 row_mask:0xf bank_mask:0xf
  s_waitcnt vmcnt(2)
  buffer_load_dwordx4 v[68:71], v184, s[48:51], 0 offen nt
  v_mfma_f32_16x16x32_bf16 v[40:43], v[100:103], v[16:19], v[40:43]
  s_waitcnt lgkmcnt(0)
  v_readfirstlane_b32 s40, v178
  v_readfirstlane_b32 s92, v179
  v_add_u32_dpp v183, v9, v5 row_newbcast:6 row_mask:0xf bank_mask:0xf
  s_waitcnt vmcnt(2)
  buffer_load_dwordx4 v[72:75], v183, s[48:51], 0 offen nt
  v_mfma_f32_16x16x32_bf16 v[40:43], v[104:107], v[20:23], v[40:43]
  s_cmp_lg_u32 s40, 0
  s_cselect_b32 s63, s40, s63
  v_add_u32_dpp v184, v9, v5 row_newbcast:7 row_mask:0xf bank_mask:0xf
  s_waitcnt vmcnt(2)
  buffer_load_dwordx4 v[76:79], v184, s[48:51], 0 offen nt
  v_mfma_f32_16x16x32_bf16 v[40:43], v[108:111], v[24:27], v[40:43]
  v_mov_b32_dpp v44, v36 row_ror:8 row_mask:0xf bank_mask:0x4
  v_mov_b32_dpp v45, v37 row_ror:4 row_mask:0xf bank_mask:0x4
  v_mov_b32_dpp v46, v38 quad_perm:[0,1,2,3] row_mask:0xf bank_mask:0x4
  v_mov_b32_dpp v47, v39 row_ror:12 row_mask:0xf bank_mask:0x4
  v_mov_b32 v28, 0
  v_mov_b32 v29, 0
  v_mov_b32 v30, 0
  v_mov_b32 v31, 0
  v_add_u32_dpp v183, v9, v5 row_newbcast:8 row_mask:0xf bank_mask:0xf
  s_waitcnt vmcnt(2)
  buffer_load_dwordx4 v[80:83], v183, s[48:51], 0 offen nt
  s_nop 1
  v_mov_b32_dpp v44, v40 row_ror:12 row_mask:0xf bank_mask:0x8
  v_mov_b32_dpp v45, v41 row_ror:8 row_mask:0xf bank_mask:0x8
  v_mov_b32_dpp v46, v42 row_ror:4 row_mask:0xf bank_mask:0x8
  v_mov_b32_dpp v47, v43 quad_perm:[0,1,2,3] row_mask:0xf bank_mask:0x8
  v_add_f32 v10, v44, v45
  v_add_f32 v11, v46, v47
  v_add_f32 v10, v10, v11
  v_cvt_pk_bf16_f32 v10, v10, v10
  v_and_b32 v10, 0xffff0000, v10
  v_mul_f32 v10, 0x3db504f3, v10
  v_cvt_pk_bf16_f32 v10, v10, v10
  v_and_b32 v10, 0xffff0000, v10
  v_max_f32 v7, v7, v10
  v_xad_u32 v10, v244, s54, v10
  ds_write_b32 v6, v10
  v_add_u32 v6, 1024, v6
  v_mov_b32 v178, 17
  ds_write_b32 v181, v7
  s_mov_b64 exec, 1
  ds_write_b32 v180, v178
  s_mov_b64 exec, -1
  v_add_u32_dpp v184, v9, v5 row_newbcast:9 row_mask:0xf bank_mask:0xf
  s_waitcnt vmcnt(2)
  buffer_load_dwordx4 v[84:87], v184, s[48:51], 0 offen nt
  v_add_u32_dpp v183, v9, v5 row_newbcast:10 row_mask:0xf bank_mask:0xf
  s_waitcnt vmcnt(2)
  buffer_load_dwordx4 v[88:91], v183, s[48:51], 0 offen nt
  v_add_u32_dpp v184, v9, v5 row_newbcast:11 row_mask:0xf bank_mask:0xf
  s_waitcnt vmcnt(2)
  buffer_load_dwordx4 v[92:95], v184, s[48:51], 0 offen nt
  s_branch L_tdone
L_tm2:
  s_memrealtime s[74:75]
  s_waitcnt vmcnt(2)
  buffer_load_dwordx4 v[80:83], v4, s[44:47], s52 offen nt
  s_xor_b32 s52, s52, 0x800
  v_mfma_f32_16x16x32_bf16 v[28:31], v[48:51], v[12:15], 0
  s_waitcnt vmcnt(2)
  buffer_load_dwordx4 v[84:87], v4, s[44:47], s52 offen nt
  s_xor_b32 s52, s52, 0x1800
  v_mfma_f32_16x16x32_bf16 v[28:31], v[52:55], v[16:19], v[28:31]
  s_waitcnt vmcnt(2)
  buffer_load_dwordx4 v[88:91], v4, s[44:47], s52 offen nt
  s_xor_b32 s52, s52, 0x800
  v_mfma_f32_16x16x32_bf16 v[28:31], v[56:59], v[20:23], v[28:31]
  s_waitcnt vmcnt(2)
  buffer_load_dwordx4 v[92:95], v4, s[44:47], s52 offen nt
  s_xor_b32 s52, s52, 0x3800
  v_mfma_f32_16x16x32_bf16 v[28:31], v[60:63], v[24:27], v[28:31]
  v_mov_b32_dpp v44, v40 row_ror:12 row_mask:0xf bank_mask:0x8
  v_mov_b32_dpp v45, v41 row_ror:8 row_mask:0xf bank_mask:0x8
  v_mov_b32_dpp v46, v42 row_ror:4 row_mask:0xf bank_mask:0x8
  v_mov_b32_dpp v47, v43 quad_perm:[0,1,2,3] row_mask:0xf bank_mask:0x8
  v_add_f32 v10, v44, v45
  v_add_f32 v11, v46, v47
  v_add_f32 v10, v10, v11
  v_cvt_pk_bf16_f32 v10, v10, v10
  v_and_b32 v10, 0xffff0000, v10
  v_mul_f32 v10, 0x3db504f3, v10
  v_cvt_pk_bf16_f32 v10, v10, v10
  v_and_b32 v10, 0xffff0000, v10
  v_max_f32 v7, v7, v10
  v_xad_u32 v10, v244, s54, v10
  ds_write_b32 v6, v10
  v_add_u32 v6, 1024, v6
  s_mov_b32 s54, s55
  s_cmp_lt_u32 s62, 8
  s_cselect_b64 s[58:59], s[56:57], s[60:61]
  s_waitcnt vmcnt(3)
  buffer_load_dwordx4 v[96:99], v4, s[44:47], s52 offen nt
  s_xor_b32 s52, s52, 0x800
  v_mfma_f32_16x16x32_bf16 v[32:35], v[64:67], v[12:15], 0
  s_lshl_b32 s55, s62, 3
  s_lshr_b64 s[58:59], s[58:59], s55
  s_and_b32 s58, s58, 0xff
  s_lshl_b32 s55, s58, 6
  s_mov_b32 s71, 0x200000
L_ls24:
  s_cmp_gt_u32 s92, 16
  s_cbranch_scc1 L_l0ok23
  ds_read_b32 v178, v176 offset:52
  s_sub_u32 s71, s71, 1
  s_cbranch_scc1 L_l0ok23
  s_waitcnt lgkmcnt(0)
  v_readfirstlane_b32 s92, v178
  s_branch L_ls24
L_l0ok23:
  ds_read_b32 v254, v185
  s_waitcnt vmcnt(3)
  buffer_load_dwordx4 v[100:103], v4, s[44:47], s52 offen nt
  s_xor_b32 s52, s52, 0x1800
  v_mfma_f32_16x16x32_bf16 v[32:35], v[68:71], v[16:19], v[32:35]
  s_waitcnt lgkmcnt(0)
  s_andn2_b32 s74, s74, 15
  s_add_u32 s41, s41, 1
  s_or_b32 s74, s74, s41
  v_mov_b32 v182, s74
  v_mov_b32 v178, s62
  ds_write_b32 v181, v7
  s_mov_b64 exec, 1
  ds_write_b32 v177, v182
  ds_write_b32 v180, v178
  s_mov_b64 exec, -1
  v_add_u32 v177, 4, v177
  s_waitcnt vmcnt(3)
  buffer_load_dwordx4 v[104:107], v4, s[44:47], s52 offen nt
  s_xor_b32 s52, s52, 0x800
  v_mfma_f32_16x16x32_bf16 v[32:35], v[72:75], v[20:23], v[32:35]
  s_waitcnt vmcnt(3)
  buffer_load_dwordx4 v[108:111], v4, s[44:47], s52 offen nt
  s_lshl_b32 s52, s55, 6
  s_waitcnt lgkmcnt(0)
  v_and_b32 v9, 0xffff, v254
  v_lshlrev_b32 v9, 6, v9
  v_mfma_f32_16x16x32_bf16 v[32:35], v[76:79], v[24:27], v[32:35]
  v_mov_b32_dpp v44, v28 quad_perm:[0,1,2,3] row_mask:0xf bank_mask:0x1
  v_mov_b32_dpp v45, v29 row_ror:12 row_mask:0xf bank_mask:0x1
  v_mov_b32_dpp v46, v30 row_ror:8 row_mask:0xf bank_mask:0x1
  v_mov_b32_dpp v47, v31 row_ror:4 row_mask:0xf bank_mask:0x1
  v_add_u32_dpp v183, v9, v5 row_newbcast:0 row_mask:0xf bank_mask:0xf
  s_waitcnt vmcnt(2)
  buffer_load_dwordx4 v[48:51], v183, s[48:51], 0 offen nt
  v_mfma_f32_16x16x32_bf16 v[36:39], v[80:83], v[12:15], 0
  v_add_u32_dpp v184, v9, v5 row_newbcast:1 row_mask:0xf bank_mask:0xf
  s_waitcnt vmcnt(2)
  buffer_load_dwordx4 v[52:55], v184, s[48:51], 0 offen nt
  v_mfma_f32_16x16x32_bf16 v[36:39], v[84:87], v[16:19], v[36:39]
  v_add_u32_dpp v183, v9, v5 row_newbcast:2 row_mask:0xf bank_mask:0xf
  s_waitcnt vmcnt(2)
  buffer_load_dwordx4 v[56:59], v183, s[48:51], 0 offen nt
  v_mfma_f32_16x16x32_bf16 v[36:39], v[88:91], v[20:23], v[36:39]
  v_add_u32_dpp v184, v9, v5 row_newbcast:3 row_mask:0xf bank_mask:0xf
  s_waitcnt vmcnt(2)
  buffer_load_dwordx4 v[60:63], v184, s[48:51], 0 offen nt
  v_mfma_f32_16x16x32_bf16 v[36:39], v[92:95], v[24:27], v[36:39]
  v_mov_b32_dpp v44, v32 row_ror:4 row_mask:0xf bank_mask:0x2
  v_mov_b32_dpp v45, v33 quad_perm:[0,1,2,3] row_mask:0xf bank_mask:0x2
  v_mov_b32_dpp v46, v34 row_ror:12 row_mask:0xf bank_mask:0x2
  v_mov_b32_dpp v47, v35 row_ror:8 row_mask:0xf bank_mask:0x2
  ds_read_b64 v[178:179], v176 offset:48
  v_add_u32_dpp v183, v9, v5 row_newbcast:4 row_mask:0xf bank_mask:0xf
  s_waitcnt vmcnt(3)
  buffer_load_dwordx4 v[64:67], v183, s[48:51], 0 offen nt
  v_mfma_f32_16x16x32_bf16 v[40:43], v[96:99], v[12:15], 0
  v_add_u32_dpp v184, v9, v5 row_newbcast:5 row_mask:0xf bank_mask:0xf
  s_waitcnt vmcnt(3)
  buffer_load_dwordx4 v[68:71], v184, s[48:51], 0 offen nt
  v_mfma_f32_16x16x32_bf16 v[40:43], v[100:103], v[16:19], v[40:43]
  s_waitcnt lgkmcnt(0)
  v_readfirstlane_b32 s40, v178
  v_readfirstlane_b32 s92, v179
  v_add_u32_dpp v183, v9, v5 row_newbcast:6 row_mask:0xf bank_mask:0xf
  s_waitcnt vmcnt(3)
  buffer_load_dwordx4 v[72:75], v183, s[48:51], 0 offen nt
  v_mfma_f32_16x16x32_bf16 v[40:43], v[104:107], v[20:23], v[40:43]
  s_cmp_lg_u32 s40, 0
  s_cselect_b32 s63, s40, s63
  v_add_u32_dpp v184, v9, v5 row_newbcast:7 row_mask:0xf bank_mask:0xf
  s_waitcnt vmcnt(3)
  buffer_load_dwordx4 v[76:79], v184, s[48:51], 0 offen nt
  v_mfma_f32_16x16x32_bf16 v[40:43], v[108:111], v[24:27], v[40:43]
  v_mov_b32_dpp v44, v36 row_ror:8 row_mask:0xf bank_mask:0x4
  v_mov_b32_dpp v45, v37 row_ror:4 row_mask:0xf bank_mask:0x4
  v_mov_b32_dpp v46, v38 quad_perm:[0,1,2,3] row_mask:0xf bank_mask:0x4
  v_mov_b32_dpp v47, v39 row_ror:12 row_mask:0xf bank_mask:0x4
  v_mov_b32 v28, 0
  v_mov_b32 v29, 0
  v_mov_b32 v30, 0
  v_mov_b32 v31, 0
  v_add_u32_dpp v183, v9, v5 row_newbcast:8 row_mask:0xf bank_mask:0xf
  s_waitcnt vmcnt(2)
  buffer_load_dwordx4 v[80:83], v183, s[48:51], 0 offen nt
  s_nop 1
  v_mov_b32_dpp v44, v40 row_ror:12 row_mask:0xf bank_mask:0x8
  v_mov_b32_dpp v45, v41 row_ror:8 row_mask:0xf bank_mask:0x8
  v_mov_b32_dpp v46, v42 row_ror:4 row_mask:0xf bank_mask:0x8
  v_mov_b32_dpp v47, v43 quad_perm:[0,1,2,3] row_mask:0xf bank_mask:0x8
  v_add_f32 v10, v44, v45
  v_add_f32 v11, v46, v47
  v_add_f32 v10, v10, v11
  v_cvt_pk_bf16_f32 v10, v10, v10
  v_and_b32 v10, 0xffff0000, v10
  v_mul_f32 v10, 0x3db504f3, v10
  v_cvt_pk_bf16_f32 v10, v10, v10
  v_and_b32 v10, 0xffff0000, v10
  v_max_f32 v7, v7, v10
  v_xad_u32 v10, v244, s54, v10
  ds_write_b32 v6, v10
  v_add_u32 v6, 1024, v6
  v_mov_b32 v178, 17
  ds_write_b32 v181, v7
  s_mov_b64 exec, 1
  ds_write_b32 v180, v178
  s_mov_b64 exec, -1
  v_add_u32_dpp v184, v9, v5 row_newbcast:9 row_mask:0xf bank_mask:0xf
  s_waitcnt vmcnt(2)
  buffer_load_dwordx4 v[84:87], v184, s[48:51], 0 offen nt
  v_add_u32_dpp v183, v9, v5 row_newbcast:10 row_mask:0xf bank_mask:0xf
  s_waitcnt vmcnt(2)
  buffer_load_dwordx4 v[88:91], v183, s[48:51], 0 offen nt
  v_add_u32_dpp v184, v9, v5 row_newbcast:11 row_mask:0xf bank_mask:0xf
  s_waitcnt vmcnt(2)
  buffer_load_dwordx4 v[92:95], v184, s[48:51], 0 offen nt
  s_branch L_tdone
L_tm3:
  s_memrealtime s[74:75]
  s_waitcnt vmcnt(3)
  buffer_load_dwordx4 v[80:83], v4, s[44:47], s52 offen nt
  s_xor_b32 s52, s52, 0x800
  v_mfma_f32_16x16x32_bf16 v[28:31], v[48:51], v[12:15], 0
  s_waitcnt vmcnt(3)
  buffer_load_dwordx4 v[84:87], v4, s[44:47], s52 offen nt
  s_xor_b32 s52, s52, 0x1800
  v_mfma_f32_16x16x32_bf16 v[28:31], v[52:55], v[16:19], v[28:31]
  s_waitcnt vmcnt(3)
  buffer_load_dwordx4 v[88:91], v4, s[44:47], s52 offen nt
  s_xor_b32 s52, s52, 0x800
  v_mfma_f32_16x16x32_bf16 v[28:31], v[56:59], v[20:23], v[28:31]
  s_waitcnt vmcnt(3)
  buffer_load_dwordx4 v[92:95], v4, s[44:47], s52 offen nt
  s_xor_b32 s52, s52, 0x3800
  v_mfma_f32_16x16x32_bf16 v[28:31], v[60:63], v[24:27], v[28:31]
  v_mov_b32_dpp v44, v40 row_ror:12 row_mask:0xf bank_mask:0x8
  v_mov_b32_dpp v45, v41 row_ror:8 row_mask:0xf bank_mask:0x8
  v_mov_b32_dpp v46, v42 row_ror:4 row_mask:0xf bank_mask:0x8
  v_mov_b32_dpp v47, v43 quad_perm:[0,1,2,3] row_mask:0xf bank_mask:0x8
  v_add_f32 v10, v44, v45
  v_add_f32 v11, v46, v47
  v_add_f32 v10, v10, v11
  v_cvt_pk_bf16_f32 v10, v10, v10
  v_and_b32 v10, 0xffff0000, v10
  v_mul_f32 v10, 0x3db504f3, v10
  v_cvt_pk_bf16_f32 v10, v10, v10
  v_and_b32 v10, 0xffff0000, v10
  v_max_f32 v7, v7, v10
  v_xad_u32 v10, v244, s54, v10
  ds_write_b32 v6, v10
  v_add_u32 v6, 1024, v6
  s_mov_b32 s54, s55
  s_cmp_lt_u32 s62, 8
  s_cselect_b64 s[58:59], s[56:57], s[60:61]
  s_waitcnt vmcnt(3)
  buffer_load_dwordx4 v[96:99], v4, s[44:47], s52 offen nt
  s_xor_b32 s52, s52, 0x800
  v_mfma_f32_16x16x32_bf16 v[32:35], v[64:67], v[12:15], 0
  s_lshl_b32 s55, s62, 3
  s_lshr_b64 s[58:59], s[58:59], s55
  s_and_b32 s58, s58, 0xff
  s_lshl_b32 s55, s58, 6
  s_mov_b32 s71, 0x200000
L_ls26:
  s_cmp_gt_u32 s92, 16
  s_cbranch_scc1 L_l0ok25
  ds_read_b32 v178, v176 offset:52
  s_sub_u32 s71, s71, 1
  s_cbranch_scc1 L_l0ok25
  s_waitcnt lgkmcnt(0)
  v_readfirstlane_b32 s92, v178
  s_branch L_ls26
L_l0ok25:
  ds_read_b32 v254, v185
  s_waitcnt vmcnt(3)
  buffer_load_dwordx4 v[100:103], v4, s[44:47], s52 offen nt
  s_xor_b32 s52, s52, 0x1800
  v_mfma_f32_16x16x32_bf16 v[32:35], v[68:71], v[16:19], v[32:35]
  s_waitcnt lgkmcnt(0)
  s_andn2_b32 s74, s74, 15
  s_add_u32 s41, s41, 1
  s_or_b32 s74, s74, s41
  v_mov_b32 v182, s74
  v_mov_b32 v178, s62
  ds_write_b32 v181, v7
  s_mov_b64 exec, 1
  ds_write_b32 v177, v182
  ds_write_b32 v180, v178
  s_mov_b64 exec, -1
  v_add_u32 v177, 4, v177
  s_waitcnt vmcnt(3)
  buffer_load_dwordx4 v[104:107], v4, s[44:47], s52 offen nt
  s_xor_b32 s52, s52, 0x800
  v_mfma_f32_16x16x32_bf16 v[32:35], v[72:75], v[20:23], v[32:35]
  s_waitcnt vmcnt(3)
  buffer_load_dwordx4 v[108:111], v4, s[44:47], s52 offen nt
  s_lshl_b32 s52, s55, 6
  s_waitcnt lgkmcnt(0)
  v_and_b32 v9, 0xffff, v254
  v_lshlrev_b32 v9, 6, v9
  v_mfma_f32_16x16x32_bf16 v[32:35], v[76:79], v[24:27], v[32:35]
  v_mov_b32_dpp v44, v28 quad_perm:[0,1,2,3] row_mask:0xf bank_mask:0x1
  v_mov_b32_dpp v45, v29 row_ror:12 row_mask:0xf bank_mask:0x1
  v_mov_b32_dpp v46, v30 row_ror:8 row_mask:0xf bank_mask:0x1
  v_mov_b32_dpp v47, v31 row_ror:4 row_mask:0xf bank_mask:0x1
  v_add_u32_dpp v183, v9, v5 row_newbcast:0 row_mask:0xf bank_mask:0xf
  s_waitcnt vmcnt(3)
  buffer_load_dwordx4 v[48:51], v183, s[48:51], 0 offen nt
  v_mfma_f32_16x16x32_bf16 v[36:39], v[80:83], v[12:15], 0
  v_add_u32_dpp v184, v9, v5 row_newbcast:1 row_mask:0xf bank_mask:0xf
  s_waitcnt vmcnt(3)
  buffer_load_dwordx4 v[52:55], v184, s[48:51], 0 offen nt
  v_mfma_f32_16x16x32_bf16 v[36:39], v[84:87], v[16:19], v[36:39]
  v_add_u32_dpp v183, v9, v5 row_newbcast:2 row_mask:0xf bank_mask:0xf
  s_waitcnt vmcnt(3)
  buffer_load_dwordx4 v[56:59], v183, s[48:51], 0 offen nt
  v_mfma_f32_16x16x32_bf16 v[36:39], v[88:91], v[20:23], v[36:39]
  v_add_u32_dpp v184, v9, v5 row_newbcast:3 row_mask:0xf bank_mask:0xf
  s_waitcnt vmcnt(3)
  buffer_load_dwordx4 v[60:63], v184, s[48:51], 0 offen nt
  v_mfma_f32_16x16x32_bf16 v[36:39], v[92:95], v[24:27], v[36:39]
  v_mov_b32_dpp v44, v32 row_ror:4 row_mask:0xf bank_mask:0x2
  v_mov_b32_dpp v45, v33 quad_perm:[0,1,2,3] row_mask:0xf bank_mask:0x2
  v_mov_b32_dpp v46, v34 row_ror:12 row_mask:0xf bank_mask:0x2
  v_mov_b32_dpp v47, v35 row_ror:8 row_mask:0xf bank_mask:0x2
  ds_read_b64 v[178:179], v176 offset:48
  v_add_u32_dpp v183, v9, v5 row_newbcast:4 row_mask:0xf bank_mask:0xf
  s_waitcnt vmcnt(3)
  buffer_load_dwordx4 v[64:67], v183, s[48:51], 0 offen nt
  v_mfma_f32_16x16x32_bf16 v[40:43], v[96:99], v[12:15], 0
  v_add_u32_dpp v184, v9, v5 row_newbcast:5 row_mask:0xf bank_mask:0xf
  s_waitcnt vmcnt(3)
  buffer_load_dwordx4 v[68:71], v184, s[48:51], 0 offen nt
  v_mfma_f32_16x16x32_bf16 v[40:43], v[100:103], v[16:19], v[40:43]
  s_waitcnt lgkmcnt(0)
  v_readfirstlane_b32 s40, v178
  v_readfirstlane_b32 s92, v179
  v_add_u32_dpp v183, v9, v5 row_newbcast:6 row_mask:0xf bank_mask:0xf
  s_waitcnt vmcnt(3)
  buffer_load_dwordx4 v[72:75], v183, s[48:51], 0 offen nt
  v_mfma_f32_16x16x32_bf16 v[40:43], v[104:107], v[20:23], v[40:43]
  s_cmp_lg_u32 s40, 0
  s_cselect_b32 s63, s40, s63
  v_add_u32_dpp v184, v9, v5 row_newbcast:7 row_mask:0xf bank_mask:0xf
  s_waitcnt vmcnt(3)
  buffer_load_dwordx4 v[76:79], v184, s[48:51], 0 offen nt
  v_mfma_f32_16x16x32_bf16 v[40:43], v[108:111], v[24:27], v[40:43]
  v_mov_b32_dpp v44, v36 row_ror:8 row_mask:0xf bank_mask:0x4
  v_mov_b32_dpp v45, v37 row_ror:4 row_mask:0xf bank_mask:0x4
  v_mov_b32_dpp v46, v38 quad_perm:[0,1,2,3] row_mask:0xf bank_mask:0x4
  v_mov_b32_dpp v47, v39 row_ror:12 row_mask:0xf bank_mask:0x4
  v_mov_b32 v28, 0
  v_mov_b32 v29, 0
  v_mov_b32 v30, 0
  v_mov_b32 v31, 0
  v_add_u32_dpp v183, v9, v5 row_newbcast:8 row_mask:0xf bank_mask:0xf
  s_waitcnt vmcnt(3)
  buffer_load_dwordx4 v[80:83], v183, s[48:51], 0 offen nt
  s_nop 1
  v_mov_b32_dpp v44, v40 row_ror:12 row_mask:0xf bank_mask:0x8
  v_mov_b32_dpp v45, v41 row_ror:8 row_mask:0xf bank_mask:0x8
  v_mov_b32_dpp v46, v42 row_ror:4 row_mask:0xf bank_mask:0x8
  v_mov_b32_dpp v47, v43 quad_perm:[0,1,2,3] row_mask:0xf bank_mask:0x8
  v_add_f32 v10, v44, v45
  v_add_f32 v11, v46, v47
  v_add_f32 v10, v10, v11
  v_cvt_pk_bf16_f32 v10, v10, v10
  v_and_b32 v10, 0xffff0000, v10
  v_mul_f32 v10, 0x3db504f3, v10
  v_cvt_pk_bf16_f32 v10, v10, v10
  v_and_b32 v10, 0xffff0000, v10
  v_max_f32 v7, v7, v10
  v_xad_u32 v10, v244, s54, v10
  ds_write_b32 v6, v10
  v_add_u32 v6, 1024, v6
  v_mov_b32 v178, 17
  ds_write_b32 v181, v7
  s_mov_b64 exec, 1
  ds_write_b32 v180, v178
  s_mov_b64 exec, -1
  v_add_u32_dpp v184, v9, v5 row_newbcast:9 row_mask:0xf bank_mask:0xf
  s_waitcnt vmcnt(3)
  buffer_load_dwordx4 v[84:87], v184, s[48:51], 0 offen nt
  v_add_u32_dpp v183, v9, v5 row_newbcast:10 row_mask:0xf bank_mask:0xf
  s_waitcnt vmcnt(3)
  buffer_load_dwordx4 v[88:91], v183, s[48:51], 0 offen nt
  v_add_u32_dpp v184, v9, v5 row_newbcast:11 row_mask:0xf bank_mask:0xf
  s_waitcnt vmcnt(3)
  buffer_load_dwordx4 v[92:95], v184, s[48:51], 0 offen nt
  s_branch L_tdone
L_tm4:
  s_memrealtime s[74:75]
  s_waitcnt vmcnt(3)
  buffer_load_dwordx4 v[80:83], v4, s[44:47], s52 offen nt
  s_xor_b32 s52, s52, 0x800
  v_mfma_f32_16x16x32_bf16 v[28:31], v[48:51], v[12:15], 0
  s_waitcnt vmcnt(3)
  buffer_load_dwordx4 v[84:87], v4, s[44:47], s52 offen nt
  s_xor_b32 s52, s52, 0x1800
  v_mfma_f32_16x16x32_bf16 v[28:31], v[52:55], v[16:19], v[28:31]
  s_waitcnt vmcnt(3)
  buffer_load_dwordx4 v[88:91], v4, s[44:47], s52 offen nt
  s_xor_b32 s52, s52, 0x800
  v_mfma_f32_16x16x32_bf16 v[28:31], v[56:59], v[20:23], v[28:31]
  s_waitcnt vmcnt(3)
  buffer_load_dwordx4 v[92:95], v4, s[44:47], s52 offen nt
  s_xor_b32 s52, s52, 0x3800
  v_mfma_f32_16x16x32_bf16 v[28:31], v[60:63], v[24:27], v[28:31]
  v_mov_b32_dpp v44, v40 row_ror:12 row_mask:0xf bank_mask:0x8
  v_mov_b32_dpp v45, v41 row_ror:8 row_mask:0xf bank_mask:0x8
  v_mov_b32_dpp v46, v42 row_ror:4 row_mask:0xf bank_mask:0x8
  v_mov_b32_dpp v47, v43 quad_perm:[0,1,2,3] row_mask:0xf bank_mask:0x8
  v_add_f32 v10, v44, v45
  v_add_f32 v11, v46, v47
  v_add_f32 v10, v10, v11
  v_cvt_pk_bf16_f32 v10, v10, v10
  v_and_b32 v10, 0xffff0000, v10
  v_mul_f32 v10, 0x3db504f3, v10
  v_cvt_pk_bf16_f32 v10, v10, v10
  v_and_b32 v10, 0xffff0000, v10
  v_max_f32 v7, v7, v10
  v_xad_u32 v10, v244, s54, v10
  ds_write_b32 v6, v10
  v_add_u32 v6, 1024, v6
  s_mov_b32 s54, s55
  s_cmp_lt_u32 s62, 8
  s_cselect_b64 s[58:59], s[56:57], s[60:61]
  s_waitcnt vmcnt(4)
  buffer_load_dwordx4 v[96:99], v4, s[44:47], s52 offen nt
  s_xor_b32 s52, s52, 0x800
  v_mfma_f32_16x16x32_bf16 v[32:35], v[64:67], v[12:15], 0
  s_lshl_b32 s55, s62, 3
  s_lshr_b64 s[58:59], s[58:59], s55
  s_and_b32 s58, s58, 0xff
  s_lshl_b32 s55, s58, 6
  s_mov_b32 s71, 0x200000
L_ls28:
  s_cmp_gt_u32 s92, 16
  s_cbranch_scc1 L_l0ok27
  ds_read_b32 v178, v176 offset:52
  s_sub_u32 s71, s71, 1
  s_cbranch_scc1 L_l0ok27
  s_waitcnt lgkmcnt(0)
  v_readfirstlane_b32 s92, v178
  s_branch L_ls28
L_l0ok27:
  ds_read_b32 v254, v185
  s_waitcnt vmcnt(4)
  buffer_load_dwordx4 v[100:103], v4, s[44:47], s52 offen nt
  s_xor_b32 s52, s52, 0x1800
  v_mfma_f32_16x16x32_bf16 v[32:35], v[68:71], v[16:19], v[32:35]
  s_waitcnt lgkmcnt(0)
  s_andn2_b32 s74, s74, 15
  s_add_u32 s41, s41, 1
  s_or_b32 s74, s74, s41
  v_mov_b32 v182, s74
  v_mov_b32 v178, s62
  ds_write_b32 v181, v7
  s_mov_b64 exec, 1
  ds_write_b32 v177, v182
  ds_write_b32 v180, v178
  s_mov_b64 exec, -1
  v_add_u32 v177, 4, v177
  s_waitcnt vmcnt(4)
  buffer_load_dwordx4 v[104:107], v4, s[44:47], s52 offen nt
  s_xor_b32 s52, s52, 0x800
  v_mfma_f32_16x16x32_bf16 v[32:35], v[72:75], v[20:23], v[32:35]
  s_waitcnt vmcnt(4)
  buffer_load_dwordx4 v[108:111], v4, s[44:47], s52 offen nt
  s_lshl_b32 s52, s55, 6
  s_waitcnt lgkmcnt(0)
  v_and_b32 v9, 0xffff, v254
  v_lshlrev_b32 v9, 6, v9
  v_mfma_f32_16x16x32_bf16 v[32:35], v[76:79], v[24:27], v[32:35]
  v_mov_b32_dpp v44, v28 quad_perm:[0,1,2,3] row_mask:0xf bank_mask:0x1
  v_mov_b32_dpp v45, v29 row_ror:12 row_mask:0xf bank_mask:0x1
  v_mov_b32_dpp v46, v30 row_ror:8 row_mask:0xf bank_mask:0x1
  v_mov_b32_dpp v47, v31 row_ror:4 row_mask:0xf bank_mask:0x1
  v_add_u32_dpp v183, v9, v5 row_newbcast:0 row_mask:0xf bank_mask:0xf
  s_waitcnt vmcnt(3)
  buffer_load_dwordx4 v[48:51], v183, s[48:51], 0 offen nt
  v_mfma_f32_16x16x32_bf16 v[36:39], v[80:83], v[12:15], 0
  v_add_u32_dpp v184, v9, v5 row_newbcast:1 row_mask:0xf bank_mask:0xf
  s_waitcnt vmcnt(3)
  buffer_load_dwordx4 v[52:55], v184, s[48:51], 0 offen nt
  v_mfma_f32_16x16x32_bf16 v[36:39], v[84:87], v[16:19], v[36:39]
  v_add_u32_dpp v183, v9, v5 row_newbcast:2 row_mask:0xf bank_mask:0xf
  s_waitcnt vmcnt(3)
  buffer_load_dwordx4 v[56:59], v183, s[48:51], 0 offen nt
  v_mfma_f32_16x16x32_bf16 v[36:39], v[88:91], v[20:23], v[36:39]
  v_add_u32_dpp v184, v9, v5 row_newbcast:3 row_mask:0xf bank_mask:0xf
  s_waitcnt vmcnt(3)
  buffer_load_dwordx4 v[60:63], v184, s[48:51], 0 offen nt
  v_mfma_f32_16x16x32_bf16 v[36:39], v[92:95], v[24:27], v[36:39]
  v_mov_b32_dpp v44, v32 row_ror:4 row_mask:0xf bank_mask:0x2
  v_mov_b32_dpp v45, v33 quad_perm:[0,1,2,3] row_mask:0xf bank_mask:0x2
  v_mov_b32_dpp v46, v34 row_ror:12 row_mask:0xf bank_mask:0x2
  v_mov_b32_dpp v47, v35 row_ror:8 row_mask:0xf bank_mask:0x2
  ds_read_b64 v[178:179], v176 offset:48
  v_add_u32_dpp v183, v9, v5 row_newbcast:4 row_mask:0xf bank_mask:0xf
  s_waitcnt vmcnt(4)
  buffer_load_dwordx4 v[64:67], v183, s[48:51], 0 offen nt
  v_mfma_f32_16x16x32_bf16 v[40:43], v[96:99], v[12:15], 0
  v_add_u32_dpp v184, v9, v5 row_newbcast:5 row_mask:0xf bank_mask:0xf
  s_waitcnt vmcnt(4)
  buffer_load_dwordx4 v[68:71], v184, s[48:51], 0 offen nt
  v_mfma_f32_16x16x32_bf16 v[40:43], v[100:103], v[16:19], v[40:43]
  s_waitcnt lgkmcnt(0)
  v_readfirstlane_b32 s40, v178
  v_readfirstlane_b32 s92, v179
  v_add_u32_dpp v183, v9, v5 row_newbcast:6 row_mask:0xf bank_mask:0xf
  s_waitcnt vmcnt(4)
  buffer_load_dwordx4 v[72:75], v183, s[48:51], 0 offen nt
  v_mfma_f32_16x16x32_bf16 v[40:43], v[104:107], v[20:23], v[40:43]
  s_cmp_lg_u32 s40, 0
  s_cselect_b32 s63, s40, s63
  v_add_u32_dpp v184, v9, v5 row_newbcast:7 row_mask:0xf bank_mask:0xf
  s_waitcnt vmcnt(4)
  buffer_load_dwordx4 v[76:79], v184, s[48:51], 0 offen nt
  v_mfma_f32_16x16x32_bf16 v[40:43], v[108:111], v[24:27], v[40:43]
  v_mov_b32_dpp v44, v36 row_ror:8 row_mask:0xf bank_mask:0x4
  v_mov_b32_dpp v45, v37 row_ror:4 row_mask:0xf bank_mask:0x4
  v_mov_b32_dpp v46, v38 quad_perm:[0,1,2,3] row_mask:0xf bank_mask:0x4
  v_mov_b32_dpp v47, v39 row_ror:12 row_mask:0xf bank_mask:0x4
  v_mov_b32 v28, 0
  v_mov_b32 v29, 0
  v_mov_b32 v30, 0
  v_mov_b32 v31, 0
  v_add_u32_dpp v183, v9, v5 row_newbcast:8 row_mask:0xf bank_mask:0xf
  s_waitcnt vmcnt(3)
  buffer_load_dwordx4 v[80:83], v183, s[48:51], 0 offen nt
  s_nop 1
  v_mov_b32_dpp v44, v40 row_ror:12 row_mask:0xf bank_mask:0x8
  v_mov_b32_dpp v45, v41 row_ror:8 row_mask:0xf bank_mask:0x8
  v_mov_b32_dpp v46, v42 row_ror:4 row_mask:0xf bank_mask:0x8
  v_mov_b32_dpp v47, v43 quad_perm:[0,1,2,3] row_mask:0xf bank_mask:0x8
  v_add_f32 v10, v44, v45
  v_add_f32 v11, v46, v47
  v_add_f32 v10, v10, v11
  v_cvt_pk_bf16_f32 v10, v10, v10
  v_and_b32 v10, 0xffff0000, v10
  v_mul_f32 v10, 0x3db504f3, v10
  v_cvt_pk_bf16_f32 v10, v10, v10
  v_and_b32 v10, 0xffff0000, v10
  v_max_f32 v7, v7, v10
  v_xad_u32 v10, v244, s54, v10
  ds_write_b32 v6, v10
  v_add_u32 v6, 1024, v6
  v_mov_b32 v178, 17
  ds_write_b32 v181, v7
  s_mov_b64 exec, 1
  ds_write_b32 v180, v178
  s_mov_b64 exec, -1
  v_add_u32_dpp v184, v9, v5 row_newbcast:9 row_mask:0xf bank_mask:0xf
  s_waitcnt vmcnt(3)
  buffer_load_dwordx4 v[84:87], v184, s[48:51], 0 offen nt
  v_add_u32_dpp v183, v9, v5 row_newbcast:10 row_mask:0xf bank_mask:0xf
  s_waitcnt vmcnt(3)
  buffer_load_dwordx4 v[88:91], v183, s[48:51], 0 offen nt
  v_add_u32_dpp v184, v9, v5 row_newbcast:11 row_mask:0xf bank_mask:0xf
  s_waitcnt vmcnt(3)
  buffer_load_dwordx4 v[92:95], v184, s[48:51], 0 offen nt
  s_branch L_tdone
L_tm5:
  s_memrealtime s[74:75]
  s_waitcnt vmcnt(4)
  buffer_load_dwordx4 v[80:83], v4, s[44:47], s52 offen nt
  s_xor_b32 s52, s52, 0x800
  v_mfma_f32_16x16x32_bf16 v[28:31], v[48:51], v[12:15], 0
  s_waitcnt vmcnt(4)
  buffer_load_dwordx4 v[84:87], v4, s[44:47], s52 offen nt
  s_xor_b32 s52, s52, 0x1800
  v_mfma_f32_16x16x32_bf16 v[28:31], v[52:55], v[16:19], v[28:31]
  s_waitcnt vmcnt(4)
  buffer_load_dwordx4 v[88:91], v4, s[44:47], s52 offen nt
  s_xor_b32 s52, s52, 0x800
  v_mfma_f32_16x16x32_bf16 v[28:31], v[56:59], v[20:23], v[28:31]
  s_waitcnt vmcnt(4)
  buffer_load_dwordx4 v[92:95], v4, s[44:47], s52 offen nt
  s_xor_b32 s52, s52, 0x3800
  v_mfma_f32_16x16x32_bf16 v[28:31], v[60:63], v[24:27], v[28:31]
  v_mov_b32_dpp v44, v40 row_ror:12 row_mask:0xf bank_mask:0x8
  v_mov_b32_dpp v45, v41 row_ror:8 row_mask:0xf bank_mask:0x8
  v_mov_b32_dpp v46, v42 row_ror:4 row_mask:0xf bank_mask:0x8
  v_mov_b32_dpp v47, v43 quad_perm:[0,1,2,3] row_mask:0xf bank_mask:0x8
  v_add_f32 v10, v44, v45
  v_add_f32 v11, v46, v47
  v_add_f32 v10, v10, v11
  v_cvt_pk_bf16_f32 v10, v10, v10
  v_and_b32 v10, 0xffff0000, v10
  v_mul_f32 v10, 0x3db504f3, v10
  v_cvt_pk_bf16_f32 v10, v10, v10
  v_and_b32 v10, 0xffff0000, v10
  v_max_f32 v7, v7, v10
  v_xad_u32 v10, v244, s54, v10
  ds_write_b32 v6, v10
  v_add_u32 v6, 1024, v6
  s_mov_b32 s54, s55
  s_cmp_lt_u32 s62, 8
  s_cselect_b64 s[58:59], s[56:57], s[60:61]
  s_waitcnt vmcnt(4)
  buffer_load_dwordx4 v[96:99], v4, s[44:47], s52 offen nt
  s_xor_b32 s52, s52, 0x800
  v_mfma_f32_16x16x32_bf16 v[32:35], v[64:67], v[12:15], 0
  s_lshl_b32 s55, s62, 3
  s_lshr_b64 s[58:59], s[58:59], s55
  s_and_b32 s58, s58, 0xff
  s_lshl_b32 s55, s58, 6
  s_mov_b32 s71, 0x200000
L_ls30:
  s_cmp_gt_u32 s92, 16
  s_cbranch_scc1 L_l0ok29
  ds_read_b32 v178, v176 offset:52
  s_sub_u32 s71, s71, 1
  s_cbranch_scc1 L_l0ok29
  s_waitcnt lgkmcnt(0)
  v_readfirstlane_b32 s92, v178
  s_branch L_ls30
L_l0ok29:
  ds_read_b32 v254, v185
  s_waitcnt vmcnt(4)
  buffer_load_dwordx4 v[100:103], v4, s[44:47], s52 offen nt
  s_xor_b32 s52, s52, 0x1800
  v_mfma_f32_16x16x32_bf16 v[32:35], v[68:71], v[16:19], v[32:35]
  s_waitcnt lgkmcnt(0)
  s_andn2_b32 s74, s74, 15
  s_add_u32 s41, s41, 1
  s_or_b32 s74, s74, s41
  v_mov_b32 v182, s74
  v_mov_b32 v178, s62
  ds_write_b32 v181, v7
  s_mov_b64 exec, 1
  ds_write_b32 v177, v182
  ds_write_b32 v180, v178
  s_mov_b64 exec, -1
  v_add_u32 v177, 4, v177
  s_waitcnt vmcnt(4)
  buffer_load_dwordx4 v[104:107], v4, s[44:47], s52 offen nt
  s_xor_b32 s52, s52, 0x800
  v_mfma_f32_16x16x32_bf16 v[32:35], v[72:75], v[20:23], v[32:35]
  s_waitcnt vmcnt(4)
  buffer_load_dwordx4 v[108:111], v4, s[44:47], s52 offen nt
  s_lshl_b32 s52, s55, 6
  s_waitcnt lgkmcnt(0)
  v_and_b32 v9, 0xffff, v254
  v_lshlrev_b32 v9, 6, v9
  v_mfma_f32_16x16x32_bf16 v[32:35], v[76:79], v[24:27], v[32:35]
  v_mov_b32_dpp v44, v28 quad_perm:[0,1,2,3] row_mask:0xf bank_mask:0x1
  v_mov_b32_dpp v45, v29 row_ror:12 row_mask:0xf bank_mask:0x1
  v_mov_b32_dpp v46, v30 row_ror:8 row_mask:0xf bank_mask:0x1
  v_mov_b32_dpp v47, v31 row_ror:4 row_mask:0xf bank_mask:0x1
  v_add_u32_dpp v183, v9, v5 row_newbcast:0 row_mask:0xf bank_mask:0xf
  s_waitcnt vmcnt(4)
  buffer_load_dwordx4 v[48:51], v183, s[48:51], 0 offen nt
  v_mfma_f32_16x16x32_bf16 v[36:39], v[80:83], v[12:15], 0
  v_add_u32_dpp v184, v9, v5 row_newbcast:1 row_mask:0xf bank_mask:0xf
  s_waitcnt vmcnt(4)
  buffer_load_dwordx4 v[52:55], v184, s[48:51], 0 offen nt
  v_mfma_f32_16x16x32_bf16 v[36:39], v[84:87], v[16:19], v[36:39]
  v_add_u32_dpp v183, v9, v5 row_newbcast:2 row_mask:0xf bank_mask:0xf
  s_waitcnt vmcnt(4)
  buffer_load_dwordx4 v[56:59], v183, s[48:51], 0 offen nt
  v_mfma_f32_16x16x32_bf16 v[36:39], v[88:91], v[20:23], v[36:39]
  v_add_u32_dpp v184, v9, v5 row_newbcast:3 row_mask:0xf bank_mask:0xf
  s_waitcnt vmcnt(4)
  buffer_load_dwordx4 v[60:63], v184, s[48:51], 0 offen nt
  v_mfma_f32_16x16x32_bf16 v[36:39], v[92:95], v[24:27], v[36:39]
  v_mov_b32_dpp v44, v32 row_ror:4 row_mask:0xf bank_mask:0x2
  v_mov_b32_dpp v45, v33 quad_perm:[0,1,2,3] row_mask:0xf bank_mask:0x2
  v_mov_b32_dpp v46, v34 row_ror:12 row_mask:0xf bank_mask:0x2
  v_mov_b32_dpp v47, v35 row_ror:8 row_mask:0xf bank_mask:0x2
  ds_read_b64 v[178:179], v176 offset:48
  v_add_u32_dpp v183, v9, v5 row_newbcast:4 row_mask:0xf bank_mask:0xf
  s_waitcnt vmcnt(4)
  buffer_load_dwordx4 v[64:67], v183, s[48:51], 0 offen nt
  v_mfma_f32_16x16x32_bf16 v[40:43], v[96:99], v[12:15], 0
  v_add_u32_dpp v184, v9, v5 row_newbcast:5 row_mask:0xf bank_mask:0xf
  s_waitcnt vmcnt(4)
  buffer_load_dwordx4 v[68:71], v184, s[48:51], 0 offen nt
  v_mfma_f32_16x16x32_bf16 v[40:43], v[100:103], v[16:19], v[40:43]
  s_waitcnt lgkmcnt(0)
  v_readfirstlane_b32 s40, v178
  v_readfirstlane_b32 s92, v179
  v_add_u32_dpp v183, v9, v5 row_newbcast:6 row_mask:0xf bank_mask:0xf
  s_waitcnt vmcnt(4)
  buffer_load_dwordx4 v[72:75], v183, s[48:51], 0 offen nt
  v_mfma_f32_16x16x32_bf16 v[40:43], v[104:107], v[20:23], v[40:43]
  s_cmp_lg_u32 s40, 0
  s_cselect_b32 s63, s40, s63
  v_add_u32_dpp v184, v9, v5 row_newbcast:7 row_mask:0xf bank_mask:0xf
  s_waitcnt vmcnt(4)
  buffer_load_dwordx4 v[76:79], v184, s[48:51], 0 offen nt
  v_mfma_f32_16x16x32_bf16 v[40:43], v[108:111], v[24:27], v[40:43]
  v_mov_b32_dpp v44, v36 row_ror:8 row_mask:0xf bank_mask:0x4
  v_mov_b32_dpp v45, v37 row_ror:4 row_mask:0xf bank_mask:0x4
  v_mov_b32_dpp v46, v38 quad_perm:[0,1,2,3] row_mask:0xf bank_mask:0x4
  v_mov_b32_dpp v47, v39 row_ror:12 row_mask:0xf bank_mask:0x4
  v_mov_b32 v28, 0
  v_mov_b32 v29, 0
  v_mov_b32 v30, 0
  v_mov_b32 v31, 0
  v_add_u32_dpp v183, v9, v5 row_newbcast:8 row_mask:0xf bank_mask:0xf
  s_waitcnt vmcnt(4)
  buffer_load_dwordx4 v[80:83], v183, s[48:51], 0 offen nt
  s_nop 1
  v_mov_b32_dpp v44, v40 row_ror:12 row_mask:0xf bank_mask:0x8
  v_mov_b32_dpp v45, v41 row_ror:8 row_mask:0xf bank_mask:0x8
  v_mov_b32_dpp v46, v42 row_ror:4 row_mask:0xf bank_mask:0x8
  v_mov_b32_dpp v47, v43 quad_perm:[0,1,2,3] row_mask:0xf bank_mask:0x8
  v_add_f32 v10, v44, v45
  v_add_f32 v11, v46, v47
  v_add_f32 v10, v10, v11
  v_cvt_pk_bf16_f32 v10, v10, v10
  v_and_b32 v10, 0xffff0000, v10
  v_mul_f32 v10, 0x3db504f3, v10
  v_cvt_pk_bf16_f32 v10, v10, v10
  v_and_b32 v10, 0xffff0000, v10
  v_max_f32 v7, v7, v10
  v_xad_u32 v10, v244, s54, v10
  ds_write_b32 v6, v10
  v_add_u32 v6, 1024, v6
  v_mov_b32 v178, 17
  ds_write_b32 v181, v7
  s_mov_b64 exec, 1
  ds_write_b32 v180, v178
  s_mov_b64 exec, -1
  v_add_u32_dpp v184, v9, v5 row_newbcast:9 row_mask:0xf bank_mask:0xf
  s_waitcnt vmcnt(4)
  buffer_load_dwordx4 v[84:87], v184, s[48:51], 0 offen nt
  v_add_u32_dpp v183, v9, v5 row_newbcast:10 row_mask:0xf bank_mask:0xf
  s_waitcnt vmcnt(4)
  buffer_load_dwordx4 v[88:91], v183, s[48:51], 0 offen nt
  v_add_u32_dpp v184, v9, v5 row_newbcast:11 row_mask:0xf bank_mask:0xf
  s_waitcnt vmcnt(4)
  buffer_load_dwordx4 v[92:95], v184, s[48:51], 0 offen nt
  s_branch L_tdone
L_tm6:
  s_memrealtime s[74:75]
  s_waitcnt vmcnt(4)
  buffer_load_dwordx4 v[80:83], v4, s[44:47], s52 offen nt
  s_xor_b32 s52, s52, 0x800
  v_mfma_f32_16x16x32_bf16 v[28:31], v[48:51], v[12:15], 0
  s_waitcnt vmcnt(4)
  buffer_load_dwordx4 v[84:87], v4, s[44:47], s52 offen nt
  s_xor_b32 s52, s52, 0x1800
  v_mfma_f32_16x16x32_bf16 v[28:31], v[52:55], v[16:19], v[28:31]
  s_waitcnt vmcnt(4)
  buffer_load_dwordx4 v[88:91], v4, s[44:47], s52 offen nt
  s_xor_b32 s52, s52, 0x800
  v_mfma_f32_16x16x32_bf16 v[28:31], v[56:59], v[20:23], v[28:31]
  s_waitcnt vmcnt(4)
  buffer_load_dwordx4 v[92:95], v4, s[44:47], s52 offen nt
  s_xor_b32 s52, s52, 0x3800
  v_mfma_f32_16x16x32_bf16 v[28:31], v[60:63], v[24:27], v[28:31]
  v_mov_b32_dpp v44, v40 row_ror:12 row_mask:0xf bank_mask:0x8
  v_mov_b32_dpp v45, v41 row_ror:8 row_mask:0xf bank_mask:0x8
  v_mov_b32_dpp v46, v42 row_ror:4 row_mask:0xf bank_mask:0x8
  v_mov_b32_dpp v47, v43 quad_perm:[0,1,2,3] row_mask:0xf bank_mask:0x8
  v_add_f32 v10, v44, v45
  v_add_f32 v11, v46, v47
  v_add_f32 v10, v10, v11
  v_cvt_pk_bf16_f32 v10, v10, v10
  v_and_b32 v10, 0xffff0000, v10
  v_mul_f32 v10, 0x3db504f3, v10
  v_cvt_pk_bf16_f32 v10, v10, v10
  v_and_b32 v10, 0xffff0000, v10
  v_max_f32 v7, v7, v10
  v_xad_u32 v10, v244, s54, v10
  ds_write_b32 v6, v10
  v_add_u32 v6, 1024, v6
  s_mov_b32 s54, s55
  s_cmp_lt_u32 s62, 8
  s_cselect_b64 s[58:59], s[56:57], s[60:61]
  s_waitcnt vmcnt(5)
  buffer_load_dwordx4 v[96:99], v4, s[44:47], s52 offen nt
  s_xor_b32 s52, s52, 0x800
  v_mfma_f32_16x16x32_bf16 v[32:35], v[64:67], v[12:15], 0
  s_lshl_b32 s55, s62, 3
  s_lshr_b64 s[58:59], s[58:59], s55
  s_and_b32 s58, s58, 0xff
  s_lshl_b32 s55, s58, 6
  s_mov_b32 s71, 0x200000
L_ls32:
  s_cmp_gt_u32 s92, 16
  s_cbranch_scc1 L_l0ok31
  ds_read_b32 v178, v176 offset:52
  s_sub_u32 s71, s71, 1
  s_cbranch_scc1 L_l0ok31
  s_waitcnt lgkmcnt(0)
  v_readfirstlane_b32 s92, v178
  s_branch L_ls32
L_l0ok31:
  ds_read_b32 v254, v185
  s_waitcnt vmcnt(5)
  buffer_load_dwordx4 v[100:103], v4, s[44:47], s52 offen nt
  s_xor_b32 s52, s52, 0x1800
  v_mfma_f32_16x16x32_bf16 v[32:35], v[68:71], v[16:19], v[32:35]
  s_waitcnt lgkmcnt(0)
  s_andn2_b32 s74, s74, 15
  s_add_u32 s41, s41, 1
  s_or_b32 s74, s74, s41
  v_mov_b32 v182, s74
  v_mov_b32 v178, s62
  ds_write_b32 v181, v7
  s_mov_b64 exec, 1
  ds_write_b32 v177, v182
  ds_write_b32 v180, v178
  s_mov_b64 exec, -1
  v_add_u32 v177, 4, v177
  s_waitcnt vmcnt(5)
  buffer_load_dwordx4 v[104:107], v4, s[44:47], s52 offen nt
  s_xor_b32 s52, s52, 0x800
  v_mfma_f32_16x16x32_bf16 v[32:35], v[72:75], v[20:23], v[32:35]
  s_waitcnt vmcnt(5)
  buffer_load_dwordx4 v[108:111], v4, s[44:47], s52 offen nt
  s_lshl_b32 s52, s55, 6
  s_waitcnt lgkmcnt(0)
  v_and_b32 v9, 0xffff, v254
  v_lshlrev_b32 v9, 6, v9
  v_mfma_f32_16x16x32_bf16 v[32:35], v[76:79], v[24:27], v[32:35]
  v_mov_b32_dpp v44, v28 quad_perm:[0,1,2,3] row_mask:0xf bank_mask:0x1
  v_mov_b32_dpp v45, v29 row_ror:12 row_mask:0xf bank_mask:0x1
  v_mov_b32_dpp v46, v30 row_ror:8 row_mask:0xf bank_mask:0x1
  v_mov_b32_dpp v47, v31 row_ror:4 row_mask:0xf bank_mask:0x1
  v_add_u32_dpp v183, v9, v5 row_newbcast:0 row_mask:0xf bank_mask:0xf
  s_waitcnt vmcnt(4)
  buffer_load_dwordx4 v[48:51], v183, s[48:51], 0 offen nt
  v_mfma_f32_16x16x32_bf16 v[36:39], v[80:83], v[12:15], 0
  v_add_u32_dpp v184, v9, v5 row_newbcast:1 row_mask:0xf bank_mask:0xf
  s_waitcnt vmcnt(4)
  buffer_load_dwordx4 v[52:55], v184, s[48:51], 0 offen nt
  v_mfma_f32_16x16x32_bf16 v[36:39], v[84:87], v[16:19], v[36:39]
  v_add_u32_dpp v183, v9, v5 row_newbcast:2 row_mask:0xf bank_mask:0xf
  s_waitcnt vmcnt(4)
  buffer_load_dwordx4 v[56:59], v183, s[48:51], 0 offen nt
  v_mfma_f32_16x16x32_bf16 v[36:39], v[88:91], v[20:23], v[36:39]
  v_add_u32_dpp v184, v9, v5 row_newbcast:3 row_mask:0xf bank_mask:0xf
  s_waitcnt vmcnt(4)
  buffer_load_dwordx4 v[60:63], v184, s[48:51], 0 offen nt
  v_mfma_f32_16x16x32_bf16 v[36:39], v[92:95], v[24:27], v[36:39]
  v_mov_b32_dpp v44, v32 row_ror:4 row_mask:0xf bank_mask:0x2
  v_mov_b32_dpp v45, v33 quad_perm:[0,1,2,3] row_mask:0xf bank_mask:0x2
  v_mov_b32_dpp v46, v34 row_ror:12 row_mask:0xf bank_mask:0x2
  v_mov_b32_dpp v47, v35 row_ror:8 row_mask:0xf bank_mask:0x2
  ds_read_b64 v[178:179], v176 offset:48
  v_add_u32_dpp v183, v9, v5 row_newbcast:4 row_mask:0xf bank_mask:0xf
  s_waitcnt vmcnt(5)
  buffer_load_dwordx4 v[64:67], v183, s[48:51], 0 offen nt
  v_mfma_f32_16x16x32_bf16 v[40:43], v[96:99], v[12:15], 0
  v_add_u32_dpp v184, v9, v5 row_newbcast:5 row_mask:0xf bank_mask:0xf
  s_waitcnt vmcnt(5)
  buffer_load_dwordx4 v[68:71], v184, s[48:51], 0 offen nt
  v_mfma_f32_16x16x32_bf16 v[40:43], v[100:103], v[16:19], v[40:43]
  s_waitcnt lgkmcnt(0)
  v_readfirstlane_b32 s40, v178
  v_readfirstlane_b32 s92, v179
  v_add_u32_dpp v183, v9, v5 row_newbcast:6 row_mask:0xf bank_mask:0xf
  s_waitcnt vmcnt(5)
  buffer_load_dwordx4 v[72:75], v183, s[48:51], 0 offen nt
  v_mfma_f32_16x16x32_bf16 v[40:43], v[104:107], v[20:23], v[40:43]
  s_cmp_lg_u32 s40, 0
  s_cselect_b32 s63, s40, s63
  v_add_u32_dpp v184, v9, v5 row_newbcast:7 row_mask:0xf bank_mask:0xf
  s_waitcnt vmcnt(5)
  buffer_load_dwordx4 v[76:79], v184, s[48:51], 0 offen nt
  v_mfma_f32_16x16x32_bf16 v[40:43], v[108:111], v[24:27], v[40:43]
  v_mov_b32_dpp v44, v36 row_ror:8 row_mask:0xf bank_mask:0x4
  v_mov_b32_dpp v45, v37 row_ror:4 row_mask:0xf bank_mask:0x4
  v_mov_b32_dpp v46, v38 quad_perm:[0,1,2,3] row_mask:0xf bank_mask:0x4
  v_mov_b32_dpp v47, v39 row_ror:12 row_mask:0xf bank_mask:0x4
  v_mov_b32 v28, 0
  v_mov_b32 v29, 0
  v_mov_b32 v30, 0
  v_mov_b32 v31, 0
  v_add_u32_dpp v183, v9, v5 row_newbcast:8 row_mask:0xf bank_mask:0xf
  s_waitcnt vmcnt(4)
  buffer_load_dwordx4 v[80:83], v183, s[48:51], 0 offen nt
  s_nop 1
  v_mov_b32_dpp v44, v40 row_ror:12 row_mask:0xf bank_mask:0x8
  v_mov_b32_dpp v45, v41 row_ror:8 row_mask:0xf bank_mask:0x8
  v_mov_b32_dpp v46, v42 row_ror:4 row_mask:0xf bank_mask:0x8
  v_mov_b32_dpp v47, v43 quad_perm:[0,1,2,3] row_mask:0xf bank_mask:0x8
  v_add_f32 v10, v44, v45
  v_add_f32 v11, v46, v47
  v_add_f32 v10, v10, v11
  v_cvt_pk_bf16_f32 v10, v10, v10
  v_and_b32 v10, 0xffff0000, v10
  v_mul_f32 v10, 0x3db504f3, v10
  v_cvt_pk_bf16_f32 v10, v10, v10
  v_and_b32 v10, 0xffff0000, v10
  v_max_f32 v7, v7, v10
  v_xad_u32 v10, v244, s54, v10
  ds_write_b32 v6, v10
  v_add_u32 v6, 1024, v6
  v_mov_b32 v178, 17
  ds_write_b32 v181, v7
  s_mov_b64 exec, 1
  ds_write_b32 v180, v178
  s_mov_b64 exec, -1
  v_add_u32_dpp v184, v9, v5 row_newbcast:9 row_mask:0xf bank_mask:0xf
  s_waitcnt vmcnt(4)
  buffer_load_dwordx4 v[84:87], v184, s[48:51], 0 offen nt
  v_add_u32_dpp v183, v9, v5 row_newbcast:10 row_mask:0xf bank_mask:0xf
  s_waitcnt vmcnt(4)
  buffer_load_dwordx4 v[88:91], v183, s[48:51], 0 offen nt
  v_add_u32_dpp v184, v9, v5 row_newbcast:11 row_mask:0xf bank_mask:0xf
  s_waitcnt vmcnt(4)
  buffer_load_dwordx4 v[92:95], v184, s[48:51], 0 offen nt
  s_branch L_tdone
L_tm7:
  s_memrealtime s[74:75]
  s_waitcnt vmcnt(5)
  buffer_load_dwordx4 v[80:83], v4, s[44:47], s52 offen nt
  s_xor_b32 s52, s52, 0x800
  v_mfma_f32_16x16x32_bf16 v[28:31], v[48:51], v[12:15], 0
  s_waitcnt vmcnt(5)
  buffer_load_dwordx4 v[84:87], v4, s[44:47], s52 offen nt
  s_xor_b32 s52, s52, 0x1800
  v_mfma_f32_16x16x32_bf16 v[28:31], v[52:55], v[16:19], v[28:31]
  s_waitcnt vmcnt(5)
  buffer_load_dwordx4 v[88:91], v4, s[44:47], s52 offen nt
  s_xor_b32 s52, s52, 0x800
  v_mfma_f32_16x16x32_bf16 v[28:31], v[56:59], v[20:23], v[28:31]
  s_waitcnt vmcnt(5)
  buffer_load_dwordx4 v[92:95], v4, s[44:47], s52 offen nt
  s_xor_b32 s52, s52, 0x3800
  v_mfma_f32_16x16x32_bf16 v[28:31], v[60:63], v[24:27], v[28:31]
  v_mov_b32_dpp v44, v40 row_ror:12 row_mask:0xf bank_mask:0x8
  v_mov_b32_dpp v45, v41 row_ror:8 row_mask:0xf bank_mask:0x8
  v_mov_b32_dpp v46, v42 row_ror:4 row_mask:0xf bank_mask:0x8
  v_mov_b32_dpp v47, v43 quad_perm:[0,1,2,3] row_mask:0xf bank_mask:0x8
  v_add_f32 v10, v44, v45
  v_add_f32 v11, v46, v47
  v_add_f32 v10, v10, v11
  v_cvt_pk_bf16_f32 v10, v10, v10
  v_and_b32 v10, 0xffff0000, v10
  v_mul_f32 v10, 0x3db504f3, v10
  v_cvt_pk_bf16_f32 v10, v10, v10
  v_and_b32 v10, 0xffff0000, v10
  v_max_f32 v7, v7, v10
  v_xad_u32 v10, v244, s54, v10
  ds_write_b32 v6, v10
  v_add_u32 v6, 1024, v6
  s_mov_b32 s54, s55
  s_cmp_lt_u32 s62, 8
  s_cselect_b64 s[58:59], s[56:57], s[60:61]
  s_waitcnt vmcnt(5)
  buffer_load_dwordx4 v[96:99], v4, s[44:47], s52 offen nt
  s_xor_b32 s52, s52, 0x800
  v_mfma_f32_16x16x32_bf16 v[32:35], v[64:67], v[12:15], 0
  s_lshl_b32 s55, s62, 3
  s_lshr_b64 s[58:59], s[58:59], s55
  s_and_b32 s58, s58, 0xff
  s_lshl_b32 s55, s58, 6
  s_mov_b32 s71, 0x200000
L_ls34:
  s_cmp_gt_u32 s92, 16
  s_cbranch_scc1 L_l0ok33
  ds_read_b32 v178, v176 offset:52
  s_sub_u32 s71, s71, 1
  s_cbranch_scc1 L_l0ok33
  s_waitcnt lgkmcnt(0)
  v_readfirstlane_b32 s92, v178
  s_branch L_ls34
L_l0ok33:
  ds_read_b32 v254, v185
  s_waitcnt vmcnt(5)
  buffer_load_dwordx4 v[100:103], v4, s[44:47], s52 offen nt
  s_xor_b32 s52, s52, 0x1800
  v_mfma_f32_16x16x32_bf16 v[32:35], v[68:71], v[16:19], v[32:35]
  s_waitcnt lgkmcnt(0)
  s_andn2_b32 s74, s74, 15
  s_add_u32 s41, s41, 1
  s_or_b32 s74, s74, s41
  v_mov_b32 v182, s74
  v_mov_b32 v178, s62
  ds_write_b32 v181, v7
  s_mov_b64 exec, 1
  ds_write_b32 v177, v182
  ds_write_b32 v180, v178
  s_mov_b64 exec, -1
  v_add_u32 v177, 4, v177
  s_waitcnt vmcnt(5)
  buffer_load_dwordx4 v[104:107], v4, s[44:47], s52 offen nt
  s_xor_b32 s52, s52, 0x800
  v_mfma_f32_16x16x32_bf16 v[32:35], v[72:75], v[20:23], v[32:35]
  s_waitcnt vmcnt(5)
  buffer_load_dwordx4 v[108:111], v4, s[44:47], s52 offen nt
  s_lshl_b32 s52, s55, 6
  s_waitcnt lgkmcnt(0)
  v_and_b32 v9, 0xffff, v254
  v_lshlrev_b32 v9, 6, v9
  v_mfma_f32_16x16x32_bf16 v[32:35], v[76:79], v[24:27], v[32:35]
  v_mov_b32_dpp v44, v28 quad_perm:[0,1,2,3] row_mask:0xf bank_mask:0x1
  v_mov_b32_dpp v45, v29 row_ror:12 row_mask:0xf bank_mask:0x1
  v_mov_b32_dpp v46, v30 row_ror:8 row_mask:0xf bank_mask:0x1
  v_mov_b32_dpp v47, v31 row_ror:4 row_mask:0xf bank_mask:0x1
  v_add_u32_dpp v183, v9, v5 row_newbcast:0 row_mask:0xf bank_mask:0xf
  s_waitcnt vmcnt(5)
  buffer_load_dwordx4 v[48:51], v183, s[48:51], 0 offen nt
  v_mfma_f32_16x16x32_bf16 v[36:39], v[80:83], v[12:15], 0
  v_add_u32_dpp v184, v9, v5 row_newbcast:1 row_mask:0xf bank_mask:0xf
  s_waitcnt vmcnt(5)
  buffer_load_dwordx4 v[52:55], v184, s[48:51], 0 offen nt
  v_mfma_f32_16x16x32_bf16 v[36:39], v[84:87], v[16:19], v[36:39]
  v_add_u32_dpp v183, v9, v5 row_newbcast:2 row_mask:0xf bank_mask:0xf
  s_waitcnt vmcnt(5)
  buffer_load_dwordx4 v[56:59], v183, s[48:51], 0 offen nt
  v_mfma_f32_16x16x32_bf16 v[36:39], v[88:91], v[20:23], v[36:39]
  v_add_u32_dpp v184, v9, v5 row_newbcast:3 row_mask:0xf bank_mask:0xf
  s_waitcnt vmcnt(5)
  buffer_load_dwordx4 v[60:63], v184, s[48:51], 0 offen nt
  v_mfma_f32_16x16x32_bf16 v[36:39], v[92:95], v[24:27], v[36:39]
  v_mov_b32_dpp v44, v32 row_ror:4 row_mask:0xf bank_mask:0x2
  v_mov_b32_dpp v45, v33 quad_perm:[0,1,2,3] row_mask:0xf bank_mask:0x2
  v_mov_b32_dpp v46, v34 row_ror:12 row_mask:0xf bank_mask:0x2
  v_mov_b32_dpp v47, v35 row_ror:8 row_mask:0xf bank_mask:0x2
  ds_read_b64 v[178:179], v176 offset:48
  v_add_u32_dpp v183, v9, v5 row_newbcast:4 row_mask:0xf bank_mask:0xf
  s_waitcnt vmcnt(5)
  buffer_load_dwordx4 v[64:67], v183, s[48:51], 0 offen nt
  v_mfma_f32_16x16x32_bf16 v[40:43], v[96:99], v[12:15], 0
  v_add_u32_dpp v184, v9, v5 row_newbcast:5 row_mask:0xf bank_mask:0xf
  s_waitcnt vmcnt(5)
  buffer_load_dwordx4 v[68:71], v184, s[48:51], 0 offen nt
  v_mfma_f32_16x16x32_bf16 v[40:43], v[100:103], v[16:19], v[40:43]
  s_waitcnt lgkmcnt(0)
  v_readfirstlane_b32 s40, v178
  v_readfirstlane_b32 s92, v179
  v_add_u32_dpp v183, v9, v5 row_newbcast:6 row_mask:0xf bank_mask:0xf
  s_waitcnt vmcnt(5)
  buffer_load_dwordx4 v[72:75], v183, s[48:51], 0 offen nt
  v_mfma_f32_16x16x32_bf16 v[40:43], v[104:107], v[20:23], v[40:43]
  s_cmp_lg_u32 s40, 0
  s_cselect_b32 s63, s40, s63
  v_add_u32_dpp v184, v9, v5 row_newbcast:7 row_mask:0xf bank_mask:0xf
  s_waitcnt vmcnt(5)
  buffer_load_dwordx4 v[76:79], v184, s[48:51], 0 offen nt
  v_mfma_f32_16x16x32_bf16 v[40:43], v[108:111], v[24:27], v[40:43]
  v_mov_b32_dpp v44, v36 row_ror:8 row_mask:0xf bank_mask:0x4
  v_mov_b32_dpp v45, v37 row_ror:4 row_mask:0xf bank_mask:0x4
  v_mov_b32_dpp v46, v38 quad_perm:[0,1,2,3] row_mask:0xf bank_mask:0x4
  v_mov_b32_dpp v47, v39 row_ror:12 row_mask:0xf bank_mask:0x4
  v_mov_b32 v28, 0
  v_mov_b32 v29, 0
  v_mov_b32 v30, 0
  v_mov_b32 v31, 0
  v_add_u32_dpp v183, v9, v5 row_newbcast:8 row_mask:0xf bank_mask:0xf
  s_waitcnt vmcnt(5)
  buffer_load_dwordx4 v[80:83], v183, s[48:51], 0 offen nt
  s_nop 1
  v_mov_b32_dpp v44, v40 row_ror:12 row_mask:0xf bank_mask:0x8
  v_mov_b32_dpp v45, v41 row_ror:8 row_mask:0xf bank_mask:0x8
  v_mov_b32_dpp v46, v42 row_ror:4 row_mask:0xf bank_mask:0x8
  v_mov_b32_dpp v47, v43 quad_perm:[0,1,2,3] row_mask:0xf bank_mask:0x8
  v_add_f32 v10, v44, v45
  v_add_f32 v11, v46, v47
  v_add_f32 v10, v10, v11
  v_cvt_pk_bf16_f32 v10, v10, v10
  v_and_b32 v10, 0xffff0000, v10
  v_mul_f32 v10, 0x3db504f3, v10
  v_cvt_pk_bf16_f32 v10, v10, v10
  v_and_b32 v10, 0xffff0000, v10
  v_max_f32 v7, v7, v10
  v_xad_u32 v10, v244, s54, v10
  ds_write_b32 v6, v10
  v_add_u32 v6, 1024, v6
  v_mov_b32 v178, 17
  ds_write_b32 v181, v7
  s_mov_b64 exec, 1
  ds_write_b32 v180, v178
  s_mov_b64 exec, -1
  v_add_u32_dpp v184, v9, v5 row_newbcast:9 row_mask:0xf bank_mask:0xf
  s_waitcnt vmcnt(5)
  buffer_load_dwordx4 v[84:87], v184, s[48:51], 0 offen nt
  v_add_u32_dpp v183, v9, v5 row_newbcast:10 row_mask:0xf bank_mask:0xf
  s_waitcnt vmcnt(5)
  buffer_load_dwordx4 v[88:91], v183, s[48:51], 0 offen nt
  v_add_u32_dpp v184, v9, v5 row_newbcast:11 row_mask:0xf bank_mask:0xf
  s_waitcnt vmcnt(5)
  buffer_load_dwordx4 v[92:95], v184, s[48:51], 0 offen nt
  s_branch L_tdone
L_tm8:
  s_memrealtime s[74:75]
  s_waitcnt vmcnt(6)
  buffer_load_dwordx4 v[80:83], v4, s[44:47], s52 offen nt
  s_xor_b32 s52, s52, 0x800
  v_mfma_f32_16x16x32_bf16 v[28:31], v[48:51], v[12:15], 0
  s_waitcnt vmcnt(6)
  buffer_load_dwordx4 v[84:87], v4, s[44:47], s52 offen nt
  s_xor_b32 s52, s52, 0x1800
  v_mfma_f32_16x16x32_bf16 v[28:31], v[52:55], v[16:19], v[28:31]
  s_waitcnt vmcnt(6)
  buffer_load_dwordx4 v[88:91], v4, s[44:47], s52 offen nt
  s_xor_b32 s52, s52, 0x800
  v_mfma_f32_16x16x32_bf16 v[28:31], v[56:59], v[20:23], v[28:31]
  s_waitcnt vmcnt(6)
  buffer_load_dwordx4 v[92:95], v4, s[44:47], s52 offen nt
  s_xor_b32 s52, s52, 0x3800
  v_mfma_f32_16x16x32_bf16 v[28:31], v[60:63], v[24:27], v[28:31]
  v_mov_b32_dpp v44, v40 row_ror:12 row_mask:0xf bank_mask:0x8
  v_mov_b32_dpp v45, v41 row_ror:8 row_mask:0xf bank_mask:0x8
  v_mov_b32_dpp v46, v42 row_ror:4 row_mask:0xf bank_mask:0x8
  v_mov_b32_dpp v47, v43 quad_perm:[0,1,2,3] row_mask:0xf bank_mask:0x8
  v_add_f32 v10, v44, v45
  v_add_f32 v11, v46, v47
  v_add_f32 v10, v10, v11
  v_cvt_pk_bf16_f32 v10, v10, v10
  v_and_b32 v10, 0xffff0000, v10
  v_mul_f32 v10, 0x3db504f3, v10
  v_cvt_pk_bf16_f32 v10, v10, v10
  v_and_b32 v10, 0xffff0000, v10
  v_max_f32 v7, v7, v10
  v_xad_u32 v10, v244, s54, v10
  ds_write_b32 v6, v10
  v_add_u32 v6, 1024, v6
  s_mov_b32 s54, s55
  s_cmp_lt_u32 s62, 8
  s_cselect_b64 s[58:59], s[56:57], s[60:61]
  s_waitcnt vmcnt(6)
  buffer_load_dwordx4 v[96:99], v4, s[44:47], s52 offen nt
  s_xor_b32 s52, s52, 0x800
  v_mfma_f32_16x16x32_bf16 v[32:35], v[64:67], v[12:15], 0
  s_lshl_b32 s55, s62, 3
  s_lshr_b64 s[58:59], s[58:59], s55
  s_and_b32 s58, s58, 0xff
  s_lshl_b32 s55, s58, 6
  s_mov_b32 s71, 0x200000
L_ls36:
  s_cmp_gt_u32 s92, 16
  s_cbranch_scc1 L_l0ok35
  ds_read_b32 v178, v176 offset:52
  s_sub_u32 s71, s71, 1
  s_cbranch_scc1 L_l0ok35
  s_waitcnt lgkmcnt(0)
  v_readfirstlane_b32 s92, v178
  s_branch L_ls36
L_l0ok35:
  ds_read_b32 v254, v185
  s_waitcnt vmcnt(6)
  buffer_load_dwordx4 v[100:103], v4, s[44:47], s52 offen nt
  s_xor_b32 s52, s52, 0x1800
  v_mfma_f32_16x16x32_bf16 v[32:35], v[68:71], v[16:19], v[32:35]
  s_waitcnt lgkmcnt(0)
  s_andn2_b32 s74, s74, 15
  s_add_u32 s41, s41, 1
  s_or_b32 s74, s74, s41
  v_mov_b32 v182, s74
  v_mov_b32 v178, s62
  ds_write_b32 v181, v7
  s_mov_b64 exec, 1
  ds_write_b32 v177, v182
  ds_write_b32 v180, v178
  s_mov_b64 exec, -1
  v_add_u32 v177, 4, v177
  s_waitcnt vmcnt(6)
  buffer_load_dwordx4 v[104:107], v4, s[44:47], s52 offen nt
  s_xor_b32 s52, s52, 0x800
  v_mfma_f32_16x16x32_bf16 v[32:35], v[72:75], v[20:23], v[32:35]
  s_waitcnt vmcnt(6)
  buffer_load_dwordx4 v[108:111], v4, s[44:47], s52 offen nt
  s_lshl_b32 s52, s55, 6
  s_waitcnt lgkmcnt(0)
  v_and_b32 v9, 0xffff, v254
  v_lshlrev_b32 v9, 6, v9
  v_mfma_f32_16x16x32_bf16 v[32:35], v[76:79], v[24:27], v[32:35]
  v_mov_b32_dpp v44, v28 quad_perm:[0,1,2,3] row_mask:0xf bank_mask:0x1
  v_mov_b32_dpp v45, v29 row_ror:12 row_mask:0xf bank_mask:0x1
  v_mov_b32_dpp v46, v30 row_ror:8 row_mask:0xf bank_mask:0x1
  v_mov_b32_dpp v47, v31 row_ror:4 row_mask:0xf bank_mask:0x1
  v_add_u32_dpp v183, v9, v5 row_newbcast:0 row_mask:0xf bank_mask:0xf
  s_waitcnt vmcnt(6)
  buffer_load_dwordx4 v[48:51], v183, s[48:51], 0 offen nt
  v_mfma_f32_16x16x32_bf16 v[36:39], v[80:83], v[12:15], 0
  v_add_u32_dpp v184, v9, v5 row_newbcast:1 row_mask:0xf bank_mask:0xf
  s_waitcnt vmcnt(6)
  buffer_load_dwordx4 v[52:55], v184, s[48:51], 0 offen nt
  v_mfma_f32_16x16x32_bf16 v[36:39], v[84:87], v[16:19], v[36:39]
  v_add_u32_dpp v183, v9, v5 row_newbcast:2 row_mask:0xf bank_mask:0xf
  s_waitcnt vmcnt(6)
  buffer_load_dwordx4 v[56:59], v183, s[48:51], 0 offen nt
  v_mfma_f32_16x16x32_bf16 v[36:39], v[88:91], v[20:23], v[36:39]
  v_add_u32_dpp v184, v9, v5 row_newbcast:3 row_mask:0xf bank_mask:0xf
  s_waitcnt vmcnt(6)
  buffer_load_dwordx4 v[60:63], v184, s[48:51], 0 offen nt
  v_mfma_f32_16x16x32_bf16 v[36:39], v[92:95], v[24:27], v[36:39]
  v_mov_b32_dpp v44, v32 row_ror:4 row_mask:0xf bank_mask:0x2
  v_mov_b32_dpp v45, v33 quad_perm:[0,1,2,3] row_mask:0xf bank_mask:0x2
  v_mov_b32_dpp v46, v34 row_ror:12 row_mask:0xf bank_mask:0x2
  v_mov_b32_dpp v47, v35 row_ror:8 row_mask:0xf bank_mask:0x2
  ds_read_b64 v[178:179], v176 offset:48
  v_add_u32_dpp v183, v9, v5 row_newbcast:4 row_mask:0xf bank_mask:0xf
  s_waitcnt vmcnt(6)
  buffer_load_dwordx4 v[64:67], v183, s[48:51], 0 offen nt
  v_mfma_f32_16x16x32_bf16 v[40:43], v[96:99], v[12:15], 0
  v_add_u32_dpp v184, v9, v5 row_newbcast:5 row_mask:0xf bank_mask:0xf
  s_waitcnt vmcnt(6)
  buffer_load_dwordx4 v[68:71], v184, s[48:51], 0 offen nt
  v_mfma_f32_16x16x32_bf16 v[40:43], v[100:103], v[16:19], v[40:43]
  s_waitcnt lgkmcnt(0)
  v_readfirstlane_b32 s40, v178
  v_readfirstlane_b32 s92, v179
  v_add_u32_dpp v183, v9, v5 row_newbcast:6 row_mask:0xf bank_mask:0xf
  s_waitcnt vmcnt(6)
  buffer_load_dwordx4 v[72:75], v183, s[48:51], 0 offen nt
  v_mfma_f32_16x16x32_bf16 v[40:43], v[104:107], v[20:23], v[40:43]
  s_cmp_lg_u32 s40, 0
  s_cselect_b32 s63, s40, s63
  v_add_u32_dpp v184, v9, v5 row_newbcast:7 row_mask:0xf bank_mask:0xf
  s_waitcnt vmcnt(6)
  buffer_load_dwordx4 v[76:79], v184, s[48:51], 0 offen nt
  v_mfma_f32_16x16x32_bf16 v[40:43], v[108:111], v[24:27], v[40:43]
  v_mov_b32_dpp v44, v36 row_ror:8 row_mask:0xf bank_mask:0x4
  v_mov_b32_dpp v45, v37 row_ror:4 row_mask:0xf bank_mask:0x4
  v_mov_b32_dpp v46, v38 quad_perm:[0,1,2,3] row_mask:0xf bank_mask:0x4
  v_mov_b32_dpp v47, v39 row_ror:12 row_mask:0xf bank_mask:0x4
  v_mov_b32 v28, 0
  v_mov_b32 v29, 0
  v_mov_b32 v30, 0
  v_mov_b32 v31, 0
  v_add_u32_dpp v183, v9, v5 row_newbcast:8 row_mask:0xf bank_mask:0xf
  s_waitcnt vmcnt(6)
  buffer_load_dwordx4 v[80:83], v183, s[48:51], 0 offen nt
  s_nop 1
  v_mov_b32_dpp v44, v40 row_ror:12 row_mask:0xf bank_mask:0x8
  v_mov_b32_dpp v45, v41 row_ror:8 row_mask:0xf bank_mask:0x8
  v_mov_b32_dpp v46, v42 row_ror:4 row_mask:0xf bank_mask:0x8
  v_mov_b32_dpp v47, v43 quad_perm:[0,1,2,3] row_mask:0xf bank_mask:0x8
  v_add_f32 v10, v44, v45
  v_add_f32 v11, v46, v47
  v_add_f32 v10, v10, v11
  v_cvt_pk_bf16_f32 v10, v10, v10
  v_and_b32 v10, 0xffff0000, v10
  v_mul_f32 v10, 0x3db504f3, v10
  v_cvt_pk_bf16_f32 v10, v10, v10
  v_and_b32 v10, 0xffff0000, v10
  v_max_f32 v7, v7, v10
  v_xad_u32 v10, v244, s54, v10
  ds_write_b32 v6, v10
  v_add_u32 v6, 1024, v6
  v_mov_b32 v178, 17
  ds_write_b32 v181, v7
  s_mov_b64 exec, 1
  ds_write_b32 v180, v178
  s_mov_b64 exec, -1
  v_add_u32_dpp v184, v9, v5 row_newbcast:9 row_mask:0xf bank_mask:0xf
  s_waitcnt vmcnt(6)
  buffer_load_dwordx4 v[84:87], v184, s[48:51], 0 offen nt
  v_add_u32_dpp v183, v9, v5 row_newbcast:10 row_mask:0xf bank_mask:0xf
  s_waitcnt vmcnt(6)
  buffer_load_dwordx4 v[88:91], v183, s[48:51], 0 offen nt
  v_add_u32_dpp v184, v9, v5 row_newbcast:11 row_mask:0xf bank_mask:0xf
  s_waitcnt vmcnt(6)
  buffer_load_dwordx4 v[92:95], v184, s[48:51], 0 offen nt
  s_branch L_tdone
L_tm9:
  s_memrealtime s[74:75]
  s_waitcnt vmcnt(7)
  buffer_load_dwordx4 v[80:83], v4, s[44:47], s52 offen nt
  s_xor_b32 s52, s52, 0x800
  v_mfma_f32_16x16x32_bf16 v[28:31], v[48:51], v[12:15], 0
  s_waitcnt vmcnt(7)
  buffer_load_dwordx4 v[84:87], v4, s[44:47], s52 offen nt
  s_xor_b32 s52, s52, 0x1800
  v_mfma_f32_16x16x32_bf16 v[28:31], v[52:55], v[16:19], v[28:31]
  s_waitcnt vmcnt(7)
  buffer_load_dwordx4 v[88:91], v4, s[44:47], s52 offen nt
  s_xor_b32 s52, s52, 0x800
  v_mfma_f32_16x16x32_bf16 v[28:31], v[56:59], v[20:23], v[28:31]
  s_waitcnt vmcnt(7)
  buffer_load_dwordx4 v[92:95], v4, s[44:47], s52 offen nt
  s_xor_b32 s52, s52, 0x3800
  v_mfma_f32_16x16x32_bf16 v[28:31], v[60:63], v[24:27], v[28:31]
  v_mov_b32_dpp v44, v40 row_ror:12 row_mask:0xf bank_mask:0x8
  v_mov_b32_dpp v45, v41 row_ror:8 row_mask:0xf bank_mask:0x8
  v_mov_b32_dpp v46, v42 row_ror:4 row_mask:0xf bank_mask:0x8
  v_mov_b32_dpp v47, v43 quad_perm:[0,1,2,3] row_mask:0xf bank_mask:0x8
  v_add_f32 v10, v44, v45
  v_add_f32 v11, v46, v47
  v_add_f32 v10, v10, v11
  v_cvt_pk_bf16_f32 v10, v10, v10
  v_and_b32 v10, 0xffff0000, v10
  v_mul_f32 v10, 0x3db504f3, v10
  v_cvt_pk_bf16_f32 v10, v10, v10
  v_and_b32 v10, 0xffff0000, v10
  v_max_f32 v7, v7, v10
  v_xad_u32 v10, v244, s54, v10
  ds_write_b32 v6, v10
  v_add_u32 v6, 1024, v6
  s_mov_b32 s54, s55
  s_cmp_lt_u32 s62, 8
  s_cselect_b64 s[58:59], s[56:57], s[60:61]
  s_waitcnt vmcnt(7)
  buffer_load_dwordx4 v[96:99], v4, s[44:47], s52 offen nt
  s_xor_b32 s52, s52, 0x800
  v_mfma_f32_16x16x32_bf16 v[32:35], v[64:67], v[12:15], 0
  s_lshl_b32 s55, s62, 3
  s_lshr_b64 s[58:59], s[58:59], s55
  s_and_b32 s58, s58, 0xff
  s_lshl_b32 s55, s58, 6
  s_mov_b32 s71, 0x200000
L_ls38:
  s_cmp_gt_u32 s92, 16
  s_cbranch_scc1 L_l0ok37
  ds_read_b32 v178, v176 offset:52
  s_sub_u32 s71, s71, 1
  s_cbranch_scc1 L_l0ok37
  s_waitcnt lgkmcnt(0)
  v_readfirstlane_b32 s92, v178
  s_branch L_ls38
L_l0ok37:
  ds_read_b32 v254, v185
  s_waitcnt vmcnt(7)
  buffer_load_dwordx4 v[100:103], v4, s[44:47], s52 offen nt
  s_xor_b32 s52, s52, 0x1800
  v_mfma_f32_16x16x32_bf16 v[32:35], v[68:71], v[16:19], v[32:35]
  s_waitcnt lgkmcnt(0)
  s_andn2_b32 s74, s74, 15
  s_add_u32 s41, s41, 1
  s_or_b32 s74, s74, s41
  v_mov_b32 v182, s74
  v_mov_b32 v178, s62
  ds_write_b32 v181, v7
  s_mov_b64 exec, 1
  ds_write_b32 v177, v182
  ds_write_b32 v180, v178
  s_mov_b64 exec, -1
  v_add_u32 v177, 4, v177
  s_waitcnt vmcnt(7)
  buffer_load_dwordx4 v[104:107], v4, s[44:47], s52 offen nt
  s_xor_b32 s52, s52, 0x800
  v_mfma_f32_16x16x32_bf16 v[32:35], v[72:75], v[20:23], v[32:35]
  s_waitcnt vmcnt(7)
  buffer_load_dwordx4 v[108:111], v4, s[44:47], s52 offen nt
  s_lshl_b32 s52, s55, 6
  s_waitcnt lgkmcnt(0)
  v_and_b32 v9, 0xffff, v254
  v_lshlrev_b32 v9, 6, v9
  v_mfma_f32_16x16x32_bf16 v[32:35], v[76:79], v[24:27], v[32:35]
  v_mov_b32_dpp v44, v28 quad_perm:[0,1,2,3] row_mask:0xf bank_mask:0x1
  v_mov_b32_dpp v45, v29 row_ror:12 row_mask:0xf bank_mask:0x1
  v_mov_b32_dpp v46, v30 row_ror:8 row_mask:0xf bank_mask:0x1
  v_mov_b32_dpp v47, v31 row_ror:4 row_mask:0xf bank_mask:0x1
  v_add_u32_dpp v183, v9, v5 row_newbcast:0 row_mask:0xf bank_mask:0xf
  s_waitcnt vmcnt(7)
  buffer_load_dwordx4 v[48:51], v183, s[48:51], 0 offen nt
  v_mfma_f32_16x16x32_bf16 v[36:39], v[80:83], v[12:15], 0
  v_add_u32_dpp v184, v9, v5 row_newbcast:1 row_mask:0xf bank_mask:0xf
  s_waitcnt vmcnt(7)
  buffer_load_dwordx4 v[52:55], v184, s[48:51], 0 offen nt
  v_mfma_f32_16x16x32_bf16 v[36:39], v[84:87], v[16:19], v[36:39]
  v_add_u32_dpp v183, v9, v5 row_newbcast:2 row_mask:0xf bank_mask:0xf
  s_waitcnt vmcnt(7)
  buffer_load_dwordx4 v[56:59], v183, s[48:51], 0 offen nt
  v_mfma_f32_16x16x32_bf16 v[36:39], v[88:91], v[20:23], v[36:39]
  v_add_u32_dpp v184, v9, v5 row_newbcast:3 row_mask:0xf bank_mask:0xf
  s_waitcnt vmcnt(7)
  buffer_load_dwordx4 v[60:63], v184, s[48:51], 0 offen nt
  v_mfma_f32_16x16x32_bf16 v[36:39], v[92:95], v[24:27], v[36:39]
  v_mov_b32_dpp v44, v32 row_ror:4 row_mask:0xf bank_mask:0x2
  v_mov_b32_dpp v45, v33 quad_perm:[0,1,2,3] row_mask:0xf bank_mask:0x2
  v_mov_b32_dpp v46, v34 row_ror:12 row_mask:0xf bank_mask:0x2
  v_mov_b32_dpp v47, v35 row_ror:8 row_mask:0xf bank_mask:0x2
  ds_read_b64 v[178:179], v176 offset:48
  v_add_u32_dpp v183, v9, v5 row_newbcast:4 row_mask:0xf bank_mask:0xf
  s_waitcnt vmcnt(7)
  buffer_load_dwordx4 v[64:67], v183, s[48:51], 0 offen nt
  v_mfma_f32_16x16x32_bf16 v[40:43], v[96:99], v[12:15], 0
  v_add_u32_dpp v184, v9, v5 row_newbcast:5 row_mask:0xf bank_mask:0xf
  s_waitcnt vmcnt(7)
  buffer_load_dwordx4 v[68:71], v184, s[48:51], 0 offen nt
  v_mfma_f32_16x16x32_bf16 v[40:43], v[100:103], v[16:19], v[40:43]
  s_waitcnt lgkmcnt(0)
  v_readfirstlane_b32 s40, v178
  v_readfirstlane_b32 s92, v179
  v_add_u32_dpp v183, v9, v5 row_newbcast:6 row_mask:0xf bank_mask:0xf
  s_waitcnt vmcnt(7)
  buffer_load_dwordx4 v[72:75], v183, s[48:51], 0 offen nt
  v_mfma_f32_16x16x32_bf16 v[40:43], v[104:107], v[20:23], v[40:43]
  s_cmp_lg_u32 s40, 0
  s_cselect_b32 s63, s40, s63
  v_add_u32_dpp v184, v9, v5 row_newbcast:7 row_mask:0xf bank_mask:0xf
  s_waitcnt vmcnt(7)
  buffer_load_dwordx4 v[76:79], v184, s[48:51], 0 offen nt
  v_mfma_f32_16x16x32_bf16 v[40:43], v[108:111], v[24:27], v[40:43]
  v_mov_b32_dpp v44, v36 row_ror:8 row_mask:0xf bank_mask:0x4
  v_mov_b32_dpp v45, v37 row_ror:4 row_mask:0xf bank_mask:0x4
  v_mov_b32_dpp v46, v38 quad_perm:[0,1,2,3] row_mask:0xf bank_mask:0x4
  v_mov_b32_dpp v47, v39 row_ror:12 row_mask:0xf bank_mask:0x4
  v_mov_b32 v28, 0
  v_mov_b32 v29, 0
  v_mov_b32 v30, 0
  v_mov_b32 v31, 0
  v_add_u32_dpp v183, v9, v5 row_newbcast:8 row_mask:0xf bank_mask:0xf
  s_waitcnt vmcnt(7)
  buffer_load_dwordx4 v[80:83], v183, s[48:51], 0 offen nt
  s_nop 1
  v_mov_b32_dpp v44, v40 row_ror:12 row_mask:0xf bank_mask:0x8
  v_mov_b32_dpp v45, v41 row_ror:8 row_mask:0xf bank_mask:0x8
  v_mov_b32_dpp v46, v42 row_ror:4 row_mask:0xf bank_mask:0x8
  v_mov_b32_dpp v47, v43 quad_perm:[0,1,2,3] row_mask:0xf bank_mask:0x8
  v_add_f32 v10, v44, v45
  v_add_f32 v11, v46, v47
  v_add_f32 v10, v10, v11
  v_cvt_pk_bf16_f32 v10, v10, v10
  v_and_b32 v10, 0xffff0000, v10
  v_mul_f32 v10, 0x3db504f3, v10
  v_cvt_pk_bf16_f32 v10, v10, v10
  v_and_b32 v10, 0xffff0000, v10
  v_max_f32 v7, v7, v10
  v_xad_u32 v10, v244, s54, v10
  ds_write_b32 v6, v10
  v_add_u32 v6, 1024, v6
  v_mov_b32 v178, 17
  ds_write_b32 v181, v7
  s_mov_b64 exec, 1
  ds_write_b32 v180, v178
  s_mov_b64 exec, -1
  v_add_u32_dpp v184, v9, v5 row_newbcast:9 row_mask:0xf bank_mask:0xf
  s_waitcnt vmcnt(7)
  buffer_load_dwordx4 v[84:87], v184, s[48:51], 0 offen nt
  v_add_u32_dpp v183, v9, v5 row_newbcast:10 row_mask:0xf bank_mask:0xf
  s_waitcnt vmcnt(7)
  buffer_load_dwordx4 v[88:91], v183, s[48:51], 0 offen nt
  v_add_u32_dpp v184, v9, v5 row_newbcast:11 row_mask:0xf bank_mask:0xf
  s_waitcnt vmcnt(7)
  buffer_load_dwordx4 v[92:95], v184, s[48:51], 0 offen nt
L_tdone:
  s_mov_b32 s71, 0x200000
L_mxw:
  ds_read_b128 v[44:47], v176 offset:32
  s_sub_u32 s71, s71, 1
  s_cbranch_scc1 L_mxd
  s_waitcnt lgkmcnt(0)
  v_min3_u32 v44, v44, v45, v46
  v_min_u32 v44, v44, v47
  s_nop 0
  v_readfirstlane_b32 s40, v44
  s_nop 0
  s_cmp_lt_u32 s40, 17
  s_cbranch_scc1 L_mxw
L_mxd:
  v_and_b32 v10, -16, v181
  ds_read_b128 v[44:47], v10
  s_waitcnt lgkmcnt(0)
  v_max3_f32 v7, v44, v45, v46
  v_max_f32 v7, v7, v47
  s_nop 1
  v_max_f32_dpp v7, v7, v7 row_ror:8 row_mask:0xf bank_mask:0xf
  s_nop 1
  v_max_f32_dpp v7, v7, v7 row_ror:4 row_mask:0xf bank_mask:0xf
  s_nop 1
  v_max_f32_dpp v7, v7, v7 row_ror:2 row_mask:0xf bank_mask:0xf
  s_nop 1
  v_max_f32_dpp v7, v7, v7 row_ror:1 row_mask:0xf bank_mask:0xf
  s_nop 1
  v_max_f32_dpp v7, v7, v7 row_bcast:15 row_mask:0xa bank_mask:0xf
  s_nop 1
  v_max_f32_dpp v7, v7, v7 row_bcast:31 row_mask:0xc bank_mask:0xf
  s_nop 0
  v_readlane_b32 s68, v7, 63
  s_nop 1
  v_mov_b32 v255, s70
  v_mul_f32 v255, s68, v255
  v_sub_f32 v255, 0, v255
  v_and_b32 v10, 0xffff0000, v254
  v_fma_f32 v10, v10, s70, v255
  v_exp_f32 v10, v10
  s_nop 0
  v_cvt_pk_bf16_f32 v252, v10, v10
  v_add_f32 v8, v8, v10
  s_nop 0
  v_and_b32_dpp v244, v252, v240 row_newbcast:0 row_mask:0xf bank_mask:0xf
  v_and_b32_dpp v245, v252, v241 row_newbcast:0 row_mask:0xf bank_mask:0xf
  v_and_b32_dpp v246, v252, v242 row_newbcast:0 row_mask:0xf bank_mask:0xf
  v_and_b32_dpp v247, v252, v243 row_newbcast:0 row_mask:0xf bank_mask:0xf
  s_mov_b32 s62, 16
L_vloop:
  s_mov_b32 s71, 0x200000
L_ls39:
  s_and_b32 s40, s92, 0xff
  s_sub_u32 s40, s40, 1
  s_cmp_gt_i32 s40, s62
  s_cbranch_scc1 L_vgo
  s_bitcmp1_b32 s92, 8
  s_cbranch_scc1 L_vdone
  ds_read_b32 v178, v176 offset:52
  s_sub_u32 s71, s71, 1
  s_cbranch_scc1 L_vdone
  s_waitcnt lgkmcnt(0)
  v_readfirstlane_b32 s92, v178
  s_branch L_ls39
L_vgo:
  v_add_u32 v185, 1024, v185
  ds_read_b32 v254, v185
  s_and_b32 s40, s63, 0xff
  s_cmp_lt_u32 s62, s40
  s_cselect_b32 s40, 8, 12
  s_lshr_b32 s41, s63, s40
  s_and_b32 s41, s41, 15
  s_add_u32 s62, s62, 1
  s_cmp_lt_u32 s41, 5
  s_cbranch_scc0 L_mt40
  s_cmp_lt_u32 s41, 2
  s_cbranch_scc0 L_mt41
  s_cmp_lt_u32 s41, 1
  s_cbranch_scc1 L_vm0
  s_branch L_vm1
L_mt41:
  s_cmp_lt_u32 s41, 3
  s_cbranch_scc1 L_vm2
  s_cmp_lt_u32 s41, 4
  s_cbranch_scc1 L_vm3
  s_branch L_vm4
L_mt40:
  s_cmp_lt_u32 s41, 7
  s_cbranch_scc0 L_mt45
  s_cmp_lt_u32 s41, 6
  s_cbranch_scc1 L_vm5
  s_branch L_vm6
L_mt45:
  s_cmp_lt_u32 s41, 8
  s_cbranch_scc1 L_vm7
  s_cmp_lt_u32 s41, 9
  s_cbranch_scc1 L_vm8
  s_branch L_vm9
L_vm0:
  s_memrealtime s[74:75]
  v_add_u32_dpp v183, v9, v5 row_newbcast:12 row_mask:0xf bank_mask:0xf
  s_waitcnt vmcnt(1)
  buffer_load_dwordx4 v[96:99], v183, s[48:51], 0 offen nt
  v_and_b32_dpp v248, v252, v240 row_newbcast:1 row_mask:0xf bank_mask:0xf
  v_and_b32_dpp v249, v252, v241 row_newbcast:1 row_mask:0xf bank_mask:0xf
  v_and_b32_dpp v250, v252, v242 row_newbcast:1 row_mask:0xf bank_mask:0xf
  v_and_b32_dpp v251, v252, v243 row_newbcast:1 row_mask:0xf bank_mask:0xf
  v_mfma_f32_16x16x32_bf16 v[28:31], v[244:247], v[48:51], v[28:31]
  v_add_u32_dpp v184, v9, v5 row_newbcast:13 row_mask:0xf bank_mask:0xf
  s_waitcnt vmcnt(1)
  buffer_load_dwordx4 v[100:103], v184, s[48:51], 0 offen nt
  v_and_b32_dpp v244, v252, v240 row_newbcast:2 row_mask:0xf bank_mask:0xf
  v_and_b32_dpp v245, v252, v241 row_newbcast:2 row_mask:0xf bank_mask:0xf
  v_and_b32_dpp v246, v252, v242 row_newbcast:2 row_mask:0xf bank_mask:0xf
  v_and_b32_dpp v247, v252, v243 row_newbcast:2 row_mask:0xf bank_mask:0xf
  v_mfma_f32_16x16x32_bf16 v[28:31], v[248:251], v[52:55], v[28:31]
  v_add_u32_dpp v183, v9, v5 row_newbcast:14 row_mask:0xf bank_mask:0xf
  s_waitcnt vmcnt(1)
  buffer_load_dwordx4 v[104:107], v183, s[48:51], 0 offen nt
  v_and_b32_dpp v248, v252, v240 row_newbcast:3 row_mask:0xf bank_mask:0xf
  v_and_b32_dpp v249, v252, v241 row_newbcast:3 row_mask:0xf bank_mask:0xf
  v_and_b32_dpp v250, v252, v242 row_newbcast:3 row_mask:0xf bank_mask:0xf
  v_and_b32_dpp v251, v252, v243 row_newbcast:3 row_mask:0xf bank_mask:0xf
  v_mfma_f32_16x16x32_bf16 v[28:31], v[244:247], v[56:59], v[28:31]
  v_add_u32_dpp v184, v9, v5 row_newbcast:15 row_mask:0xf bank_mask:0xf
  s_waitcnt vmcnt(1)
  buffer_load_dwordx4 v[108:111], v184, s[48:51], 0 offen nt
  s_waitcnt lgkmcnt(0)
  v_and_b32 v9, 0xffff, v254
  v_lshlrev_b32 v9, 6, v9
  v_and_b32_dpp v244, v252, v240 row_newbcast:4 row_mask:0xf bank_mask:0xf
  v_and_b32_dpp v245, v252, v241 row_newbcast:4 row_mask:0xf bank_mask:0xf
  v_and_b32_dpp v246, v252, v242 row_newbcast:4 row_mask:0xf bank_mask:0xf
  v_and_b32_dpp v247, v252, v243 row_newbcast:4 row_mask:0xf bank_mask:0xf
  v_mfma_f32_16x16x32_bf16 v[28:31], v[248:251], v[60:63], v[28:31]
  v_add_u32_dpp v183, v9, v5 row_newbcast:0 row_mask:0xf bank_mask:0xf
  s_waitcnt vmcnt(2)
  buffer_load_dwordx4 v[48:51], v183, s[48:51], 0 offen nt
  v_and_b32_dpp v248, v252, v240 row_newbcast:5 row_mask:0xf bank_mask:0xf
  v_and_b32_dpp v249, v252, v241 row_newbcast:5 row_mask:0xf bank_mask:0xf
  v_and_b32_dpp v250, v252, v242 row_newbcast:5 row_mask:0xf bank_mask:0xf
  v_and_b32_dpp v251, v252, v243 row_newbcast:5 row_mask:0xf bank_mask:0xf
  v_mfma_f32_16x16x32_bf16 v[28:31], v[244:247], v[64:67], v[28:31]
  v_add_u32_dpp v184, v9, v5 row_newbcast:1 row_mask:0xf bank_mask:0xf
  s_waitcnt vmcnt(2)
  buffer_load_dwordx4 v[52:55], v184, s[48:51], 0 offen nt
  v_and_b32_dpp v244, v252, v240 row_newbcast:6 row_mask:0xf bank_mask:0xf
  v_and_b32_dpp v245, v252, v241 row_newbcast:6 row_mask:0xf bank_mask:0xf
  v_and_b32_dpp v246, v252, v242 row_newbcast:6 row_mask:0xf bank_mask:0xf
  v_and_b32_dpp v247, v252, v243 row_newbcast:6 row_mask:0xf bank_mask:0xf
  v_mfma_f32_16x16x32_bf16 v[28:31], v[248:251], v[68:71], v[28:31]
  s_waitcnt lgkmcnt(0)
  s_andn2_b32 s74, s74, 15
  s_add_u32 s41, s41, 1
  s_or_b32 s74, s74, s41
  v_mov_b32 v182, s74
  v_mov_b32 v178, s62
  s_mov_b64 exec, 1
  ds_write_b32 v177, v182
  ds_write_b32 v180, v178
  s_mov_b64 exec, -1
  v_add_u32 v177, 4, v177
  v_add_u32_dpp v183, v9, v5 row_newbcast:2 row_mask:0xf bank_mask:0xf
  s_waitcnt vmcnt(2)
  buffer_load_dwordx4 v[56:59], v183, s[48:51], 0 offen nt
  v_and_b32_dpp v248, v252, v240 row_newbcast:7 row_mask:0xf bank_mask:0xf
  v_and_b32_dpp v249, v252, v241 row_newbcast:7 row_mask:0xf bank_mask:0xf
  v_and_b32_dpp v250, v252, v242 row_newbcast:7 row_mask:0xf bank_mask:0xf
  v_and_b32_dpp v251, v252, v243 row_newbcast:7 row_mask:0xf bank_mask:0xf
  v_mfma_f32_16x16x32_bf16 v[28:31], v[244:247], v[72:75], v[28:31]
  v_add_u32_dpp v184, v9, v5 row_newbcast:3 row_mask:0xf bank_mask:0xf
  s_waitcnt vmcnt(2)
  buffer_load_dwordx4 v[60:63], v184, s[48:51], 0 offen nt
  v_and_b32_dpp v244, v252, v240 row_newbcast:8 row_mask:0xf bank_mask:0xf
  v_and_b32_dpp v245, v252, v241 row_newbcast:8 row_mask:0xf bank_mask:0xf
  v_and_b32_dpp v246, v252, v242 row_newbcast:8 row_mask:0xf bank_mask:0xf
  v_and_b32_dpp v247, v252, v243 row_newbcast:8 row_mask:0xf bank_mask:0xf
  v_mfma_f32_16x16x32_bf16 v[28:31], v[248:251], v[76:79], v[28:31]
  v_add_u32_dpp v183, v9, v5 row_newbcast:4 row_mask:0xf bank_mask:0xf
  s_waitcnt vmcnt(1)
  buffer_load_dwordx4 v[64:67], v183, s[48:51], 0 offen nt
  v_and_b32 v10, 0xffff0000, v254
  v_fma_f32 v10, v10, s70, v255
  v_exp_f32 v10, v10
  s_nop 0
  v_cvt_pk_bf16_f32 v253, v10, v10
  v_add_f32 v8, v8, v10
  v_and_b32_dpp v248, v252, v240 row_newbcast:9 row_mask:0xf bank_mask:0xf
  v_and_b32_dpp v249, v252, v241 row_newbcast:9 row_mask:0xf bank_mask:0xf
  v_and_b32_dpp v250, v252, v242 row_newbcast:9 row_mask:0xf bank_mask:0xf
  v_and_b32_dpp v251, v252, v243 row_newbcast:9 row_mask:0xf bank_mask:0xf
  v_mfma_f32_16x16x32_bf16 v[28:31], v[244:247], v[80:83], v[28:31]
  v_add_u32_dpp v184, v9, v5 row_newbcast:5 row_mask:0xf bank_mask:0xf
  s_waitcnt vmcnt(1)
  buffer_load_dwordx4 v[68:71], v184, s[48:51], 0 offen nt
  v_and_b32_dpp v244, v252, v240 row_newbcast:10 row_mask:0xf bank_mask:0xf
  v_and_b32_dpp v245, v252, v241 row_newbcast:10 row_mask:0xf bank_mask:0xf
  v_and_b32_dpp v246, v252, v242 row_newbcast:10 row_mask:0xf bank_mask:0xf
  v_and_b32_dpp v247, v252, v243 row_newbcast:10 row_mask:0xf bank_mask:0xf
  v_mfma_f32_16x16x32_bf16 v[28:31], v[248:251], v[84:87], v[28:31]
  v_add_u32_dpp v183, v9, v5 row_newbcast:6 row_mask:0xf bank_mask:0xf
  s_waitcnt vmcnt(1)
  buffer_load_dwordx4 v[72:75], v183, s[48:51], 0 offen nt
  v_and_b32_dpp v248, v252, v240 row_newbcast:11 row_mask:0xf bank_mask:0xf
  v_and_b32_dpp v249, v252, v241 row_newbcast:11 row_mask:0xf bank_mask:0xf
  v_and_b32_dpp v250, v252, v242 row_newbcast:11 row_mask:0xf bank_mask:0xf
  v_and_b32_dpp v251, v252, v243 row_newbcast:11 row_mask:0xf bank_mask:0xf
  v_mfma_f32_16x16x32_bf16 v[28:31], v[244:247], v[88:91], v[28:31]
  v_add_u32_dpp v184, v9, v5 row_newbcast:7 row_mask:0xf bank_mask:0xf
  s_waitcnt vmcnt(1)
  buffer_load_dwordx4 v[76:79], v184, s[48:51], 0 offen nt
  v_and_b32_dpp v244, v252, v240 row_newbcast:12 row_mask:0xf bank_mask:0xf
  v_and_b32_dpp v245, v252, v241 row_newbcast:12 row_mask:0xf bank_mask:0xf
  v_and_b32_dpp v246, v252, v242 row_newbcast:12 row_mask:0xf bank_mask:0xf
  v_and_b32_dpp v247, v252, v243 row_newbcast:12 row_mask:0xf bank_mask:0xf
  v_mfma_f32_16x16x32_bf16 v[28:31], v[248:251], v[92:95], v[28:31]
  ds_read_b64 v[178:179], v176 offset:48
  v_add_u32_dpp v183, v9, v5 row_newbcast:8 row_mask:0xf bank_mask:0xf
  s_waitcnt vmcnt(2)
  buffer_load_dwordx4 v[80:83], v183, s[48:51], 0 offen nt
  v_and_b32_dpp v248, v252, v240 row_newbcast:13 row_mask:0xf bank_mask:0xf
  v_and_b32_dpp v249, v252, v241 row_newbcast:13 row_mask:0xf bank_mask:0xf
  v_and_b32_dpp v250, v252, v242 row_newbcast:13 row_mask:0xf bank_mask:0xf
  v_and_b32_dpp v251, v252, v243 row_newbcast:13 row_mask:0xf bank_mask:0xf
  v_mfma_f32_16x16x32_bf16 v[28:31], v[244:247], v[96:99], v[28:31]
  v_add_u32_dpp v184, v9, v5 row_newbcast:9 row_mask:0xf bank_mask:0xf
  s_waitcnt vmcnt(2)
  buffer_load_dwordx4 v[84:87], v184, s[48:51], 0 offen nt
  v_and_b32_dpp v244, v252, v240 row_newbcast:14 row_mask:0xf bank_mask:0xf
  v_and_b32_dpp v245, v252, v241 row_newbcast:14 row_mask:0xf bank_mask:0xf
  v_and_b32_dpp v246, v252, v242 row_newbcast:14 row_mask:0xf bank_mask:0xf
  v_and_b32_dpp v247, v252, v243 row_newbcast:14 row_mask:0xf bank_mask:0xf
  v_mfma_f32_16x16x32_bf16 v[28:31], v[248:251], v[100:103], v[28:31]
  s_waitcnt lgkmcnt(0)
  v_readfirstlane_b32 s40, v178
  v_readfirstlane_b32 s92, v179
  v_add_u32_dpp v183, v9, v5 row_newbcast:10 row_mask:0xf bank_mask:0xf
  s_waitcnt vmcnt(2)
  buffer_load_dwordx4 v[88:91], v183, s[48:51], 0 offen nt
  v_and_b32_dpp v248, v252, v240 row_newbcast:15 row_mask:0xf bank_mask:0xf
  v_and_b32_dpp v249, v252, v241 row_newbcast:15 row_mask:0xf bank_mask:0xf
  v_and_b32_dpp v250, v252, v242 row_newbcast:15 row_mask:0xf bank_mask:0xf
  v_and_b32_dpp v251, v252, v243 row_newbcast:15 row_mask:0xf bank_mask:0xf
  v_mfma_f32_16x16x32_bf16 v[28:31], v[244:247], v[104:107], v[28:31]
  s_cmp_lg_u32 s40, 0
  s_cselect_b32 s63, s40, s63
  v_mov_b32 v252, v253
  v_add_u32_dpp v184, v9, v5 row_newbcast:11 row_mask:0xf bank_mask:0xf
  s_waitcnt vmcnt(2)
  buffer_load_dwordx4 v[92:95], v184, s[48:51], 0 offen nt
  v_and_b32_dpp v244, v252, v240 row_newbcast:0 row_mask:0xf bank_mask:0xf
  v_and_b32_dpp v245, v252, v241 row_newbcast:0 row_mask:0xf bank_mask:0xf
  v_and_b32_dpp v246, v252, v242 row_newbcast:0 row_mask:0xf bank_mask:0xf
  v_and_b32_dpp v247, v252, v243 row_newbcast:0 row_mask:0xf bank_mask:0xf
  v_mfma_f32_16x16x32_bf16 v[28:31], v[248:251], v[108:111], v[28:31]
  s_branch L_vloop
L_vm1:
  s_memrealtime s[74:75]
  v_add_u32_dpp v183, v9, v5 row_newbcast:12 row_mask:0xf bank_mask:0xf
  s_waitcnt vmcnt(2)
  buffer_load_dwordx4 v[96:99], v183, s[48:51], 0 offen nt
  v_and_b32_dpp v248, v252, v240 row_newbcast:1 row_mask:0xf bank_mask:0xf
  v_and_b32_dpp v249, v252, v241 row_newbcast:1 row_mask:0xf bank_mask:0xf
  v_and_b32_dpp v250, v252, v242 row_newbcast:1 row_mask:0xf bank_mask:0xf
  v_and_b32_dpp v251, v252, v243 row_newbcast:1 row_mask:0xf bank_mask:0xf
  v_mfma_f32_16x16x32_bf16 v[28:31], v[244:247], v[48:51], v[28:31]
  v_add_u32_dpp v184, v9, v5 row_newbcast:13 row_mask:0xf bank_mask:0xf
  s_waitcnt vmcnt(2)
  buffer_load_dwordx4 v[100:103], v184, s[48:51], 0 offen nt
  v_and_b32_dpp v244, v252, v240 row_newbcast:2 row_mask:0xf bank_mask:0xf
  v_and_b32_dpp v245, v252, v241 row_newbcast:2 row_mask:0xf bank_mask:0xf
  v_and_b32_dpp v246, v252, v242 row_newbcast:2 row_mask:0xf bank_mask:0xf
  v_and_b32_dpp v247, v252, v243 row_newbcast:2 row_mask:0xf bank_mask:0xf
  v_mfma_f32_16x16x32_bf16 v[28:31], v[248:251], v[52:55], v[28:31]
  v_add_u32_dpp v183, v9, v5 row_newbcast:14 row_mask:0xf bank_mask:0xf
  s_waitcnt vmcnt(2)
  buffer_load_dwordx4 v[104:107], v183, s[48:51], 0 offen nt
  v_and_b32_dpp v248, v252, v240 row_newbcast:3 row_mask:0xf bank_mask:0xf
  v_and_b32_dpp v249, v252, v241 row_newbcast:3 row_mask:0xf bank_mask:0xf
  v_and_b32_dpp v250, v252, v242 row_newbcast:3 row_mask:0xf bank_mask:0xf
  v_and_b32_dpp v251, v252, v243 row_newbcast:3 row_mask:0xf bank_mask:0xf
  v_mfma_f32_16x16x32_bf16 v[28:31], v[244:247], v[56:59], v[28:31]
  v_add_u32_dpp v184, v9, v5 row_newbcast:15 row_mask:0xf bank_mask:0xf
  s_waitcnt vmcnt(2)
  buffer_load_dwordx4 v[108:111], v184, s[48:51], 0 offen nt
  s_waitcnt lgkmcnt(0)
  v_and_b32 v9, 0xffff, v254
  v_lshlrev_b32 v9, 6, v9
  v_and_b32_dpp v244, v252, v240 row_newbcast:4 row_mask:0xf bank_mask:0xf
  v_and_b32_dpp v245, v252, v241 row_newbcast:4 row_mask:0xf bank_mask:0xf
  v_and_b32_dpp v246, v252, v242 row_newbcast:4 row_mask:0xf bank_mask:0xf
  v_and_b32_dpp v247, v252, v243 row_newbcast:4 row_mask:0xf bank_mask:0xf
  v_mfma_f32_16x16x32_bf16 v[28:31], v[248:251], v[60:63], v[28:31]
  v_add_u32_dpp v183, v9, v5 row_newbcast:0 row_mask:0xf bank_mask:0xf
  s_waitcnt vmcnt(2)
  buffer_load_dwordx4 v[48:51], v183, s[48:51], 0 offen nt
  v_and_b32_dpp v248, v252, v240 row_newbcast:5 row_mask:0xf bank_mask:0xf
  v_and_b32_dpp v249, v252, v241 row_newbcast:5 row_mask:0xf bank_mask:0xf
  v_and_b32_dpp v250, v252, v242 row_newbcast:5 row_mask:0xf bank_mask:0xf
  v_and_b32_dpp v251, v252, v243 row_newbcast:5 row_mask:0xf bank_mask:0xf
  v_mfma_f32_16x16x32_bf16 v[28:31], v[244:247], v[64:67], v[28:31]
  v_add_u32_dpp v184, v9, v5 row_newbcast:1 row_mask:0xf bank_mask:0xf
  s_waitcnt vmcnt(2)
  buffer_load_dwordx4 v[52:55], v184, s[48:51], 0 offen nt
  v_and_b32_dpp v244, v252, v240 row_newbcast:6 row_mask:0xf bank_mask:0xf
  v_and_b32_dpp v245, v252, v241 row_newbcast:6 row_mask:0xf bank_mask:0xf
  v_and_b32_dpp v246, v252, v242 row_newbcast:6 row_mask:0xf bank_mask:0xf
  v_and_b32_dpp v247, v252, v243 row_newbcast:6 row_mask:0xf bank_mask:0xf
  v_mfma_f32_16x16x32_bf16 v[28:31], v[248:251], v[68:71], v[28:31]
  s_waitcnt lgkmcnt(0)
  s_andn2_b32 s74, s74, 15
  s_add_u32 s41, s41, 1
  s_or_b32 s74, s74, s41
  v_mov_b32 v182, s74
  v_mov_b32 v178, s62
  s_mov_b64 exec, 1
  ds_write_b32 v177, v182
  ds_write_b32 v180, v178
  s_mov_b64 exec, -1
  v_add_u32 v177, 4, v177
  v_add_u32_dpp v183, v9, v5 row_newbcast:2 row_mask:0xf bank_mask:0xf
  s_waitcnt vmcnt(2)
  buffer_load_dwordx4 v[56:59], v183, s[48:51], 0 offen nt
  v_and_b32_dpp v248, v252, v240 row_newbcast:7 row_mask:0xf bank_mask:0xf
  v_and_b32_dpp v249, v252, v241 row_newbcast:7 row_mask:0xf bank_mask:0xf
  v_and_b32_dpp v250, v252, v242 row_newbcast:7 row_mask:0xf bank_mask:0xf
  v_and_b32_dpp v251, v252, v243 row_newbcast:7 row_mask:0xf bank_mask:0xf
  v_mfma_f32_16x16x32_bf16 v[28:31], v[244:247], v[72:75], v[28:31]
  v_add_u32_dpp v184, v9, v5 row_newbcast:3 row_mask:0xf bank_mask:0xf
  s_waitcnt vmcnt(2)
  buffer_load_dwordx4 v[60:63], v184, s[48:51], 0 offen nt
  v_and_b32_dpp v244, v252, v240 row_newbcast:8 row_mask:0xf bank_mask:0xf
  v_and_b32_dpp v245, v252, v241 row_newbcast:8 row_mask:0xf bank_mask:0xf
  v_and_b32_dpp v246, v252, v242 row_newbcast:8 row_mask:0xf bank_mask:0xf
  v_and_b32_dpp v247, v252, v243 row_newbcast:8 row_mask:0xf bank_mask:0xf
  v_mfma_f32_16x16x32_bf16 v[28:31], v[248:251], v[76:79], v[28:31]
  v_add_u32_dpp v183, v9, v5 row_newbcast:4 row_mask:0xf bank_mask:0xf
  s_waitcnt vmcnt(2)
  buffer_load_dwordx4 v[64:67], v183, s[48:51], 0 offen nt
  v_and_b32 v10, 0xffff0000, v254
  v_fma_f32 v10, v10, s70, v255
  v_exp_f32 v10, v10
  s_nop 0
  v_cvt_pk_bf16_f32 v253, v10, v10
  v_add_f32 v8, v8, v10
  v_and_b32_dpp v248, v252, v240 row_newbcast:9 row_mask:0xf bank_mask:0xf
  v_and_b32_dpp v249, v252, v241 row_newbcast:9 row_mask:0xf bank_mask:0xf
  v_and_b32_dpp v250, v252, v242 row_newbcast:9 row_mask:0xf bank_mask:0xf
  v_and_b32_dpp v251, v252, v243 row_newbcast:9 row_mask:0xf bank_mask:0xf
  v_mfma_f32_16x16x32_bf16 v[28:31], v[244:247], v[80:83], v[28:31]
  v_add_u32_dpp v184, v9, v5 row_newbcast:5 row_mask:0xf bank_mask:0xf
  s_waitcnt vmcnt(2)
  buffer_load_dwordx4 v[68:71], v184, s[48:51], 0 offen nt
  v_and_b32_dpp v244, v252, v240 row_newbcast:10 row_mask:0xf bank_mask:0xf
  v_and_b32_dpp v245, v252, v241 row_newbcast:10 row_mask:0xf bank_mask:0xf
  v_and_b32_dpp v246, v252, v242 row_newbcast:10 row_mask:0xf bank_mask:0xf
  v_and_b32_dpp v247, v252, v243 row_newbcast:10 row_mask:0xf bank_mask:0xf
  v_mfma_f32_16x16x32_bf16 v[28:31], v[248:251], v[84:87], v[28:31]
  v_add_u32_dpp v183, v9, v5 row_newbcast:6 row_mask:0xf bank_mask:0xf
  s_waitcnt vmcnt(2)
  buffer_load_dwordx4 v[72:75], v183, s[48:51], 0 offen nt
  v_and_b32_dpp v248, v252, v240 row_newbcast:11 row_mask:0xf bank_mask:0xf
  v_and_b32_dpp v249, v252, v241 row_newbcast:11 row_mask:0xf bank_mask:0xf
  v_and_b32_dpp v250, v252, v242 row_newbcast:11 row_mask:0xf bank_mask:0xf
  v_and_b32_dpp v251, v252, v243 row_newbcast:11 row_mask:0xf bank_mask:0xf
  v_mfma_f32_16x16x32_bf16 v[28:31], v[244:247], v[88:91], v[28:31]
  v_add_u32_dpp v184, v9, v5 row_newbcast:7 row_mask:0xf bank_mask:0xf
  s_waitcnt vmcnt(2)
  buffer_load_dwordx4 v[76:79], v184, s[48:51], 0 offen nt
  v_and_b32_dpp v244, v252, v240 row_newbcast:12 row_mask:0xf bank_mask:0xf
  v_and_b32_dpp v245, v252, v241 row_newbcast:12 row_mask:0xf bank_mask:0xf
  v_and_b32_dpp v246, v252, v242 row_newbcast:12 row_mask:0xf bank_mask:0xf
  v_and_b32_dpp v247, v252, v243 row_newbcast:12 row_mask:0xf bank_mask:0xf
  v_mfma_f32_16x16x32_bf16 v[28:31], v[248:251], v[92:95], v[28:31]
  ds_read_b64 v[178:179], v176 offset:48
  v_add_u32_dpp v183, v9, v5 row_newbcast:8 row_mask:0xf bank_mask:0xf
  s_waitcnt vmcnt(2)
  buffer_load_dwordx4 v[80:83], v183, s[48:51], 0 offen nt
  v_and_b32_dpp v248, v252, v240 row_newbcast:13 row_mask:0xf bank_mask:0xf
  v_and_b32_dpp v249, v252, v241 row_newbcast:13 row_mask:0xf bank_mask:0xf
  v_and_b32_dpp v250, v252, v242 row_newbcast:13 row_mask:0xf bank_mask:0xf
  v_and_b32_dpp v251, v252, v243 row_newbcast:13 row_mask:0xf bank_mask:0xf
  v_mfma_f32_16x16x32_bf16 v[28:31], v[244:247], v[96:99], v[28:31]
  v_add_u32_dpp v184, v9, v5 row_newbcast:9 row_mask:0xf bank_mask:0xf
  s_waitcnt vmcnt(2)
  buffer_load_dwordx4 v[84:87], v184, s[48:51], 0 offen nt
  v_and_b32_dpp v244, v252, v240 row_newbcast:14 row_mask:0xf bank_mask:0xf
  v_and_b32_dpp v245, v252, v241 row_newbcast:14 row_mask:0xf bank_mask:0xf
  v_and_b32_dpp v246, v252, v242 row_newbcast:14 row_mask:0xf bank_mask:0xf
  v_and_b32_dpp v247, v252, v243 row_newbcast:14 row_mask:0xf bank_mask:0xf
  v_mfma_f32_16x16x32_bf16 v[28:31], v[248:251], v[100:103], v[28:31]
  s_waitcnt lgkmcnt(0)
  v_readfirstlane_b32 s40, v178
  v_readfirstlane_b32 s92, v179
  v_add_u32_dpp v183, v9, v5 row_newbcast:10 row_mask:0xf bank_mask:0xf
  s_waitcnt vmcnt(2)
  buffer_load_dwordx4 v[88:91], v183, s[48:51], 0 offen nt
  v_and_b32_dpp v248, v252, v240 row_newbcast:15 row_mask:0xf bank_mask:0xf
  v_and_b32_dpp v249, v252, v241 row_newbcast:15 row_mask:0xf bank_mask:0xf
  v_and_b32_dpp v250, v252, v242 row_newbcast:15 row_mask:0xf bank_mask:0xf
  v_and_b32_dpp v251, v252, v243 row_newbcast:15 row_mask:0xf bank_mask:0xf
  v_mfma_f32_16x16x32_bf16 v[28:31], v[244:247], v[104:107], v[28:31]
  s_cmp_lg_u32 s40, 0
  s_cselect_b32 s63, s40, s63
  v_mov_b32 v252, v253
  v_add_u32_dpp v184, v9, v5 row_newbcast:11 row_mask:0xf bank_mask:0xf
  s_waitcnt vmcnt(2)
  buffer_load_dwordx4 v[92:95], v184, s[48:51], 0 offen nt
  v_and_b32_dpp v244, v252, v240 row_newbcast:0 row_mask:0xf bank_mask:0xf
  v_and_b32_dpp v245, v252, v241 row_newbcast:0 row_mask:0xf bank_mask:0xf
  v_and_b32_dpp v246, v252, v242 row_newbcast:0 row_mask:0xf bank_mask:0xf
  v_and_b32_dpp v247, v252, v243 row_newbcast:0 row_mask:0xf bank_mask:0xf
  v_mfma_f32_16x16x32_bf16 v[28:31], v[248:251], v[108:111], v[28:31]
  s_branch L_vloop
L_vm2:
  s_memrealtime s[74:75]
  v_add_u32_dpp v183, v9, v5 row_newbcast:12 row_mask:0xf bank_mask:0xf
  s_waitcnt vmcnt(2)
  buffer_load_dwordx4 v[96:99], v183, s[48:51], 0 offen nt
  v_and_b32_dpp v248, v252, v240 row_newbcast:1 row_mask:0xf bank_mask:0xf
  v_and_b32_dpp v249, v252, v241 row_newbcast:1 row_mask:0xf bank_mask:0xf
  v_and_b32_dpp v250, v252, v242 row_newbcast:1 row_mask:0xf bank_mask:0xf
  v_and_b32_dpp v251, v252, v243 row_newbcast:1 row_mask:0xf bank_mask:0xf
  v_mfma_f32_16x16x32_bf16 v[28:31], v[244:247], v[48:51], v[28:31]
  v_add_u32_dpp v184, v9, v5 row_newbcast:13 row_mask:0xf bank_mask:0xf
  s_waitcnt vmcnt(2)
  buffer_load_dwordx4 v[100:103], v184, s[48:51], 0 offen nt
  v_and_b32_dpp v244, v252, v240 row_newbcast:2 row_mask:0xf bank_mask:0xf
  v_and_b32_dpp v245, v252, v241 row_newbcast:2 row_mask:0xf bank_mask:0xf
  v_and_b32_dpp v246, v252, v242 row_newbcast:2 row_mask:0xf bank_mask:0xf
  v_and_b32_dpp v247, v252, v243 row_newbcast:2 row_mask:0xf bank_mask:0xf
  v_mfma_f32_16x16x32_bf16 v[28:31], v[248:251], v[52:55], v[28:31]
  v_add_u32_dpp v183, v9, v5 row_newbcast:14 row_mask:0xf bank_mask:0xf
  s_waitcnt vmcnt(2)
  buffer_load_dwordx4 v[104:107], v183, s[48:51], 0 offen nt
  v_and_b32_dpp v248, v252, v240 row_newbcast:3 row_mask:0xf bank_mask:0xf
  v_and_b32_dpp v249, v252, v241 row_newbcast:3 row_mask:0xf bank_mask:0xf
  v_and_b32_dpp v250, v252, v242 row_newbcast:3 row_mask:0xf bank_mask:0xf
  v_and_b32_dpp v251, v252, v243 row_newbcast:3 row_mask:0xf bank_mask:0xf
  v_mfma_f32_16x16x32_bf16 v[28:31], v[244:247], v[56:59], v[28:31]
  v_add_u32_dpp v184, v9, v5 row_newbcast:15 row_mask:0xf bank_mask:0xf
  s_waitcnt vmcnt(2)
  buffer_load_dwordx4 v[108:111], v184, s[48:51], 0 offen nt
  s_waitcnt lgkmcnt(0)
  v_and_b32 v9, 0xffff, v254
  v_lshlrev_b32 v9, 6, v9
  v_and_b32_dpp v244, v252, v240 row_newbcast:4 row_mask:0xf bank_mask:0xf
  v_and_b32_dpp v245, v252, v241 row_newbcast:4 row_mask:0xf bank_mask:0xf
  v_and_b32_dpp v246, v252, v242 row_newbcast:4 row_mask:0xf bank_mask:0xf
  v_and_b32_dpp v247, v252, v243 row_newbcast:4 row_mask:0xf bank_mask:0xf
  v_mfma_f32_16x16x32_bf16 v[28:31], v[248:251], v[60:63], v[28:31]
  v_add_u32_dpp v183, v9, v5 row_newbcast:0 row_mask:0xf bank_mask:0xf
  s_waitcnt vmcnt(3)
  buffer_load_dwordx4 v[48:51], v183, s[48:51], 0 offen nt
  v_and_b32_dpp v248, v252, v240 row_newbcast:5 row_mask:0xf bank_mask:0xf
  v_and_b32_dpp v249, v252, v241 row_newbcast:5 row_mask:0xf bank_mask:0xf
  v_and_b32_dpp v250, v252, v242 row_newbcast:5 row_mask:0xf bank_mask:0xf
  v_and_b32_dpp v251, v252, v243 row_newbcast:5 row_mask:0xf bank_mask:0xf
  v_mfma_f32_16x16x32_bf16 v[28:31], v[244:247], v[64:67], v[28:31]
  v_add_u32_dpp v184, v9, v5 row_newbcast:1 row_mask:0xf bank_mask:0xf
  s_waitcnt vmcnt(3)
  buffer_load_dwordx4 v[52:55], v184, s[48:51], 0 offen nt
  v_and_b32_dpp v244, v252, v240 row_newbcast:6 row_mask:0xf bank_mask:0xf
  v_and_b32_dpp v245, v252, v241 row_newbcast:6 row_mask:0xf bank_mask:0xf
  v_and_b32_dpp v246, v252, v242 row_newbcast:6 row_mask:0xf bank_mask:0xf
  v_and_b32_dpp v247, v252, v243 row_newbcast:6 row_mask:0xf bank_mask:0xf
  v_mfma_f32_16x16x32_bf16 v[28:31], v[248:251], v[68:71], v[28:31]
  s_waitcnt lgkmcnt(0)
  s_andn2_b32 s74, s74, 15
  s_add_u32 s41, s41, 1
  s_or_b32 s74, s74, s41
  v_mov_b32 v182, s74
  v_mov_b32 v178, s62
  s_mov_b64 exec, 1
  ds_write_b32 v177, v182
  ds_write_b32 v180, v178
  s_mov_b64 exec, -1
  v_add_u32 v177, 4, v177
  v_add_u32_dpp v183, v9, v5 row_newbcast:2 row_mask:0xf bank_mask:0xf
  s_waitcnt vmcnt(3)
  buffer_load_dwordx4 v[56:59], v183, s[48:51], 0 offen nt
  v_and_b32_dpp v248, v252, v240 row_newbcast:7 row_mask:0xf bank_mask:0xf
  v_and_b32_dpp v249, v252, v241 row_newbcast:7 row_mask:0xf bank_mask:0xf
  v_and_b32_dpp v250, v252, v242 row_newbcast:7 row_mask:0xf bank_mask:0xf
  v_and_b32_dpp v251, v252, v243 row_newbcast:7 row_mask:0xf bank_mask:0xf
  v_mfma_f32_16x16x32_bf16 v[28:31], v[244:247], v[72:75], v[28:31]
  v_add_u32_dpp v184, v9, v5 row_newbcast:3 row_mask:0xf bank_mask:0xf
  s_waitcnt vmcnt(3)
  buffer_load_dwordx4 v[60:63], v184, s[48:51], 0 offen nt
  v_and_b32_dpp v244, v252, v240 row_newbcast:8 row_mask:0xf bank_mask:0xf
  v_and_b32_dpp v245, v252, v241 row_newbcast:8 row_mask:0xf bank_mask:0xf
  v_and_b32_dpp v246, v252, v242 row_newbcast:8 row_mask:0xf bank_mask:0xf
  v_and_b32_dpp v247, v252, v243 row_newbcast:8 row_mask:0xf bank_mask:0xf
  v_mfma_f32_16x16x32_bf16 v[28:31], v[248:251], v[76:79], v[28:31]
  v_add_u32_dpp v183, v9, v5 row_newbcast:4 row_mask:0xf bank_mask:0xf
  s_waitcnt vmcnt(2)
  buffer_load_dwordx4 v[64:67], v183, s[48:51], 0 offen nt
  v_and_b32 v10, 0xffff0000, v254
  v_fma_f32 v10, v10, s70, v255
  v_exp_f32 v10, v10
  s_nop 0
  v_cvt_pk_bf16_f32 v253, v10, v10
  v_add_f32 v8, v8, v10
  v_and_b32_dpp v248, v252, v240 row_newbcast:9 row_mask:0xf bank_mask:0xf
  v_and_b32_dpp v249, v252, v241 row_newbcast:9 row_mask:0xf bank_mask:0xf
  v_and_b32_dpp v250, v252, v242 row_newbcast:9 row_mask:0xf bank_mask:0xf
  v_and_b32_dpp v251, v252, v243 row_newbcast:9 row_mask:0xf bank_mask:0xf
  v_mfma_f32_16x16x32_bf16 v[28:31], v[244:247], v[80:83], v[28:31]
  v_add_u32_dpp v184, v9, v5 row_newbcast:5 row_mask:0xf bank_mask:0xf
  s_waitcnt vmcnt(2)
  buffer_load_dwordx4 v[68:71], v184, s[48:51], 0 offen nt
  v_and_b32_dpp v244, v252, v240 row_newbcast:10 row_mask:0xf bank_mask:0xf
  v_and_b32_dpp v245, v252, v241 row_newbcast:10 row_mask:0xf bank_mask:0xf
  v_and_b32_dpp v246, v252, v242 row_newbcast:10 row_mask:0xf bank_mask:0xf
  v_and_b32_dpp v247, v252, v243 row_newbcast:10 row_mask:0xf bank_mask:0xf
  v_mfma_f32_16x16x32_bf16 v[28:31], v[248:251], v[84:87], v[28:31]
  v_add_u32_dpp v183, v9, v5 row_newbcast:6 row_mask:0xf bank_mask:0xf
  s_waitcnt vmcnt(2)
  buffer_load_dwordx4 v[72:75], v183, s[48:51], 0 offen nt
  v_and_b32_dpp v248, v252, v240 row_newbcast:11 row_mask:0xf bank_mask:0xf
  v_and_b32_dpp v249, v252, v241 row_newbcast:11 row_mask:0xf bank_mask:0xf
  v_and_b32_dpp v250, v252, v242 row_newbcast:11 row_mask:0xf bank_mask:0xf
  v_and_b32_dpp v251, v252, v243 row_newbcast:11 row_mask:0xf bank_mask:0xf
  v_mfma_f32_16x16x32_bf16 v[28:31], v[244:247], v[88:91], v[28:31]
  v_add_u32_dpp v184, v9, v5 row_newbcast:7 row_mask:0xf bank_mask:0xf
  s_waitcnt vmcnt(2)
  buffer_load_dwordx4 v[76:79], v184, s[48:51], 0 offen nt
  v_and_b32_dpp v244, v252, v240 row_newbcast:12 row_mask:0xf bank_mask:0xf
  v_and_b32_dpp v245, v252, v241 row_newbcast:12 row_mask:0xf bank_mask:0xf
  v_and_b32_dpp v246, v252, v242 row_newbcast:12 row_mask:0xf bank_mask:0xf
  v_and_b32_dpp v247, v252, v243 row_newbcast:12 row_mask:0xf bank_mask:0xf
  v_mfma_f32_16x16x32_bf16 v[28:31], v[248:251], v[92:95], v[28:31]
  ds_read_b64 v[178:179], v176 offset:48
  v_add_u32_dpp v183, v9, v5 row_newbcast:8 row_mask:0xf bank_mask:0xf
  s_waitcnt vmcnt(3)
  buffer_load_dwordx4 v[80:83], v183, s[48:51], 0 offen nt
  v_and_b32_dpp v248, v252, v240 row_newbcast:13 row_mask:0xf bank_mask:0xf
  v_and_b32_dpp v249, v252, v241 row_newbcast:13 row_mask:0xf bank_mask:0xf
  v_and_b32_dpp v250, v252, v242 row_newbcast:13 row_mask:0xf bank_mask:0xf
  v_and_b32_dpp v251, v252, v243 row_newbcast:13 row_mask:0xf bank_mask:0xf
  v_mfma_f32_16x16x32_bf16 v[28:31], v[244:247], v[96:99], v[28:31]
  v_add_u32_dpp v184, v9, v5 row_newbcast:9 row_mask:0xf bank_mask:0xf
  s_waitcnt vmcnt(3)
  buffer_load_dwordx4 v[84:87], v184, s[48:51], 0 offen nt
  v_and_b32_dpp v244, v252, v240 row_newbcast:14 row_mask:0xf bank_mask:0xf
  v_and_b32_dpp v245, v252, v241 row_newbcast:14 row_mask:0xf bank_mask:0xf
  v_and_b32_dpp v246, v252, v242 row_newbcast:14 row_mask:0xf bank_mask:0xf
  v_and_b32_dpp v247, v252, v243 row_newbcast:14 row_mask:0xf bank_mask:0xf
  v_mfma_f32_16x16x32_bf16 v[28:31], v[248:251], v[100:103], v[28:31]
  s_waitcnt lgkmcnt(0)
  v_readfirstlane_b32 s40, v178
  v_readfirstlane_b32 s92, v179
  v_add_u32_dpp v183, v9, v5 row_newbcast:10 row_mask:0xf bank_mask:0xf
  s_waitcnt vmcnt(3)
  buffer_load_dwordx4 v[88:91], v183, s[48:51], 0 offen nt
  v_and_b32_dpp v248, v252, v240 row_newbcast:15 row_mask:0xf bank_mask:0xf
  v_and_b32_dpp v249, v252, v241 row_newbcast:15 row_mask:0xf bank_mask:0xf
  v_and_b32_dpp v250, v252, v242 row_newbcast:15 row_mask:0xf bank_mask:0xf
  v_and_b32_dpp v251, v252, v243 row_newbcast:15 row_mask:0xf bank_mask:0xf
  v_mfma_f32_16x16x32_bf16 v[28:31], v[244:247], v[104:107], v[28:31]
  s_cmp_lg_u32 s40, 0
  s_cselect_b32 s63, s40, s63
  v_mov_b32 v252, v253
  v_add_u32_dpp v184, v9, v5 row_newbcast:11 row_mask:0xf bank_mask:0xf
  s_waitcnt vmcnt(3)
  buffer_load_dwordx4 v[92:95], v184, s[48:51], 0 offen nt
  v_and_b32_dpp v244, v252, v240 row_newbcast:0 row_mask:0xf bank_mask:0xf
  v_and_b32_dpp v245, v252, v241 row_newbcast:0 row_mask:0xf bank_mask:0xf
  v_and_b32_dpp v246, v252, v242 row_newbcast:0 row_mask:0xf bank_mask:0xf
  v_and_b32_dpp v247, v252, v243 row_newbcast:0 row_mask:0xf bank_mask:0xf
  v_mfma_f32_16x16x32_bf16 v[28:31], v[248:251], v[108:111], v[28:31]
  s_branch L_vloop
L_vm3:
  s_memrealtime s[74:75]
  v_add_u32_dpp v183, v9, v5 row_newbcast:12 row_mask:0xf bank_mask:0xf
  s_waitcnt vmcnt(3)
  buffer_load_dwordx4 v[96:99], v183, s[48:51], 0 offen nt
  v_and_b32_dpp v248, v252, v240 row_newbcast:1 row_mask:0xf bank_mask:0xf
  v_and_b32_dpp v249, v252, v241 row_newbcast:1 row_mask:0xf bank_mask:0xf
  v_and_b32_dpp v250, v252, v242 row_newbcast:1 row_mask:0xf bank_mask:0xf
  v_and_b32_dpp v251, v252, v243 row_newbcast:1 row_mask:0xf bank_mask:0xf
  v_mfma_f32_16x16x32_bf16 v[28:31], v[244:247], v[48:51], v[28:31]
  v_add_u32_dpp v184, v9, v5 row_newbcast:13 row_mask:0xf bank_mask:0xf
  s_waitcnt vmcnt(3)
  buffer_load_dwordx4 v[100:103], v184, s[48:51], 0 offen nt
  v_and_b32_dpp v244, v252, v240 row_newbcast:2 row_mask:0xf bank_mask:0xf
  v_and_b32_dpp v245, v252, v241 row_newbcast:2 row_mask:0xf bank_mask:0xf
  v_and_b32_dpp v246, v252, v242 row_newbcast:2 row_mask:0xf bank_mask:0xf
  v_and_b32_dpp v247, v252, v243 row_newbcast:2 row_mask:0xf bank_mask:0xf
  v_mfma_f32_16x16x32_bf16 v[28:31], v[248:251], v[52:55], v[28:31]
  v_add_u32_dpp v183, v9, v5 row_newbcast:14 row_mask:0xf bank_mask:0xf
  s_waitcnt vmcnt(3)
  buffer_load_dwordx4 v[104:107], v183, s[48:51], 0 offen nt
  v_and_b32_dpp v248, v252, v240 row_newbcast:3 row_mask:0xf bank_mask:0xf
  v_and_b32_dpp v249, v252, v241 row_newbcast:3 row_mask:0xf bank_mask:0xf
  v_and_b32_dpp v250, v252, v242 row_newbcast:3 row_mask:0xf bank_mask:0xf
  v_and_b32_dpp v251, v252, v243 row_newbcast:3 row_mask:0xf bank_mask:0xf
  v_mfma_f32_16x16x32_bf16 v[28:31], v[244:247], v[56:59], v[28:31]
  v_add_u32_dpp v184, v9, v5 row_newbcast:15 row_mask:0xf bank_mask:0xf
  s_waitcnt vmcnt(3)
  buffer_load_dwordx4 v[108:111], v184, s[48:51], 0 offen nt
  s_waitcnt lgkmcnt(0)
  v_and_b32 v9, 0xffff, v254
  v_lshlrev_b32 v9, 6, v9
  v_and_b32_dpp v244, v252, v240 row_newbcast:4 row_mask:0xf bank_mask:0xf
  v_and_b32_dpp v245, v252, v241 row_newbcast:4 row_mask:0xf bank_mask:0xf
  v_and_b32_dpp v246, v252, v242 row_newbcast:4 row_mask:0xf bank_mask:0xf
  v_and_b32_dpp v247, v252, v243 row_newbcast:4 row_mask:0xf bank_mask:0xf
  v_mfma_f32_16x16x32_bf16 v[28:31], v[248:251], v[60:63], v[28:31]
  v_add_u32_dpp v183, v9, v5 row_newbcast:0 row_mask:0xf bank_mask:0xf
  s_waitcnt vmcnt(3)
  buffer_load_dwordx4 v[48:51], v183, s[48:51], 0 offen nt
  v_and_b32_dpp v248, v252, v240 row_newbcast:5 row_mask:0xf bank_mask:0xf
  v_and_b32_dpp v249, v252, v241 row_newbcast:5 row_mask:0xf bank_mask:0xf
  v_and_b32_dpp v250, v252, v242 row_newbcast:5 row_mask:0xf bank_mask:0xf
  v_and_b32_dpp v251, v252, v243 row_newbcast:5 row_mask:0xf bank_mask:0xf
  v_mfma_f32_16x16x32_bf16 v[28:31], v[244:247], v[64:67], v[28:31]
  v_add_u32_dpp v184, v9, v5 row_newbcast:1 row_mask:0xf bank_mask:0xf
  s_waitcnt vmcnt(3)
  buffer_load_dwordx4 v[52:55], v184, s[48:51], 0 offen nt
  v_and_b32_dpp v244, v252, v240 row_newbcast:6 row_mask:0xf bank_mask:0xf
  v_and_b32_dpp v245, v252, v241 row_newbcast:6 row_mask:0xf bank_mask:0xf
  v_and_b32_dpp v246, v252, v242 row_newbcast:6 row_mask:0xf bank_mask:0xf
  v_and_b32_dpp v247, v252, v243 row_newbcast:6 row_mask:0xf bank_mask:0xf
  v_mfma_f32_16x16x32_bf16 v[28:31], v[248:251], v[68:71], v[28:31]
  s_waitcnt lgkmcnt(0)
  s_andn2_b32 s74, s74, 15
  s_add_u32 s41, s41, 1
  s_or_b32 s74, s74, s41
  v_mov_b32 v182, s74
  v_mov_b32 v178, s62
  s_mov_b64 exec, 1
  ds_write_b32 v177, v182
  ds_write_b32 v180, v178
  s_mov_b64 exec, -1
  v_add_u32 v177, 4, v177
  v_add_u32_dpp v183, v9, v5 row_newbcast:2 row_mask:0xf bank_mask:0xf
  s_waitcnt vmcnt(3)
  buffer_load_dwordx4 v[56:59], v183, s[48:51], 0 offen nt
  v_and_b32_dpp v248, v252, v240 row_newbcast:7 row_mask:0xf bank_mask:0xf
  v_and_b32_dpp v249, v252, v241 row_newbcast:7 row_mask:0xf bank_mask:0xf
  v_and_b32_dpp v250, v252, v242 row_newbcast:7 row_mask:0xf bank_mask:0xf
  v_and_b32_dpp v251, v252, v243 row_newbcast:7 row_mask:0xf bank_mask:0xf
  v_mfma_f32_16x16x32_bf16 v[28:31], v[244:247], v[72:75], v[28:31]
  v_add_u32_dpp v184, v9, v5 row_newbcast:3 row_mask:0xf bank_mask:0xf
  s_waitcnt vmcnt(3)
  buffer_load_dwordx4 v[60:63], v184, s[48:51], 0 offen nt
  v_and_b32_dpp v244, v252, v240 row_newbcast:8 row_mask:0xf bank_mask:0xf
  v_and_b32_dpp v245, v252, v241 row_newbcast:8 row_mask:0xf bank_mask:0xf
  v_and_b32_dpp v246, v252, v242 row_newbcast:8 row_mask:0xf bank_mask:0xf
  v_and_b32_dpp v247, v252, v243 row_newbcast:8 row_mask:0xf bank_mask:0xf
  v_mfma_f32_16x16x32_bf16 v[28:31], v[248:251], v[76:79], v[28:31]
  v_add_u32_dpp v183, v9, v5 row_newbcast:4 row_mask:0xf bank_mask:0xf
  s_waitcnt vmcnt(3)
  buffer_load_dwordx4 v[64:67], v183, s[48:51], 0 offen nt
  v_and_b32 v10, 0xffff0000, v254
  v_fma_f32 v10, v10, s70, v255
  v_exp_f32 v10, v10
  s_nop 0
  v_cvt_pk_bf16_f32 v253, v10, v10
  v_add_f32 v8, v8, v10
  v_and_b32_dpp v248, v252, v240 row_newbcast:9 row_mask:0xf bank_mask:0xf
  v_and_b32_dpp v249, v252, v241 row_newbcast:9 row_mask:0xf bank_mask:0xf
  v_and_b32_dpp v250, v252, v242 row_newbcast:9 row_mask:0xf bank_mask:0xf
  v_and_b32_dpp v251, v252, v243 row_newbcast:9 row_mask:0xf bank_mask:0xf
  v_mfma_f32_16x16x32_bf16 v[28:31], v[244:247], v[80:83], v[28:31]
  v_add_u32_dpp v184, v9, v5 row_newbcast:5 row_mask:0xf bank_mask:0xf
  s_waitcnt vmcnt(3)
  buffer_load_dwordx4 v[68:71], v184, s[48:51], 0 offen nt
  v_and_b32_dpp v244, v252, v240 row_newbcast:10 row_mask:0xf bank_mask:0xf
  v_and_b32_dpp v245, v252, v241 row_newbcast:10 row_mask:0xf bank_mask:0xf
  v_and_b32_dpp v246, v252, v242 row_newbcast:10 row_mask:0xf bank_mask:0xf
  v_and_b32_dpp v247, v252, v243 row_newbcast:10 row_mask:0xf bank_mask:0xf
  v_mfma_f32_16x16x32_bf16 v[28:31], v[248:251], v[84:87], v[28:31]
  v_add_u32_dpp v183, v9, v5 row_newbcast:6 row_mask:0xf bank_mask:0xf
  s_waitcnt vmcnt(3)
  buffer_load_dwordx4 v[72:75], v183, s[48:51], 0 offen nt
  v_and_b32_dpp v248, v252, v240 row_newbcast:11 row_mask:0xf bank_mask:0xf
  v_and_b32_dpp v249, v252, v241 row_newbcast:11 row_mask:0xf bank_mask:0xf
  v_and_b32_dpp v250, v252, v242 row_newbcast:11 row_mask:0xf bank_mask:0xf
  v_and_b32_dpp v251, v252, v243 row_newbcast:11 row_mask:0xf bank_mask:0xf
  v_mfma_f32_16x16x32_bf16 v[28:31], v[244:247], v[88:91], v[28:31]
  v_add_u32_dpp v184, v9, v5 row_newbcast:7 row_mask:0xf bank_mask:0xf
  s_waitcnt vmcnt(3)
  buffer_load_dwordx4 v[76:79], v184, s[48:51], 0 offen nt
  v_and_b32_dpp v244, v252, v240 row_newbcast:12 row_mask:0xf bank_mask:0xf
  v_and_b32_dpp v245, v252, v241 row_newbcast:12 row_mask:0xf bank_mask:0xf
  v_and_b32_dpp v246, v252, v242 row_newbcast:12 row_mask:0xf bank_mask:0xf
  v_and_b32_dpp v247, v252, v243 row_newbcast:12 row_mask:0xf bank_mask:0xf
  v_mfma_f32_16x16x32_bf16 v[28:31], v[248:251], v[92:95], v[28:31]
  ds_read_b64 v[178:179], v176 offset:48
  v_add_u32_dpp v183, v9, v5 row_newbcast:8 row_mask:0xf bank_mask:0xf
  s_waitcnt vmcnt(3)
  buffer_load_dwordx4 v[80:83], v183, s[48:51], 0 offen nt
  v_and_b32_dpp v248, v252, v240 row_newbcast:13 row_mask:0xf bank_mask:0xf
  v_and_b32_dpp v249, v252, v241 row_newbcast:13 row_mask:0xf bank_mask:0xf
  v_and_b32_dpp v250, v252, v242 row_newbcast:13 row_mask:0xf bank_mask:0xf
  v_and_b32_dpp v251, v252, v243 row_newbcast:13 row_mask:0xf bank_mask:0xf
  v_mfma_f32_16x16x32_bf16 v[28:31], v[244:247], v[96:99], v[28:31]
  v_add_u32_dpp v184, v9, v5 row_newbcast:9 row_mask:0xf bank_mask:0xf
  s_waitcnt vmcnt(3)
  buffer_load_dwordx4 v[84:87], v184, s[48:51], 0 offen nt
  v_and_b32_dpp v244, v252, v240 row_newbcast:14 row_mask:0xf bank_mask:0xf
  v_and_b32_dpp v245, v252, v241 row_newbcast:14 row_mask:0xf bank_mask:0xf
  v_and_b32_dpp v246, v252, v242 row_newbcast:14 row_mask:0xf bank_mask:0xf
  v_and_b32_dpp v247, v252, v243 row_newbcast:14 row_mask:0xf bank_mask:0xf
  v_mfma_f32_16x16x32_bf16 v[28:31], v[248:251], v[100:103], v[28:31]
  s_waitcnt lgkmcnt(0)
  v_readfirstlane_b32 s40, v178
  v_readfirstlane_b32 s92, v179
  v_add_u32_dpp v183, v9, v5 row_newbcast:10 row_mask:0xf bank_mask:0xf
  s_waitcnt vmcnt(3)
  buffer_load_dwordx4 v[88:91], v183, s[48:51], 0 offen nt
  v_and_b32_dpp v248, v252, v240 row_newbcast:15 row_mask:0xf bank_mask:0xf
  v_and_b32_dpp v249, v252, v241 row_newbcast:15 row_mask:0xf bank_mask:0xf
  v_and_b32_dpp v250, v252, v242 row_newbcast:15 row_mask:0xf bank_mask:0xf
  v_and_b32_dpp v251, v252, v243 row_newbcast:15 row_mask:0xf bank_mask:0xf
  v_mfma_f32_16x16x32_bf16 v[28:31], v[244:247], v[104:107], v[28:31]
  s_cmp_lg_u32 s40, 0
  s_cselect_b32 s63, s40, s63
  v_mov_b32 v252, v253
  v_add_u32_dpp v184, v9, v5 row_newbcast:11 row_mask:0xf bank_mask:0xf
  s_waitcnt vmcnt(3)
  buffer_load_dwordx4 v[92:95], v184, s[48:51], 0 offen nt
  v_and_b32_dpp v244, v252, v240 row_newbcast:0 row_mask:0xf bank_mask:0xf
  v_and_b32_dpp v245, v252, v241 row_newbcast:0 row_mask:0xf bank_mask:0xf
  v_and_b32_dpp v246, v252, v242 row_newbcast:0 row_mask:0xf bank_mask:0xf
  v_and_b32_dpp v247, v252, v243 row_newbcast:0 row_mask:0xf bank_mask:0xf
  v_mfma_f32_16x16x32_bf16 v[28:31], v[248:251], v[108:111], v[28:31]
  s_branch L_vloop
L_vm4:
  s_memrealtime s[74:75]
  v_add_u32_dpp v183, v9, v5 row_newbcast:12 row_mask:0xf bank_mask:0xf
  s_waitcnt vmcnt(3)
  buffer_load_dwordx4 v[96:99], v183, s[48:51], 0 offen nt
  v_and_b32_dpp v248, v252, v240 row_newbcast:1 row_mask:0xf bank_mask:0xf
  v_and_b32_dpp v249, v252, v241 row_newbcast:1 row_mask:0xf bank_mask:0xf
  v_and_b32_dpp v250, v252, v242 row_newbcast:1 row_mask:0xf bank_mask:0xf
  v_and_b32_dpp v251, v252, v243 row_newbcast:1 row_mask:0xf bank_mask:0xf
  v_mfma_f32_16x16x32_bf16 v[28:31], v[244:247], v[48:51], v[28:31]
  v_add_u32_dpp v184, v9, v5 row_newbcast:13 row_mask:0xf bank_mask:0xf
  s_waitcnt vmcnt(3)
  buffer_load_dwordx4 v[100:103], v184, s[48:51], 0 offen nt
  v_and_b32_dpp v244, v252, v240 row_newbcast:2 row_mask:0xf bank_mask:0xf
  v_and_b32_dpp v245, v252, v241 row_newbcast:2 row_mask:0xf bank_mask:0xf
  v_and_b32_dpp v246, v252, v242 row_newbcast:2 row_mask:0xf bank_mask:0xf
  v_and_b32_dpp v247, v252, v243 row_newbcast:2 row_mask:0xf bank_mask:0xf
  v_mfma_f32_16x16x32_bf16 v[28:31], v[248:251], v[52:55], v[28:31]
  v_add_u32_dpp v183, v9, v5 row_newbcast:14 row_mask:0xf bank_mask:0xf
  s_waitcnt vmcnt(3)
  buffer_load_dwordx4 v[104:107], v183, s[48:51], 0 offen nt
  v_and_b32_dpp v248, v252, v240 row_newbcast:3 row_mask:0xf bank_mask:0xf
  v_and_b32_dpp v249, v252, v241 row_newbcast:3 row_mask:0xf bank_mask:0xf
  v_and_b32_dpp v250, v252, v242 row_newbcast:3 row_mask:0xf bank_mask:0xf
  v_and_b32_dpp v251, v252, v243 row_newbcast:3 row_mask:0xf bank_mask:0xf
  v_mfma_f32_16x16x32_bf16 v[28:31], v[244:247], v[56:59], v[28:31]
  v_add_u32_dpp v184, v9, v5 row_newbcast:15 row_mask:0xf bank_mask:0xf
  s_waitcnt vmcnt(3)
  buffer_load_dwordx4 v[108:111], v184, s[48:51], 0 offen nt
  s_waitcnt lgkmcnt(0)
  v_and_b32 v9, 0xffff, v254
  v_lshlrev_b32 v9, 6, v9
  v_and_b32_dpp v244, v252, v240 row_newbcast:4 row_mask:0xf bank_mask:0xf
  v_and_b32_dpp v245, v252, v241 row_newbcast:4 row_mask:0xf bank_mask:0xf
  v_and_b32_dpp v246, v252, v242 row_newbcast:4 row_mask:0xf bank_mask:0xf
  v_and_b32_dpp v247, v252, v243 row_newbcast:4 row_mask:0xf bank_mask:0xf
  v_mfma_f32_16x16x32_bf16 v[28:31], v[248:251], v[60:63], v[28:31]
  v_add_u32_dpp v183, v9, v5 row_newbcast:0 row_mask:0xf bank_mask:0xf
  s_waitcnt vmcnt(4)
  buffer_load_dwordx4 v[48:51], v183, s[48:51], 0 offen nt
  v_and_b32_dpp v248, v252, v240 row_newbcast:5 row_mask:0xf bank_mask:0xf
  v_and_b32_dpp v249, v252, v241 row_newbcast:5 row_mask:0xf bank_mask:0xf
  v_and_b32_dpp v250, v252, v242 row_newbcast:5 row_mask:0xf bank_mask:0xf
  v_and_b32_dpp v251, v252, v243 row_newbcast:5 row_mask:0xf bank_mask:0xf
  v_mfma_f32_16x16x32_bf16 v[28:31], v[244:247], v[64:67], v[28:31]
  v_add_u32_dpp v184, v9, v5 row_newbcast:1 row_mask:0xf bank_mask:0xf
  s_waitcnt vmcnt(4)
  buffer_load_dwordx4 v[52:55], v184, s[48:51], 0 offen nt
  v_and_b32_dpp v244, v252, v240 row_newbcast:6 row_mask:0xf bank_mask:0xf
  v_and_b32_dpp v245, v252, v241 row_newbcast:6 row_mask:0xf bank_mask:0xf
  v_and_b32_dpp v246, v252, v242 row_newbcast:6 row_mask:0xf bank_mask:0xf
  v_and_b32_dpp v247, v252, v243 row_newbcast:6 row_mask:0xf bank_mask:0xf
  v_mfma_f32_16x16x32_bf16 v[28:31], v[248:251], v[68:71], v[28:31]
  s_waitcnt lgkmcnt(0)
  s_andn2_b32 s74, s74, 15
  s_add_u32 s41, s41, 1
  s_or_b32 s74, s74, s41
  v_mov_b32 v182, s74
  v_mov_b32 v178, s62
  s_mov_b64 exec, 1
  ds_write_b32 v177, v182
  ds_write_b32 v180, v178
  s_mov_b64 exec, -1
  v_add_u32 v177, 4, v177
  v_add_u32_dpp v183, v9, v5 row_newbcast:2 row_mask:0xf bank_mask:0xf
  s_waitcnt vmcnt(4)
  buffer_load_dwordx4 v[56:59], v183, s[48:51], 0 offen nt
  v_and_b32_dpp v248, v252, v240 row_newbcast:7 row_mask:0xf bank_mask:0xf
  v_and_b32_dpp v249, v252, v241 row_newbcast:7 row_mask:0xf bank_mask:0xf
  v_and_b32_dpp v250, v252, v242 row_newbcast:7 row_mask:0xf bank_mask:0xf
  v_and_b32_dpp v251, v252, v243 row_newbcast:7 row_mask:0xf bank_mask:0xf
  v_mfma_f32_16x16x32_bf16 v[28:31], v[244:247], v[72:75], v[28:31]
  v_add_u32_dpp v184, v9, v5 row_newbcast:3 row_mask:0xf bank_mask:0xf
  s_waitcnt vmcnt(4)
  buffer_load_dwordx4 v[60:63], v184, s[48:51], 0 offen nt
  v_and_b32_dpp v244, v252, v240 row_newbcast:8 row_mask:0xf bank_mask:0xf
  v_and_b32_dpp v245, v252, v241 row_newbcast:8 row_mask:0xf bank_mask:0xf
  v_and_b32_dpp v246, v252, v242 row_newbcast:8 row_mask:0xf bank_mask:0xf
  v_and_b32_dpp v247, v252, v243 row_newbcast:8 row_mask:0xf bank_mask:0xf
  v_mfma_f32_16x16x32_bf16 v[28:31], v[248:251], v[76:79], v[28:31]
  v_add_u32_dpp v183, v9, v5 row_newbcast:4 row_mask:0xf bank_mask:0xf
  s_waitcnt vmcnt(3)
  buffer_load_dwordx4 v[64:67], v183, s[48:51], 0 offen nt
  v_and_b32 v10, 0xffff0000, v254
  v_fma_f32 v10, v10, s70, v255
  v_exp_f32 v10, v10
  s_nop 0
  v_cvt_pk_bf16_f32 v253, v10, v10
  v_add_f32 v8, v8, v10
  v_and_b32_dpp v248, v252, v240 row_newbcast:9 row_mask:0xf bank_mask:0xf
  v_and_b32_dpp v249, v252, v241 row_newbcast:9 row_mask:0xf bank_mask:0xf
  v_and_b32_dpp v250, v252, v242 row_newbcast:9 row_mask:0xf bank_mask:0xf
  v_and_b32_dpp v251, v252, v243 row_newbcast:9 row_mask:0xf bank_mask:0xf
  v_mfma_f32_16x16x32_bf16 v[28:31], v[244:247], v[80:83], v[28:31]
  v_add_u32_dpp v184, v9, v5 row_newbcast:5 row_mask:0xf bank_mask:0xf
  s_waitcnt vmcnt(3)
  buffer_load_dwordx4 v[68:71], v184, s[48:51], 0 offen nt
  v_and_b32_dpp v244, v252, v240 row_newbcast:10 row_mask:0xf bank_mask:0xf
  v_and_b32_dpp v245, v252, v241 row_newbcast:10 row_mask:0xf bank_mask:0xf
  v_and_b32_dpp v246, v252, v242 row_newbcast:10 row_mask:0xf bank_mask:0xf
  v_and_b32_dpp v247, v252, v243 row_newbcast:10 row_mask:0xf bank_mask:0xf
  v_mfma_f32_16x16x32_bf16 v[28:31], v[248:251], v[84:87], v[28:31]
  v_add_u32_dpp v183, v9, v5 row_newbcast:6 row_mask:0xf bank_mask:0xf
  s_waitcnt vmcnt(3)
  buffer_load_dwordx4 v[72:75], v183, s[48:51], 0 offen nt
  v_and_b32_dpp v248, v252, v240 row_newbcast:11 row_mask:0xf bank_mask:0xf
  v_and_b32_dpp v249, v252, v241 row_newbcast:11 row_mask:0xf bank_mask:0xf
  v_and_b32_dpp v250, v252, v242 row_newbcast:11 row_mask:0xf bank_mask:0xf
  v_and_b32_dpp v251, v252, v243 row_newbcast:11 row_mask:0xf bank_mask:0xf
  v_mfma_f32_16x16x32_bf16 v[28:31], v[244:247], v[88:91], v[28:31]
  v_add_u32_dpp v184, v9, v5 row_newbcast:7 row_mask:0xf bank_mask:0xf
  s_waitcnt vmcnt(3)
  buffer_load_dwordx4 v[76:79], v184, s[48:51], 0 offen nt
  v_and_b32_dpp v244, v252, v240 row_newbcast:12 row_mask:0xf bank_mask:0xf
  v_and_b32_dpp v245, v252, v241 row_newbcast:12 row_mask:0xf bank_mask:0xf
  v_and_b32_dpp v246, v252, v242 row_newbcast:12 row_mask:0xf bank_mask:0xf
  v_and_b32_dpp v247, v252, v243 row_newbcast:12 row_mask:0xf bank_mask:0xf
  v_mfma_f32_16x16x32_bf16 v[28:31], v[248:251], v[92:95], v[28:31]
  ds_read_b64 v[178:179], v176 offset:48
  v_add_u32_dpp v183, v9, v5 row_newbcast:8 row_mask:0xf bank_mask:0xf
  s_waitcnt vmcnt(4)
  buffer_load_dwordx4 v[80:83], v183, s[48:51], 0 offen nt
  v_and_b32_dpp v248, v252, v240 row_newbcast:13 row_mask:0xf bank_mask:0xf
  v_and_b32_dpp v249, v252, v241 row_newbcast:13 row_mask:0xf bank_mask:0xf
  v_and_b32_dpp v250, v252, v242 row_newbcast:13 row_mask:0xf bank_mask:0xf
  v_and_b32_dpp v251, v252, v243 row_newbcast:13 row_mask:0xf bank_mask:0xf
  v_mfma_f32_16x16x32_bf16 v[28:31], v[244:247], v[96:99], v[28:31]
  v_add_u32_dpp v184, v9, v5 row_newbcast:9 row_mask:0xf bank_mask:0xf
  s_waitcnt vmcnt(4)
  buffer_load_dwordx4 v[84:87], v184, s[48:51], 0 offen nt
  v_and_b32_dpp v244, v252, v240 row_newbcast:14 row_mask:0xf bank_mask:0xf
  v_and_b32_dpp v245, v252, v241 row_newbcast:14 row_mask:0xf bank_mask:0xf
  v_and_b32_dpp v246, v252, v242 row_newbcast:14 row_mask:0xf bank_mask:0xf
  v_and_b32_dpp v247, v252, v243 row_newbcast:14 row_mask:0xf bank_mask:0xf
  v_mfma_f32_16x16x32_bf16 v[28:31], v[248:251], v[100:103], v[28:31]
  s_waitcnt lgkmcnt(0)
  v_readfirstlane_b32 s40, v178
  v_readfirstlane_b32 s92, v179
  v_add_u32_dpp v183, v9, v5 row_newbcast:10 row_mask:0xf bank_mask:0xf
  s_waitcnt vmcnt(4)
  buffer_load_dwordx4 v[88:91], v183, s[48:51], 0 offen nt
  v_and_b32_dpp v248, v252, v240 row_newbcast:15 row_mask:0xf bank_mask:0xf
  v_and_b32_dpp v249, v252, v241 row_newbcast:15 row_mask:0xf bank_mask:0xf
  v_and_b32_dpp v250, v252, v242 row_newbcast:15 row_mask:0xf bank_mask:0xf
  v_and_b32_dpp v251, v252, v243 row_newbcast:15 row_mask:0xf bank_mask:0xf
  v_mfma_f32_16x16x32_bf16 v[28:31], v[244:247], v[104:107], v[28:31]
  s_cmp_lg_u32 s40, 0
  s_cselect_b32 s63, s40, s63
  v_mov_b32 v252, v253
  v_add_u32_dpp v184, v9, v5 row_newbcast:11 row_mask:0xf bank_mask:0xf
  s_waitcnt vmcnt(4)
  buffer_load_dwordx4 v[92:95], v184, s[48:51], 0 offen nt
  v_and_b32_dpp v244, v252, v240 row_newbcast:0 row_mask:0xf bank_mask:0xf
  v_and_b32_dpp v245, v252, v241 row_newbcast:0 row_mask:0xf bank_mask:0xf
  v_and_b32_dpp v246, v252, v242 row_newbcast:0 row_mask:0xf bank_mask:0xf
  v_and_b32_dpp v247, v252, v243 row_newbcast:0 row_mask:0xf bank_mask:0xf
  v_mfma_f32_16x16x32_bf16 v[28:31], v[248:251], v[108:111], v[28:31]
  s_branch L_vloop
L_vm5:
  s_memrealtime s[74:75]
  v_add_u32_dpp v183, v9, v5 row_newbcast:12 row_mask:0xf bank_mask:0xf
  s_waitcnt vmcnt(4)
  buffer_load_dwordx4 v[96:99], v183, s[48:51], 0 offen nt
  v_and_b32_dpp v248, v252, v240 row_newbcast:1 row_mask:0xf bank_mask:0xf
  v_and_b32_dpp v249, v252, v241 row_newbcast:1 row_mask:0xf bank_mask:0xf
  v_and_b32_dpp v250, v252, v242 row_newbcast:1 row_mask:0xf bank_mask:0xf
  v_and_b32_dpp v251, v252, v243 row_newbcast:1 row_mask:0xf bank_mask:0xf
  v_mfma_f32_16x16x32_bf16 v[28:31], v[244:247], v[48:51], v[28:31]
  v_add_u32_dpp v184, v9, v5 row_newbcast:13 row_mask:0xf bank_mask:0xf
  s_waitcnt vmcnt(4)
  buffer_load_dwordx4 v[100:103], v184, s[48:51], 0 offen nt
  v_and_b32_dpp v244, v252, v240 row_newbcast:2 row_mask:0xf bank_mask:0xf
  v_and_b32_dpp v245, v252, v241 row_newbcast:2 row_mask:0xf bank_mask:0xf
  v_and_b32_dpp v246, v252, v242 row_newbcast:2 row_mask:0xf bank_mask:0xf
  v_and_b32_dpp v247, v252, v243 row_newbcast:2 row_mask:0xf bank_mask:0xf
  v_mfma_f32_16x16x32_bf16 v[28:31], v[248:251], v[52:55], v[28:31]
  v_add_u32_dpp v183, v9, v5 row_newbcast:14 row_mask:0xf bank_mask:0xf
  s_waitcnt vmcnt(4)
  buffer_load_dwordx4 v[104:107], v183, s[48:51], 0 offen nt
  v_and_b32_dpp v248, v252, v240 row_newbcast:3 row_mask:0xf bank_mask:0xf
  v_and_b32_dpp v249, v252, v241 row_newbcast:3 row_mask:0xf bank_mask:0xf
  v_and_b32_dpp v250, v252, v242 row_newbcast:3 row_mask:0xf bank_mask:0xf
  v_and_b32_dpp v251, v252, v243 row_newbcast:3 row_mask:0xf bank_mask:0xf
  v_mfma_f32_16x16x32_bf16 v[28:31], v[244:247], v[56:59], v[28:31]
  v_add_u32_dpp v184, v9, v5 row_newbcast:15 row_mask:0xf bank_mask:0xf
  s_waitcnt vmcnt(4)
  buffer_load_dwordx4 v[108:111], v184, s[48:51], 0 offen nt
  s_waitcnt lgkmcnt(0)
  v_and_b32 v9, 0xffff, v254
  v_lshlrev_b32 v9, 6, v9
  v_and_b32_dpp v244, v252, v240 row_newbcast:4 row_mask:0xf bank_mask:0xf
  v_and_b32_dpp v245, v252, v241 row_newbcast:4 row_mask:0xf bank_mask:0xf
  v_and_b32_dpp v246, v252, v242 row_newbcast:4 row_mask:0xf bank_mask:0xf
  v_and_b32_dpp v247, v252, v243 row_newbcast:4 row_mask:0xf bank_mask:0xf
  v_mfma_f32_16x16x32_bf16 v[28:31], v[248:251], v[60:63], v[28:31]
  v_add_u32_dpp v183, v9, v5 row_newbcast:0 row_mask:0xf bank_mask:0xf
  s_waitcnt vmcnt(4)
  buffer_load_dwordx4 v[48:51], v183, s[48:51], 0 offen nt
  v_and_b32_dpp v248, v252, v240 row_newbcast:5 row_mask:0xf bank_mask:0xf
  v_and_b32_dpp v249, v252, v241 row_newbcast:5 row_mask:0xf bank_mask:0xf
  v_and_b32_dpp v250, v252, v242 row_newbcast:5 row_mask:0xf bank_mask:0xf
  v_and_b32_dpp v251, v252, v243 row_newbcast:5 row_mask:0xf bank_mask:0xf
  v_mfma_f32_16x16x32_bf16 v[28:31], v[244:247], v[64:67], v[28:31]
  v_add_u32_dpp v184, v9, v5 row_newbcast:1 row_mask:0xf bank_mask:0xf
  s_waitcnt vmcnt(4)
  buffer_load_dwordx4 v[52:55], v184, s[48:51], 0 offen nt
  v_and_b32_dpp v244, v252, v240 row_newbcast:6 row_mask:0xf bank_mask:0xf
  v_and_b32_dpp v245, v252, v241 row_newbcast:6 row_mask:0xf bank_mask:0xf
  v_and_b32_dpp v246, v252, v242 row_newbcast:6 row_mask:0xf bank_mask:0xf
  v_and_b32_dpp v247, v252, v243 row_newbcast:6 row_mask:0xf bank_mask:0xf
  v_mfma_f32_16x16x32_bf16 v[28:31], v[248:251], v[68:71], v[28:31]
  s_waitcnt lgkmcnt(0)
  s_andn2_b32 s74, s74, 15
  s_add_u32 s41, s41, 1
  s_or_b32 s74, s74, s41
  v_mov_b32 v182, s74
  v_mov_b32 v178, s62
  s_mov_b64 exec, 1
  ds_write_b32 v177, v182
  ds_write_b32 v180, v178
  s_mov_b64 exec, -1
  v_add_u32 v177, 4, v177
  v_add_u32_dpp v183, v9, v5 row_newbcast:2 row_mask:0xf bank_mask:0xf
  s_waitcnt vmcnt(4)
  buffer_load_dwordx4 v[56:59], v183, s[48:51], 0 offen nt
  v_and_b32_dpp v248, v252, v240 row_newbcast:7 row_mask:0xf bank_mask:0xf
  v_and_b32_dpp v249, v252, v241 row_newbcast:7 row_mask:0xf bank_mask:0xf
  v_and_b32_dpp v250, v252, v242 row_newbcast:7 row_mask:0xf bank_mask:0xf
  v_and_b32_dpp v251, v252, v243 row_newbcast:7 row_mask:0xf bank_mask:0xf
  v_mfma_f32_16x16x32_bf16 v[28:31], v[244:247], v[72:75], v[28:31]
  v_add_u32_dpp v184, v9, v5 row_newbcast:3 row_mask:0xf bank_mask:0xf
  s_waitcnt vmcnt(4)
  buffer_load_dwordx4 v[60:63], v184, s[48:51], 0 offen nt
  v_and_b32_dpp v244, v252, v240 row_newbcast:8 row_mask:0xf bank_mask:0xf
  v_and_b32_dpp v245, v252, v241 row_newbcast:8 row_mask:0xf bank_mask:0xf
  v_and_b32_dpp v246, v252, v242 row_newbcast:8 row_mask:0xf bank_mask:0xf
  v_and_b32_dpp v247, v252, v243 row_newbcast:8 row_mask:0xf bank_mask:0xf
  v_mfma_f32_16x16x32_bf16 v[28:31], v[248:251], v[76:79], v[28:31]
  v_add_u32_dpp v183, v9, v5 row_newbcast:4 row_mask:0xf bank_mask:0xf
  s_waitcnt vmcnt(4)
  buffer_load_dwordx4 v[64:67], v183, s[48:51], 0 offen nt
  v_and_b32 v10, 0xffff0000, v254
  v_fma_f32 v10, v10, s70, v255
  v_exp_f32 v10, v10
  s_nop 0
  v_cvt_pk_bf16_f32 v253, v10, v10
  v_add_f32 v8, v8, v10
  v_and_b32_dpp v248, v252, v240 row_newbcast:9 row_mask:0xf bank_mask:0xf
  v_and_b32_dpp v249, v252, v241 row_newbcast:9 row_mask:0xf bank_mask:0xf
  v_and_b32_dpp v250, v252, v242 row_newbcast:9 row_mask:0xf bank_mask:0xf
  v_and_b32_dpp v251, v252, v243 row_newbcast:9 row_mask:0xf bank_mask:0xf
  v_mfma_f32_16x16x32_bf16 v[28:31], v[244:247], v[80:83], v[28:31]
  v_add_u32_dpp v184, v9, v5 row_newbcast:5 row_mask:0xf bank_mask:0xf
  s_waitcnt vmcnt(4)
  buffer_load_dwordx4 v[68:71], v184, s[48:51], 0 offen nt
  v_and_b32_dpp v244, v252, v240 row_newbcast:10 row_mask:0xf bank_mask:0xf
  v_and_b32_dpp v245, v252, v241 row_newbcast:10 row_mask:0xf bank_mask:0xf
  v_and_b32_dpp v246, v252, v242 row_newbcast:10 row_mask:0xf bank_mask:0xf
  v_and_b32_dpp v247, v252, v243 row_newbcast:10 row_mask:0xf bank_mask:0xf
  v_mfma_f32_16x16x32_bf16 v[28:31], v[248:251], v[84:87], v[28:31]
  v_add_u32_dpp v183, v9, v5 row_newbcast:6 row_mask:0xf bank_mask:0xf
  s_waitcnt vmcnt(4)
  buffer_load_dwordx4 v[72:75], v183, s[48:51], 0 offen nt
  v_and_b32_dpp v248, v252, v240 row_newbcast:11 row_mask:0xf bank_mask:0xf
  v_and_b32_dpp v249, v252, v241 row_newbcast:11 row_mask:0xf bank_mask:0xf
  v_and_b32_dpp v250, v252, v242 row_newbcast:11 row_mask:0xf bank_mask:0xf
  v_and_b32_dpp v251, v252, v243 row_newbcast:11 row_mask:0xf bank_mask:0xf
  v_mfma_f32_16x16x32_bf16 v[28:31], v[244:247], v[88:91], v[28:31]
  v_add_u32_dpp v184, v9, v5 row_newbcast:7 row_mask:0xf bank_mask:0xf
  s_waitcnt vmcnt(4)
  buffer_load_dwordx4 v[76:79], v184, s[48:51], 0 offen nt
  v_and_b32_dpp v244, v252, v240 row_newbcast:12 row_mask:0xf bank_mask:0xf
  v_and_b32_dpp v245, v252, v241 row_newbcast:12 row_mask:0xf bank_mask:0xf
  v_and_b32_dpp v246, v252, v242 row_newbcast:12 row_mask:0xf bank_mask:0xf
  v_and_b32_dpp v247, v252, v243 row_newbcast:12 row_mask:0xf bank_mask:0xf
  v_mfma_f32_16x16x32_bf16 v[28:31], v[248:251], v[92:95], v[28:31]
  ds_read_b64 v[178:179], v176 offset:48
  v_add_u32_dpp v183, v9, v5 row_newbcast:8 row_mask:0xf bank_mask:0xf
  s_waitcnt vmcnt(4)
  buffer_load_dwordx4 v[80:83], v183, s[48:51], 0 offen nt
  v_and_b32_dpp v248, v252, v240 row_newbcast:13 row_mask:0xf bank_mask:0xf
  v_and_b32_dpp v249, v252, v241 row_newbcast:13 row_mask:0xf bank_mask:0xf
  v_and_b32_dpp v250, v252, v242 row_newbcast:13 row_mask:0xf bank_mask:0xf
  v_and_b32_dpp v251, v252, v243 row_newbcast:13 row_mask:0xf bank_mask:0xf
  v_mfma_f32_16x16x32_bf16 v[28:31], v[244:247], v[96:99], v[28:31]
  v_add_u32_dpp v184, v9, v5 row_newbcast:9 row_mask:0xf bank_mask:0xf
  s_waitcnt vmcnt(4)
  buffer_load_dwordx4 v[84:87], v184, s[48:51], 0 offen nt
  v_and_b32_dpp v244, v252, v240 row_newbcast:14 row_mask:0xf bank_mask:0xf
  v_and_b32_dpp v245, v252, v241 row_newbcast:14 row_mask:0xf bank_mask:0xf
  v_and_b32_dpp v246, v252, v242 row_newbcast:14 row_mask:0xf bank_mask:0xf
  v_and_b32_dpp v247, v252, v243 row_newbcast:14 row_mask:0xf bank_mask:0xf
  v_mfma_f32_16x16x32_bf16 v[28:31], v[248:251], v[100:103], v[28:31]
  s_waitcnt lgkmcnt(0)
  v_readfirstlane_b32 s40, v178
  v_readfirstlane_b32 s92, v179
  v_add_u32_dpp v183, v9, v5 row_newbcast:10 row_mask:0xf bank_mask:0xf
  s_waitcnt vmcnt(4)
  buffer_load_dwordx4 v[88:91], v183, s[48:51], 0 offen nt
  v_and_b32_dpp v248, v252, v240 row_newbcast:15 row_mask:0xf bank_mask:0xf
  v_and_b32_dpp v249, v252, v241 row_newbcast:15 row_mask:0xf bank_mask:0xf
  v_and_b32_dpp v250, v252, v242 row_newbcast:15 row_mask:0xf bank_mask:0xf
  v_and_b32_dpp v251, v252, v243 row_newbcast:15 row_mask:0xf bank_mask:0xf
  v_mfma_f32_16x16x32_bf16 v[28:31], v[244:247], v[104:107], v[28:31]
  s_cmp_lg_u32 s40, 0
  s_cselect_b32 s63, s40, s63
  v_mov_b32 v252, v253
  v_add_u32_dpp v184, v9, v5 row_newbcast:11 row_mask:0xf bank_mask:0xf
  s_waitcnt vmcnt(4)
  buffer_load_dwordx4 v[92:95], v184, s[48:51], 0 offen nt
  v_and_b32_dpp v244, v252, v240 row_newbcast:0 row_mask:0xf bank_mask:0xf
  v_and_b32_dpp v245, v252, v241 row_newbcast:0 row_mask:0xf bank_mask:0xf
  v_and_b32_dpp v246, v252, v242 row_newbcast:0 row_mask:0xf bank_mask:0xf
  v_and_b32_dpp v247, v252, v243 row_newbcast:0 row_mask:0xf bank_mask:0xf
  v_mfma_f32_16x16x32_bf16 v[28:31], v[248:251], v[108:111], v[28:31]
  s_branch L_vloop
L_vm6:
  s_memrealtime s[74:75]
  v_add_u32_dpp v183, v9, v5 row_newbcast:12 row_mask:0xf bank_mask:0xf
  s_waitcnt vmcnt(4)
  buffer_load_dwordx4 v[96:99], v183, s[48:51], 0 offen nt
  v_and_b32_dpp v248, v252, v240 row_newbcast:1 row_mask:0xf bank_mask:0xf
  v_and_b32_dpp v249, v252, v241 row_newbcast:1 row_mask:0xf bank_mask:0xf
  v_and_b32_dpp v250, v252, v242 row_newbcast:1 row_mask:0xf bank_mask:0xf
  v_and_b32_dpp v251, v252, v243 row_newbcast:1 row_mask:0xf bank_mask:0xf
  v_mfma_f32_16x16x32_bf16 v[28:31], v[244:247], v[48:51], v[28:31]
  v_add_u32_dpp v184, v9, v5 row_newbcast:13 row_mask:0xf bank_mask:0xf
  s_waitcnt vmcnt(4)
  buffer_load_dwordx4 v[100:103], v184, s[48:51], 0 offen nt
  v_and_b32_dpp v244, v252, v240 row_newbcast:2 row_mask:0xf bank_mask:0xf
  v_and_b32_dpp v245, v252, v241 row_newbcast:2 row_mask:0xf bank_mask:0xf
  v_and_b32_dpp v246, v252, v242 row_newbcast:2 row_mask:0xf bank_mask:0xf
  v_and_b32_dpp v247, v252, v243 row_newbcast:2 row_mask:0xf bank_mask:0xf
  v_mfma_f32_16x16x32_bf16 v[28:31], v[248:251], v[52:55], v[28:31]
  v_add_u32_dpp v183, v9, v5 row_newbcast:14 row_mask:0xf bank_mask:0xf
  s_waitcnt vmcnt(4)
  buffer_load_dwordx4 v[104:107], v183, s[48:51], 0 offen nt
  v_and_b32_dpp v248, v252, v240 row_newbcast:3 row_mask:0xf bank_mask:0xf
  v_and_b32_dpp v249, v252, v241 row_newbcast:3 row_mask:0xf bank_mask:0xf
  v_and_b32_dpp v250, v252, v242 row_newbcast:3 row_mask:0xf bank_mask:0xf
  v_and_b32_dpp v251, v252, v243 row_newbcast:3 row_mask:0xf bank_mask:0xf
  v_mfma_f32_16x16x32_bf16 v[28:31], v[244:247], v[56:59], v[28:31]
  v_add_u32_dpp v184, v9, v5 row_newbcast:15 row_mask:0xf bank_mask:0xf
  s_waitcnt vmcnt(4)
  buffer_load_dwordx4 v[108:111], v184, s[48:51], 0 offen nt
  s_waitcnt lgkmcnt(0)
  v_and_b32 v9, 0xffff, v254
  v_lshlrev_b32 v9, 6, v9
  v_and_b32_dpp v244, v252, v240 row_newbcast:4 row_mask:0xf bank_mask:0xf
  v_and_b32_dpp v245, v252, v241 row_newbcast:4 row_mask:0xf bank_mask:0xf
  v_and_b32_dpp v246, v252, v242 row_newbcast:4 row_mask:0xf bank_mask:0xf
  v_and_b32_dpp v247, v252, v243 row_newbcast:4 row_mask:0xf bank_mask:0xf
  v_mfma_f32_16x16x32_bf16 v[28:31], v[248:251], v[60:63], v[28:31]
  v_add_u32_dpp v183, v9, v5 row_newbcast:0 row_mask:0xf bank_mask:0xf
  s_waitcnt vmcnt(5)
  buffer_load_dwordx4 v[48:51], v183, s[48:51], 0 offen nt
  v_and_b32_dpp v248, v252, v240 row_newbcast:5 row_mask:0xf bank_mask:0xf
  v_and_b32_dpp v249, v252, v241 row_newbcast:5 row_mask:0xf bank_mask:0xf
  v_and_b32_dpp v250, v252, v242 row_newbcast:5 row_mask:0xf bank_mask:0xf
  v_and_b32_dpp v251, v252, v243 row_newbcast:5 row_mask:0xf bank_mask:0xf
  v_mfma_f32_16x16x32_bf16 v[28:31], v[244:247], v[64:67], v[28:31]
  v_add_u32_dpp v184, v9, v5 row_newbcast:1 row_mask:0xf bank_mask:0xf
  s_waitcnt vmcnt(5)
  buffer_load_dwordx4 v[52:55], v184, s[48:51], 0 offen nt
  v_and_b32_dpp v244, v252, v240 row_newbcast:6 row_mask:0xf bank_mask:0xf
  v_and_b32_dpp v245, v252, v241 row_newbcast:6 row_mask:0xf bank_mask:0xf
  v_and_b32_dpp v246, v252, v242 row_newbcast:6 row_mask:0xf bank_mask:0xf
  v_and_b32_dpp v247, v252, v243 row_newbcast:6 row_mask:0xf bank_mask:0xf
  v_mfma_f32_16x16x32_bf16 v[28:31], v[248:251], v[68:71], v[28:31]
  s_waitcnt lgkmcnt(0)
  s_andn2_b32 s74, s74, 15
  s_add_u32 s41, s41, 1
  s_or_b32 s74, s74, s41
  v_mov_b32 v182, s74
  v_mov_b32 v178, s62
  s_mov_b64 exec, 1
  ds_write_b32 v177, v182
  ds_write_b32 v180, v178
  s_mov_b64 exec, -1
  v_add_u32 v177, 4, v177
  v_add_u32_dpp v183, v9, v5 row_newbcast:2 row_mask:0xf bank_mask:0xf
  s_waitcnt vmcnt(5)
  buffer_load_dwordx4 v[56:59], v183, s[48:51], 0 offen nt
  v_and_b32_dpp v248, v252, v240 row_newbcast:7 row_mask:0xf bank_mask:0xf
  v_and_b32_dpp v249, v252, v241 row_newbcast:7 row_mask:0xf bank_mask:0xf
  v_and_b32_dpp v250, v252, v242 row_newbcast:7 row_mask:0xf bank_mask:0xf
  v_and_b32_dpp v251, v252, v243 row_newbcast:7 row_mask:0xf bank_mask:0xf
  v_mfma_f32_16x16x32_bf16 v[28:31], v[244:247], v[72:75], v[28:31]
  v_add_u32_dpp v184, v9, v5 row_newbcast:3 row_mask:0xf bank_mask:0xf
  s_waitcnt vmcnt(5)
  buffer_load_dwordx4 v[60:63], v184, s[48:51], 0 offen nt
  v_and_b32_dpp v244, v252, v240 row_newbcast:8 row_mask:0xf bank_mask:0xf
  v_and_b32_dpp v245, v252, v241 row_newbcast:8 row_mask:0xf bank_mask:0xf
  v_and_b32_dpp v246, v252, v242 row_newbcast:8 row_mask:0xf bank_mask:0xf
  v_and_b32_dpp v247, v252, v243 row_newbcast:8 row_mask:0xf bank_mask:0xf
  v_mfma_f32_16x16x32_bf16 v[28:31], v[248:251], v[76:79], v[28:31]
  v_add_u32_dpp v183, v9, v5 row_newbcast:4 row_mask:0xf bank_mask:0xf
  s_waitcnt vmcnt(4)
  buffer_load_dwordx4 v[64:67], v183, s[48:51], 0 offen nt
  v_and_b32 v10, 0xffff0000, v254
  v_fma_f32 v10, v10, s70, v255
  v_exp_f32 v10, v10
  s_nop 0
  v_cvt_pk_bf16_f32 v253, v10, v10
  v_add_f32 v8, v8, v10
  v_and_b32_dpp v248, v252, v240 row_newbcast:9 row_mask:0xf bank_mask:0xf
  v_and_b32_dpp v249, v252, v241 row_newbcast:9 row_mask:0xf bank_mask:0xf
  v_and_b32_dpp v250, v252, v242 row_newbcast:9 row_mask:0xf bank_mask:0xf
  v_and_b32_dpp v251, v252, v243 row_newbcast:9 row_mask:0xf bank_mask:0xf
  v_mfma_f32_16x16x32_bf16 v[28:31], v[244:247], v[80:83], v[28:31]
  v_add_u32_dpp v184, v9, v5 row_newbcast:5 row_mask:0xf bank_mask:0xf
  s_waitcnt vmcnt(4)
  buffer_load_dwordx4 v[68:71], v184, s[48:51], 0 offen nt
  v_and_b32_dpp v244, v252, v240 row_newbcast:10 row_mask:0xf bank_mask:0xf
  v_and_b32_dpp v245, v252, v241 row_newbcast:10 row_mask:0xf bank_mask:0xf
  v_and_b32_dpp v246, v252, v242 row_newbcast:10 row_mask:0xf bank_mask:0xf
  v_and_b32_dpp v247, v252, v243 row_newbcast:10 row_mask:0xf bank_mask:0xf
  v_mfma_f32_16x16x32_bf16 v[28:31], v[248:251], v[84:87], v[28:31]
  v_add_u32_dpp v183, v9, v5 row_newbcast:6 row_mask:0xf bank_mask:0xf
  s_waitcnt vmcnt(4)
  buffer_load_dwordx4 v[72:75], v183, s[48:51], 0 offen nt
  v_and_b32_dpp v248, v252, v240 row_newbcast:11 row_mask:0xf bank_mask:0xf
  v_and_b32_dpp v249, v252, v241 row_newbcast:11 row_mask:0xf bank_mask:0xf
  v_and_b32_dpp v250, v252, v242 row_newbcast:11 row_mask:0xf bank_mask:0xf
  v_and_b32_dpp v251, v252, v243 row_newbcast:11 row_mask:0xf bank_mask:0xf
  v_mfma_f32_16x16x32_bf16 v[28:31], v[244:247], v[88:91], v[28:31]
  v_add_u32_dpp v184, v9, v5 row_newbcast:7 row_mask:0xf bank_mask:0xf
  s_waitcnt vmcnt(4)
  buffer_load_dwordx4 v[76:79], v184, s[48:51], 0 offen nt
  v_and_b32_dpp v244, v252, v240 row_newbcast:12 row_mask:0xf bank_mask:0xf
  v_and_b32_dpp v245, v252, v241 row_newbcast:12 row_mask:0xf bank_mask:0xf
  v_and_b32_dpp v246, v252, v242 row_newbcast:12 row_mask:0xf bank_mask:0xf
  v_and_b32_dpp v247, v252, v243 row_newbcast:12 row_mask:0xf bank_mask:0xf
  v_mfma_f32_16x16x32_bf16 v[28:31], v[248:251], v[92:95], v[28:31]
  ds_read_b64 v[178:179], v176 offset:48
  v_add_u32_dpp v183, v9, v5 row_newbcast:8 row_mask:0xf bank_mask:0xf
  s_waitcnt vmcnt(5)
  buffer_load_dwordx4 v[80:83], v183, s[48:51], 0 offen nt
  v_and_b32_dpp v248, v252, v240 row_newbcast:13 row_mask:0xf bank_mask:0xf
  v_and_b32_dpp v249, v252, v241 row_newbcast:13 row_mask:0xf bank_mask:0xf
  v_and_b32_dpp v250, v252, v242 row_newbcast:13 row_mask:0xf bank_mask:0xf
  v_and_b32_dpp v251, v252, v243 row_newbcast:13 row_mask:0xf bank_mask:0xf
  v_mfma_f32_16x16x32_bf16 v[28:31], v[244:247], v[96:99], v[28:31]
  v_add_u32_dpp v184, v9, v5 row_newbcast:9 row_mask:0xf bank_mask:0xf
  s_waitcnt vmcnt(5)
  buffer_load_dwordx4 v[84:87], v184, s[48:51], 0 offen nt
  v_and_b32_dpp v244, v252, v240 row_newbcast:14 row_mask:0xf bank_mask:0xf
  v_and_b32_dpp v245, v252, v241 row_newbcast:14 row_mask:0xf bank_mask:0xf
  v_and_b32_dpp v246, v252, v242 row_newbcast:14 row_mask:0xf bank_mask:0xf
  v_and_b32_dpp v247, v252, v243 row_newbcast:14 row_mask:0xf bank_mask:0xf
  v_mfma_f32_16x16x32_bf16 v[28:31], v[248:251], v[100:103], v[28:31]
  s_waitcnt lgkmcnt(0)
  v_readfirstlane_b32 s40, v178
  v_readfirstlane_b32 s92, v179
  v_add_u32_dpp v183, v9, v5 row_newbcast:10 row_mask:0xf bank_mask:0xf
  s_waitcnt vmcnt(5)
  buffer_load_dwordx4 v[88:91], v183, s[48:51], 0 offen nt
  v_and_b32_dpp v248, v252, v240 row_newbcast:15 row_mask:0xf bank_mask:0xf
  v_and_b32_dpp v249, v252, v241 row_newbcast:15 row_mask:0xf bank_mask:0xf
  v_and_b32_dpp v250, v252, v242 row_newbcast:15 row_mask:0xf bank_mask:0xf
  v_and_b32_dpp v251, v252, v243 row_newbcast:15 row_mask:0xf bank_mask:0xf
  v_mfma_f32_16x16x32_bf16 v[28:31], v[244:247], v[104:107], v[28:31]
  s_cmp_lg_u32 s40, 0
  s_cselect_b32 s63, s40, s63
  v_mov_b32 v252, v253
  v_add_u32_dpp v184, v9, v5 row_newbcast:11 row_mask:0xf bank_mask:0xf
  s_waitcnt vmcnt(5)
  buffer_load_dwordx4 v[92:95], v184, s[48:51], 0 offen nt
  v_and_b32_dpp v244, v252, v240 row_newbcast:0 row_mask:0xf bank_mask:0xf
  v_and_b32_dpp v245, v252, v241 row_newbcast:0 row_mask:0xf bank_mask:0xf
  v_and_b32_dpp v246, v252, v242 row_newbcast:0 row_mask:0xf bank_mask:0xf
  v_and_b32_dpp v247, v252, v243 row_newbcast:0 row_mask:0xf bank_mask:0xf
  v_mfma_f32_16x16x32_bf16 v[28:31], v[248:251], v[108:111], v[28:31]
  s_branch L_vloop
L_vm7:
  s_memrealtime s[74:75]
  v_add_u32_dpp v183, v9, v5 row_newbcast:12 row_mask:0xf bank_mask:0xf
  s_waitcnt vmcnt(5)
  buffer_load_dwordx4 v[96:99], v183, s[48:51], 0 offen nt
  v_and_b32_dpp v248, v252, v240 row_newbcast:1 row_mask:0xf bank_mask:0xf
  v_and_b32_dpp v249, v252, v241 row_newbcast:1 row_mask:0xf bank_mask:0xf
  v_and_b32_dpp v250, v252, v242 row_newbcast:1 row_mask:0xf bank_mask:0xf
  v_and_b32_dpp v251, v252, v243 row_newbcast:1 row_mask:0xf bank_mask:0xf
  v_mfma_f32_16x16x32_bf16 v[28:31], v[244:247], v[48:51], v[28:31]
  v_add_u32_dpp v184, v9, v5 row_newbcast:13 row_mask:0xf bank_mask:0xf
  s_waitcnt vmcnt(5)
  buffer_load_dwordx4 v[100:103], v184, s[48:51], 0 offen nt
  v_and_b32_dpp v244, v252, v240 row_newbcast:2 row_mask:0xf bank_mask:0xf
  v_and_b32_dpp v245, v252, v241 row_newbcast:2 row_mask:0xf bank_mask:0xf
  v_and_b32_dpp v246, v252, v242 row_newbcast:2 row_mask:0xf bank_mask:0xf
  v_and_b32_dpp v247, v252, v243 row_newbcast:2 row_mask:0xf bank_mask:0xf
  v_mfma_f32_16x16x32_bf16 v[28:31], v[248:251], v[52:55], v[28:31]
  v_add_u32_dpp v183, v9, v5 row_newbcast:14 row_mask:0xf bank_mask:0xf
  s_waitcnt vmcnt(5)
  buffer_load_dwordx4 v[104:107], v183, s[48:51], 0 offen nt
  v_and_b32_dpp v248, v252, v240 row_newbcast:3 row_mask:0xf bank_mask:0xf
  v_and_b32_dpp v249, v252, v241 row_newbcast:3 row_mask:0xf bank_mask:0xf
  v_and_b32_dpp v250, v252, v242 row_newbcast:3 row_mask:0xf bank_mask:0xf
  v_and_b32_dpp v251, v252, v243 row_newbcast:3 row_mask:0xf bank_mask:0xf
  v_mfma_f32_16x16x32_bf16 v[28:31], v[244:247], v[56:59], v[28:31]
  v_add_u32_dpp v184, v9, v5 row_newbcast:15 row_mask:0xf bank_mask:0xf
  s_waitcnt vmcnt(5)
  buffer_load_dwordx4 v[108:111], v184, s[48:51], 0 offen nt
  s_waitcnt lgkmcnt(0)
  v_and_b32 v9, 0xffff, v254
  v_lshlrev_b32 v9, 6, v9
  v_and_b32_dpp v244, v252, v240 row_newbcast:4 row_mask:0xf bank_mask:0xf
  v_and_b32_dpp v245, v252, v241 row_newbcast:4 row_mask:0xf bank_mask:0xf
  v_and_b32_dpp v246, v252, v242 row_newbcast:4 row_mask:0xf bank_mask:0xf
  v_and_b32_dpp v247, v252, v243 row_newbcast:4 row_mask:0xf bank_mask:0xf
  v_mfma_f32_16x16x32_bf16 v[28:31], v[248:251], v[60:63], v[28:31]
  v_add_u32_dpp v183, v9, v5 row_newbcast:0 row_mask:0xf bank_mask:0xf
  s_waitcnt vmcnt(5)
  buffer_load_dwordx4 v[48:51], v183, s[48:51], 0 offen nt
  v_and_b32_dpp v248, v252, v240 row_newbcast:5 row_mask:0xf bank_mask:0xf
  v_and_b32_dpp v249, v252, v241 row_newbcast:5 row_mask:0xf bank_mask:0xf
  v_and_b32_dpp v250, v252, v242 row_newbcast:5 row_mask:0xf bank_mask:0xf
  v_and_b32_dpp v251, v252, v243 row_newbcast:5 row_mask:0xf bank_mask:0xf
  v_mfma_f32_16x16x32_bf16 v[28:31], v[244:247], v[64:67], v[28:31]
  v_add_u32_dpp v184, v9, v5 row_newbcast:1 row_mask:0xf bank_mask:0xf
  s_waitcnt vmcnt(5)
  buffer_load_dwordx4 v[52:55], v184, s[48:51], 0 offen nt
  v_and_b32_dpp v244, v252, v240 row_newbcast:6 row_mask:0xf bank_mask:0xf
  v_and_b32_dpp v245, v252, v241 row_newbcast:6 row_mask:0xf bank_mask:0xf
  v_and_b32_dpp v246, v252, v242 row_newbcast:6 row_mask:0xf bank_mask:0xf
  v_and_b32_dpp v247, v252, v243 row_newbcast:6 row_mask:0xf bank_mask:0xf
  v_mfma_f32_16x16x32_bf16 v[28:31], v[248:251], v[68:71], v[28:31]
  s_waitcnt lgkmcnt(0)
  s_andn2_b32 s74, s74, 15
  s_add_u32 s41, s41, 1
  s_or_b32 s74, s74, s41
  v_mov_b32 v182, s74
  v_mov_b32 v178, s62
  s_mov_b64 exec, 1
  ds_write_b32 v177, v182
  ds_write_b32 v180, v178
  s_mov_b64 exec, -1
  v_add_u32 v177, 4, v177
  v_add_u32_dpp v183, v9, v5 row_newbcast:2 row_mask:0xf bank_mask:0xf
  s_waitcnt vmcnt(5)
  buffer_load_dwordx4 v[56:59], v183, s[48:51], 0 offen nt
  v_and_b32_dpp v248, v252, v240 row_newbcast:7 row_mask:0xf bank_mask:0xf
  v_and_b32_dpp v249, v252, v241 row_newbcast:7 row_mask:0xf bank_mask:0xf
  v_and_b32_dpp v250, v252, v242 row_newbcast:7 row_mask:0xf bank_mask:0xf
  v_and_b32_dpp v251, v252, v243 row_newbcast:7 row_mask:0xf bank_mask:0xf
  v_mfma_f32_16x16x32_bf16 v[28:31], v[244:247], v[72:75], v[28:31]
  v_add_u32_dpp v184, v9, v5 row_newbcast:3 row_mask:0xf bank_mask:0xf
  s_waitcnt vmcnt(5)
  buffer_load_dwordx4 v[60:63], v184, s[48:51], 0 offen nt
  v_and_b32_dpp v244, v252, v240 row_newbcast:8 row_mask:0xf bank_mask:0xf
  v_and_b32_dpp v245, v252, v241 row_newbcast:8 row_mask:0xf bank_mask:0xf
  v_and_b32_dpp v246, v252, v242 row_newbcast:8 row_mask:0xf bank_mask:0xf
  v_and_b32_dpp v247, v252, v243 row_newbcast:8 row_mask:0xf bank_mask:0xf
  v_mfma_f32_16x16x32_bf16 v[28:31], v[248:251], v[76:79], v[28:31]
  v_add_u32_dpp v183, v9, v5 row_newbcast:4 row_mask:0xf bank_mask:0xf
  s_waitcnt vmcnt(5)
  buffer_load_dwordx4 v[64:67], v183, s[48:51], 0 offen nt
  v_and_b32 v10, 0xffff0000, v254
  v_fma_f32 v10, v10, s70, v255
  v_exp_f32 v10, v10
  s_nop 0
  v_cvt_pk_bf16_f32 v253, v10, v10
  v_add_f32 v8, v8, v10
  v_and_b32_dpp v248, v252, v240 row_newbcast:9 row_mask:0xf bank_mask:0xf
  v_and_b32_dpp v249, v252, v241 row_newbcast:9 row_mask:0xf bank_mask:0xf
  v_and_b32_dpp v250, v252, v242 row_newbcast:9 row_mask:0xf bank_mask:0xf
  v_and_b32_dpp v251, v252, v243 row_newbcast:9 row_mask:0xf bank_mask:0xf
  v_mfma_f32_16x16x32_bf16 v[28:31], v[244:247], v[80:83], v[28:31]
  v_add_u32_dpp v184, v9, v5 row_newbcast:5 row_mask:0xf bank_mask:0xf
  s_waitcnt vmcnt(5)
  buffer_load_dwordx4 v[68:71], v184, s[48:51], 0 offen nt
  v_and_b32_dpp v244, v252, v240 row_newbcast:10 row_mask:0xf bank_mask:0xf
  v_and_b32_dpp v245, v252, v241 row_newbcast:10 row_mask:0xf bank_mask:0xf
  v_and_b32_dpp v246, v252, v242 row_newbcast:10 row_mask:0xf bank_mask:0xf
  v_and_b32_dpp v247, v252, v243 row_newbcast:10 row_mask:0xf bank_mask:0xf
  v_mfma_f32_16x16x32_bf16 v[28:31], v[248:251], v[84:87], v[28:31]
  v_add_u32_dpp v183, v9, v5 row_newbcast:6 row_mask:0xf bank_mask:0xf
  s_waitcnt vmcnt(5)
  buffer_load_dwordx4 v[72:75], v183, s[48:51], 0 offen nt
  v_and_b32_dpp v248, v252, v240 row_newbcast:11 row_mask:0xf bank_mask:0xf
  v_and_b32_dpp v249, v252, v241 row_newbcast:11 row_mask:0xf bank_mask:0xf
  v_and_b32_dpp v250, v252, v242 row_newbcast:11 row_mask:0xf bank_mask:0xf
  v_and_b32_dpp v251, v252, v243 row_newbcast:11 row_mask:0xf bank_mask:0xf
  v_mfma_f32_16x16x32_bf16 v[28:31], v[244:247], v[88:91], v[28:31]
  v_add_u32_dpp v184, v9, v5 row_newbcast:7 row_mask:0xf bank_mask:0xf
  s_waitcnt vmcnt(5)
  buffer_load_dwordx4 v[76:79], v184, s[48:51], 0 offen nt
  v_and_b32_dpp v244, v252, v240 row_newbcast:12 row_mask:0xf bank_mask:0xf
  v_and_b32_dpp v245, v252, v241 row_newbcast:12 row_mask:0xf bank_mask:0xf
  v_and_b32_dpp v246, v252, v242 row_newbcast:12 row_mask:0xf bank_mask:0xf
  v_and_b32_dpp v247, v252, v243 row_newbcast:12 row_mask:0xf bank_mask:0xf
  v_mfma_f32_16x16x32_bf16 v[28:31], v[248:251], v[92:95], v[28:31]
  ds_read_b64 v[178:179], v176 offset:48
  v_add_u32_dpp v183, v9, v5 row_newbcast:8 row_mask:0xf bank_mask:0xf
  s_waitcnt vmcnt(5)
  buffer_load_dwordx4 v[80:83], v183, s[48:51], 0 offen nt
  v_and_b32_dpp v248, v252, v240 row_newbcast:13 row_mask:0xf bank_mask:0xf
  v_and_b32_dpp v249, v252, v241 row_newbcast:13 row_mask:0xf bank_mask:0xf
  v_and_b32_dpp v250, v252, v242 row_newbcast:13 row_mask:0xf bank_mask:0xf
  v_and_b32_dpp v251, v252, v243 row_newbcast:13 row_mask:0xf bank_mask:0xf
  v_mfma_f32_16x16x32_bf16 v[28:31], v[244:247], v[96:99], v[28:31]
  v_add_u32_dpp v184, v9, v5 row_newbcast:9 row_mask:0xf bank_mask:0xf
  s_waitcnt vmcnt(5)
  buffer_load_dwordx4 v[84:87], v184, s[48:51], 0 offen nt
  v_and_b32_dpp v244, v252, v240 row_newbcast:14 row_mask:0xf bank_mask:0xf
  v_and_b32_dpp v245, v252, v241 row_newbcast:14 row_mask:0xf bank_mask:0xf
  v_and_b32_dpp v246, v252, v242 row_newbcast:14 row_mask:0xf bank_mask:0xf
  v_and_b32_dpp v247, v252, v243 row_newbcast:14 row_mask:0xf bank_mask:0xf
  v_mfma_f32_16x16x32_bf16 v[28:31], v[248:251], v[100:103], v[28:31]
  s_waitcnt lgkmcnt(0)
  v_readfirstlane_b32 s40, v178
  v_readfirstlane_b32 s92, v179
  v_add_u32_dpp v183, v9, v5 row_newbcast:10 row_mask:0xf bank_mask:0xf
  s_waitcnt vmcnt(5)
  buffer_load_dwordx4 v[88:91], v183, s[48:51], 0 offen nt
  v_and_b32_dpp v248, v252, v240 row_newbcast:15 row_mask:0xf bank_mask:0xf
  v_and_b32_dpp v249, v252, v241 row_newbcast:15 row_mask:0xf bank_mask:0xf
  v_and_b32_dpp v250, v252, v242 row_newbcast:15 row_mask:0xf bank_mask:0xf
  v_and_b32_dpp v251, v252, v243 row_newbcast:15 row_mask:0xf bank_mask:0xf
  v_mfma_f32_16x16x32_bf16 v[28:31], v[244:247], v[104:107], v[28:31]
  s_cmp_lg_u32 s40, 0
  s_cselect_b32 s63, s40, s63
  v_mov_b32 v252, v253
  v_add_u32_dpp v184, v9, v5 row_newbcast:11 row_mask:0xf bank_mask:0xf
  s_waitcnt vmcnt(5)
  buffer_load_dwordx4 v[92:95], v184, s[48:51], 0 offen nt
  v_and_b32_dpp v244, v252, v240 row_newbcast:0 row_mask:0xf bank_mask:0xf
  v_and_b32_dpp v245, v252, v241 row_newbcast:0 row_mask:0xf bank_mask:0xf
  v_and_b32_dpp v246, v252, v242 row_newbcast:0 row_mask:0xf bank_mask:0xf
  v_and_b32_dpp v247, v252, v243 row_newbcast:0 row_mask:0xf bank_mask:0xf
  v_mfma_f32_16x16x32_bf16 v[28:31], v[248:251], v[108:111], v[28:31]
  s_branch L_vloop
L_vm8:
  s_memrealtime s[74:75]
  v_add_u32_dpp v183, v9, v5 row_newbcast:12 row_mask:0xf bank_mask:0xf
  s_waitcnt vmcnt(6)
  buffer_load_dwordx4 v[96:99], v183, s[48:51], 0 offen nt
  v_and_b32_dpp v248, v252, v240 row_newbcast:1 row_mask:0xf bank_mask:0xf
  v_and_b32_dpp v249, v252, v241 row_newbcast:1 row_mask:0xf bank_mask:0xf
  v_and_b32_dpp v250, v252, v242 row_newbcast:1 row_mask:0xf bank_mask:0xf
  v_and_b32_dpp v251, v252, v243 row_newbcast:1 row_mask:0xf bank_mask:0xf
  v_mfma_f32_16x16x32_bf16 v[28:31], v[244:247], v[48:51], v[28:31]
  v_add_u32_dpp v184, v9, v5 row_newbcast:13 row_mask:0xf bank_mask:0xf
  s_waitcnt vmcnt(6)
  buffer_load_dwordx4 v[100:103], v184, s[48:51], 0 offen nt
  v_and_b32_dpp v244, v252, v240 row_newbcast:2 row_mask:0xf bank_mask:0xf
  v_and_b32_dpp v245, v252, v241 row_newbcast:2 row_mask:0xf bank_mask:0xf
  v_and_b32_dpp v246, v252, v242 row_newbcast:2 row_mask:0xf bank_mask:0xf
  v_and_b32_dpp v247, v252, v243 row_newbcast:2 row_mask:0xf bank_mask:0xf
  v_mfma_f32_16x16x32_bf16 v[28:31], v[248:251], v[52:55], v[28:31]
  v_add_u32_dpp v183, v9, v5 row_newbcast:14 row_mask:0xf bank_mask:0xf
  s_waitcnt vmcnt(6)
  buffer_load_dwordx4 v[104:107], v183, s[48:51], 0 offen nt
  v_and_b32_dpp v248, v252, v240 row_newbcast:3 row_mask:0xf bank_mask:0xf
  v_and_b32_dpp v249, v252, v241 row_newbcast:3 row_mask:0xf bank_mask:0xf
  v_and_b32_dpp v250, v252, v242 row_newbcast:3 row_mask:0xf bank_mask:0xf
  v_and_b32_dpp v251, v252, v243 row_newbcast:3 row_mask:0xf bank_mask:0xf
  v_mfma_f32_16x16x32_bf16 v[28:31], v[244:247], v[56:59], v[28:31]
  v_add_u32_dpp v184, v9, v5 row_newbcast:15 row_mask:0xf bank_mask:0xf
  s_waitcnt vmcnt(6)
  buffer_load_dwordx4 v[108:111], v184, s[48:51], 0 offen nt
  s_waitcnt lgkmcnt(0)
  v_and_b32 v9, 0xffff, v254
  v_lshlrev_b32 v9, 6, v9
  v_and_b32_dpp v244, v252, v240 row_newbcast:4 row_mask:0xf bank_mask:0xf
  v_and_b32_dpp v245, v252, v241 row_newbcast:4 row_mask:0xf bank_mask:0xf
  v_and_b32_dpp v246, v252, v242 row_newbcast:4 row_mask:0xf bank_mask:0xf
  v_and_b32_dpp v247, v252, v243 row_newbcast:4 row_mask:0xf bank_mask:0xf
  v_mfma_f32_16x16x32_bf16 v[28:31], v[248:251], v[60:63], v[28:31]
  v_add_u32_dpp v183, v9, v5 row_newbcast:0 row_mask:0xf bank_mask:0xf
  s_waitcnt vmcnt(6)
  buffer_load_dwordx4 v[48:51], v183, s[48:51], 0 offen nt
  v_and_b32_dpp v248, v252, v240 row_newbcast:5 row_mask:0xf bank_mask:0xf
  v_and_b32_dpp v249, v252, v241 row_newbcast:5 row_mask:0xf bank_mask:0xf
  v_and_b32_dpp v250, v252, v242 row_newbcast:5 row_mask:0xf bank_mask:0xf
  v_and_b32_dpp v251, v252, v243 row_newbcast:5 row_mask:0xf bank_mask:0xf
  v_mfma_f32_16x16x32_bf16 v[28:31], v[244:247], v[64:67], v[28:31]
  v_add_u32_dpp v184, v9, v5 row_newbcast:1 row_mask:0xf bank_mask:0xf
  s_waitcnt vmcnt(6)
  buffer_load_dwordx4 v[52:55], v184, s[48:51], 0 offen nt
  v_and_b32_dpp v244, v252, v240 row_newbcast:6 row_mask:0xf bank_mask:0xf
  v_and_b32_dpp v245, v252, v241 row_newbcast:6 row_mask:0xf bank_mask:0xf
  v_and_b32_dpp v246, v252, v242 row_newbcast:6 row_mask:0xf bank_mask:0xf
  v_and_b32_dpp v247, v252, v243 row_newbcast:6 row_mask:0xf bank_mask:0xf
  v_mfma_f32_16x16x32_bf16 v[28:31], v[248:251], v[68:71], v[28:31]
  s_waitcnt lgkmcnt(0)
  s_andn2_b32 s74, s74, 15
  s_add_u32 s41, s41, 1
  s_or_b32 s74, s74, s41
  v_mov_b32 v182, s74
  v_mov_b32 v178, s62
  s_mov_b64 exec, 1
  ds_write_b32 v177, v182
  ds_write_b32 v180, v178
  s_mov_b64 exec, -1
  v_add_u32 v177, 4, v177
  v_add_u32_dpp v183, v9, v5 row_newbcast:2 row_mask:0xf bank_mask:0xf
  s_waitcnt vmcnt(6)
  buffer_load_dwordx4 v[56:59], v183, s[48:51], 0 offen nt
  v_and_b32_dpp v248, v252, v240 row_newbcast:7 row_mask:0xf bank_mask:0xf
  v_and_b32_dpp v249, v252, v241 row_newbcast:7 row_mask:0xf bank_mask:0xf
  v_and_b32_dpp v250, v252, v242 row_newbcast:7 row_mask:0xf bank_mask:0xf
  v_and_b32_dpp v251, v252, v243 row_newbcast:7 row_mask:0xf bank_mask:0xf
  v_mfma_f32_16x16x32_bf16 v[28:31], v[244:247], v[72:75], v[28:31]
  v_add_u32_dpp v184, v9, v5 row_newbcast:3 row_mask:0xf bank_mask:0xf
  s_waitcnt vmcnt(6)
  buffer_load_dwordx4 v[60:63], v184, s[48:51], 0 offen nt
  v_and_b32_dpp v244, v252, v240 row_newbcast:8 row_mask:0xf bank_mask:0xf
  v_and_b32_dpp v245, v252, v241 row_newbcast:8 row_mask:0xf bank_mask:0xf
  v_and_b32_dpp v246, v252, v242 row_newbcast:8 row_mask:0xf bank_mask:0xf
  v_and_b32_dpp v247, v252, v243 row_newbcast:8 row_mask:0xf bank_mask:0xf
  v_mfma_f32_16x16x32_bf16 v[28:31], v[248:251], v[76:79], v[28:31]
  v_add_u32_dpp v183, v9, v5 row_newbcast:4 row_mask:0xf bank_mask:0xf
  s_waitcnt vmcnt(6)
  buffer_load_dwordx4 v[64:67], v183, s[48:51], 0 offen nt
  v_and_b32 v10, 0xffff0000, v254
  v_fma_f32 v10, v10, s70, v255
  v_exp_f32 v10, v10
  s_nop 0
  v_cvt_pk_bf16_f32 v253, v10, v10
  v_add_f32 v8, v8, v10
  v_and_b32_dpp v248, v252, v240 row_newbcast:9 row_mask:0xf bank_mask:0xf
  v_and_b32_dpp v249, v252, v241 row_newbcast:9 row_mask:0xf bank_mask:0xf
  v_and_b32_dpp v250, v252, v242 row_newbcast:9 row_mask:0xf bank_mask:0xf
  v_and_b32_dpp v251, v252, v243 row_newbcast:9 row_mask:0xf bank_mask:0xf
  v_mfma_f32_16x16x32_bf16 v[28:31], v[244:247], v[80:83], v[28:31]
  v_add_u32_dpp v184, v9, v5 row_newbcast:5 row_mask:0xf bank_mask:0xf
  s_waitcnt vmcnt(6)
  buffer_load_dwordx4 v[68:71], v184, s[48:51], 0 offen nt
  v_and_b32_dpp v244, v252, v240 row_newbcast:10 row_mask:0xf bank_mask:0xf
  v_and_b32_dpp v245, v252, v241 row_newbcast:10 row_mask:0xf bank_mask:0xf
  v_and_b32_dpp v246, v252, v242 row_newbcast:10 row_mask:0xf bank_mask:0xf
  v_and_b32_dpp v247, v252, v243 row_newbcast:10 row_mask:0xf bank_mask:0xf
  v_mfma_f32_16x16x32_bf16 v[28:31], v[248:251], v[84:87], v[28:31]
  v_add_u32_dpp v183, v9, v5 row_newbcast:6 row_mask:0xf bank_mask:0xf
  s_waitcnt vmcnt(6)
  buffer_load_dwordx4 v[72:75], v183, s[48:51], 0 offen nt
  v_and_b32_dpp v248, v252, v240 row_newbcast:11 row_mask:0xf bank_mask:0xf
  v_and_b32_dpp v249, v252, v241 row_newbcast:11 row_mask:0xf bank_mask:0xf
  v_and_b32_dpp v250, v252, v242 row_newbcast:11 row_mask:0xf bank_mask:0xf
  v_and_b32_dpp v251, v252, v243 row_newbcast:11 row_mask:0xf bank_mask:0xf
  v_mfma_f32_16x16x32_bf16 v[28:31], v[244:247], v[88:91], v[28:31]
  v_add_u32_dpp v184, v9, v5 row_newbcast:7 row_mask:0xf bank_mask:0xf
  s_waitcnt vmcnt(6)
  buffer_load_dwordx4 v[76:79], v184, s[48:51], 0 offen nt
  v_and_b32_dpp v244, v252, v240 row_newbcast:12 row_mask:0xf bank_mask:0xf
  v_and_b32_dpp v245, v252, v241 row_newbcast:12 row_mask:0xf bank_mask:0xf
  v_and_b32_dpp v246, v252, v242 row_newbcast:12 row_mask:0xf bank_mask:0xf
  v_and_b32_dpp v247, v252, v243 row_newbcast:12 row_mask:0xf bank_mask:0xf
  v_mfma_f32_16x16x32_bf16 v[28:31], v[248:251], v[92:95], v[28:31]
  ds_read_b64 v[178:179], v176 offset:48
  v_add_u32_dpp v183, v9, v5 row_newbcast:8 row_mask:0xf bank_mask:0xf
  s_waitcnt vmcnt(6)
  buffer_load_dwordx4 v[80:83], v183, s[48:51], 0 offen nt
  v_and_b32_dpp v248, v252, v240 row_newbcast:13 row_mask:0xf bank_mask:0xf
  v_and_b32_dpp v249, v252, v241 row_newbcast:13 row_mask:0xf bank_mask:0xf
  v_and_b32_dpp v250, v252, v242 row_newbcast:13 row_mask:0xf bank_mask:0xf
  v_and_b32_dpp v251, v252, v243 row_newbcast:13 row_mask:0xf bank_mask:0xf
  v_mfma_f32_16x16x32_bf16 v[28:31], v[244:247], v[96:99], v[28:31]
  v_add_u32_dpp v184, v9, v5 row_newbcast:9 row_mask:0xf bank_mask:0xf
  s_waitcnt vmcnt(6)
  buffer_load_dwordx4 v[84:87], v184, s[48:51], 0 offen nt
  v_and_b32_dpp v244, v252, v240 row_newbcast:14 row_mask:0xf bank_mask:0xf
  v_and_b32_dpp v245, v252, v241 row_newbcast:14 row_mask:0xf bank_mask:0xf
  v_and_b32_dpp v246, v252, v242 row_newbcast:14 row_mask:0xf bank_mask:0xf
  v_and_b32_dpp v247, v252, v243 row_newbcast:14 row_mask:0xf bank_mask:0xf
  v_mfma_f32_16x16x32_bf16 v[28:31], v[248:251], v[100:103], v[28:31]
  s_waitcnt lgkmcnt(0)
  v_readfirstlane_b32 s40, v178
  v_readfirstlane_b32 s92, v179
  v_add_u32_dpp v183, v9, v5 row_newbcast:10 row_mask:0xf bank_mask:0xf
  s_waitcnt vmcnt(6)
  buffer_load_dwordx4 v[88:91], v183, s[48:51], 0 offen nt
  v_and_b32_dpp v248, v252, v240 row_newbcast:15 row_mask:0xf bank_mask:0xf
  v_and_b32_dpp v249, v252, v241 row_newbcast:15 row_mask:0xf bank_mask:0xf
  v_and_b32_dpp v250, v252, v242 row_newbcast:15 row_mask:0xf bank_mask:0xf
  v_and_b32_dpp v251, v252, v243 row_newbcast:15 row_mask:0xf bank_mask:0xf
  v_mfma_f32_16x16x32_bf16 v[28:31], v[244:247], v[104:107], v[28:31]
  s_cmp_lg_u32 s40, 0
  s_cselect_b32 s63, s40, s63
  v_mov_b32 v252, v253
  v_add_u32_dpp v184, v9, v5 row_newbcast:11 row_mask:0xf bank_mask:0xf
  s_waitcnt vmcnt(6)
  buffer_load_dwordx4 v[92:95], v184, s[48:51], 0 offen nt
  v_and_b32_dpp v244, v252, v240 row_newbcast:0 row_mask:0xf bank_mask:0xf
  v_and_b32_dpp v245, v252, v241 row_newbcast:0 row_mask:0xf bank_mask:0xf
  v_and_b32_dpp v246, v252, v242 row_newbcast:0 row_mask:0xf bank_mask:0xf
  v_and_b32_dpp v247, v252, v243 row_newbcast:0 row_mask:0xf bank_mask:0xf
  v_mfma_f32_16x16x32_bf16 v[28:31], v[248:251], v[108:111], v[28:31]
  s_branch L_vloop
L_vm9:
  s_memrealtime s[74:75]
  v_add_u32_dpp v183, v9, v5 row_newbcast:12 row_mask:0xf bank_mask:0xf
  s_waitcnt vmcnt(7)
  buffer_load_dwordx4 v[96:99], v183, s[48:51], 0 offen nt
  v_and_b32_dpp v248, v252, v240 row_newbcast:1 row_mask:0xf bank_mask:0xf
  v_and_b32_dpp v249, v252, v241 row_newbcast:1 row_mask:0xf bank_mask:0xf
  v_and_b32_dpp v250, v252, v242 row_newbcast:1 row_mask:0xf bank_mask:0xf
  v_and_b32_dpp v251, v252, v243 row_newbcast:1 row_mask:0xf bank_mask:0xf
  v_mfma_f32_16x16x32_bf16 v[28:31], v[244:247], v[48:51], v[28:31]
  v_add_u32_dpp v184, v9, v5 row_newbcast:13 row_mask:0xf bank_mask:0xf
  s_waitcnt vmcnt(7)
  buffer_load_dwordx4 v[100:103], v184, s[48:51], 0 offen nt
  v_and_b32_dpp v244, v252, v240 row_newbcast:2 row_mask:0xf bank_mask:0xf
  v_and_b32_dpp v245, v252, v241 row_newbcast:2 row_mask:0xf bank_mask:0xf
  v_and_b32_dpp v246, v252, v242 row_newbcast:2 row_mask:0xf bank_mask:0xf
  v_and_b32_dpp v247, v252, v243 row_newbcast:2 row_mask:0xf bank_mask:0xf
  v_mfma_f32_16x16x32_bf16 v[28:31], v[248:251], v[52:55], v[28:31]
  v_add_u32_dpp v183, v9, v5 row_newbcast:14 row_mask:0xf bank_mask:0xf
  s_waitcnt vmcnt(7)
  buffer_load_dwordx4 v[104:107], v183, s[48:51], 0 offen nt
  v_and_b32_dpp v248, v252, v240 row_newbcast:3 row_mask:0xf bank_mask:0xf
  v_and_b32_dpp v249, v252, v241 row_newbcast:3 row_mask:0xf bank_mask:0xf
  v_and_b32_dpp v250, v252, v242 row_newbcast:3 row_mask:0xf bank_mask:0xf
  v_and_b32_dpp v251, v252, v243 row_newbcast:3 row_mask:0xf bank_mask:0xf
  v_mfma_f32_16x16x32_bf16 v[28:31], v[244:247], v[56:59], v[28:31]
  v_add_u32_dpp v184, v9, v5 row_newbcast:15 row_mask:0xf bank_mask:0xf
  s_waitcnt vmcnt(7)
  buffer_load_dwordx4 v[108:111], v184, s[48:51], 0 offen nt
  s_waitcnt lgkmcnt(0)
  v_and_b32 v9, 0xffff, v254
  v_lshlrev_b32 v9, 6, v9
  v_and_b32_dpp v244, v252, v240 row_newbcast:4 row_mask:0xf bank_mask:0xf
  v_and_b32_dpp v245, v252, v241 row_newbcast:4 row_mask:0xf bank_mask:0xf
  v_and_b32_dpp v246, v252, v242 row_newbcast:4 row_mask:0xf bank_mask:0xf
  v_and_b32_dpp v247, v252, v243 row_newbcast:4 row_mask:0xf bank_mask:0xf
  v_mfma_f32_16x16x32_bf16 v[28:31], v[248:251], v[60:63], v[28:31]
  v_add_u32_dpp v183, v9, v5 row_newbcast:0 row_mask:0xf bank_mask:0xf
  s_waitcnt vmcnt(7)
  buffer_load_dwordx4 v[48:51], v183, s[48:51], 0 offen nt
  v_and_b32_dpp v248, v252, v240 row_newbcast:5 row_mask:0xf bank_mask:0xf
  v_and_b32_dpp v249, v252, v241 row_newbcast:5 row_mask:0xf bank_mask:0xf
  v_and_b32_dpp v250, v252, v242 row_newbcast:5 row_mask:0xf bank_mask:0xf
  v_and_b32_dpp v251, v252, v243 row_newbcast:5 row_mask:0xf bank_mask:0xf
  v_mfma_f32_16x16x32_bf16 v[28:31], v[244:247], v[64:67], v[28:31]
  v_add_u32_dpp v184, v9, v5 row_newbcast:1 row_mask:0xf bank_mask:0xf
  s_waitcnt vmcnt(7)
  buffer_load_dwordx4 v[52:55], v184, s[48:51], 0 offen nt
  v_and_b32_dpp v244, v252, v240 row_newbcast:6 row_mask:0xf bank_mask:0xf
  v_and_b32_dpp v245, v252, v241 row_newbcast:6 row_mask:0xf bank_mask:0xf
  v_and_b32_dpp v246, v252, v242 row_newbcast:6 row_mask:0xf bank_mask:0xf
  v_and_b32_dpp v247, v252, v243 row_newbcast:6 row_mask:0xf bank_mask:0xf
  v_mfma_f32_16x16x32_bf16 v[28:31], v[248:251], v[68:71], v[28:31]
  s_waitcnt lgkmcnt(0)
  s_andn2_b32 s74, s74, 15
  s_add_u32 s41, s41, 1
  s_or_b32 s74, s74, s41
  v_mov_b32 v182, s74
  v_mov_b32 v178, s62
  s_mov_b64 exec, 1
  ds_write_b32 v177, v182
  ds_write_b32 v180, v178
  s_mov_b64 exec, -1
  v_add_u32 v177, 4, v177
  v_add_u32_dpp v183, v9, v5 row_newbcast:2 row_mask:0xf bank_mask:0xf
  s_waitcnt vmcnt(7)
  buffer_load_dwordx4 v[56:59], v183, s[48:51], 0 offen nt
  v_and_b32_dpp v248, v252, v240 row_newbcast:7 row_mask:0xf bank_mask:0xf
  v_and_b32_dpp v249, v252, v241 row_newbcast:7 row_mask:0xf bank_mask:0xf
  v_and_b32_dpp v250, v252, v242 row_newbcast:7 row_mask:0xf bank_mask:0xf
  v_and_b32_dpp v251, v252, v243 row_newbcast:7 row_mask:0xf bank_mask:0xf
  v_mfma_f32_16x16x32_bf16 v[28:31], v[244:247], v[72:75], v[28:31]
  v_add_u32_dpp v184, v9, v5 row_newbcast:3 row_mask:0xf bank_mask:0xf
  s_waitcnt vmcnt(7)
  buffer_load_dwordx4 v[60:63], v184, s[48:51], 0 offen nt
  v_and_b32_dpp v244, v252, v240 row_newbcast:8 row_mask:0xf bank_mask:0xf
  v_and_b32_dpp v245, v252, v241 row_newbcast:8 row_mask:0xf bank_mask:0xf
  v_and_b32_dpp v246, v252, v242 row_newbcast:8 row_mask:0xf bank_mask:0xf
  v_and_b32_dpp v247, v252, v243 row_newbcast:8 row_mask:0xf bank_mask:0xf
  v_mfma_f32_16x16x32_bf16 v[28:31], v[248:251], v[76:79], v[28:31]
  v_add_u32_dpp v183, v9, v5 row_newbcast:4 row_mask:0xf bank_mask:0xf
  s_waitcnt vmcnt(7)
  buffer_load_dwordx4 v[64:67], v183, s[48:51], 0 offen nt
  v_and_b32 v10, 0xffff0000, v254
  v_fma_f32 v10, v10, s70, v255
  v_exp_f32 v10, v10
  s_nop 0
  v_cvt_pk_bf16_f32 v253, v10, v10
  v_add_f32 v8, v8, v10
  v_and_b32_dpp v248, v252, v240 row_newbcast:9 row_mask:0xf bank_mask:0xf
  v_and_b32_dpp v249, v252, v241 row_newbcast:9 row_mask:0xf bank_mask:0xf
  v_and_b32_dpp v250, v252, v242 row_newbcast:9 row_mask:0xf bank_mask:0xf
  v_and_b32_dpp v251, v252, v243 row_newbcast:9 row_mask:0xf bank_mask:0xf
  v_mfma_f32_16x16x32_bf16 v[28:31], v[244:247], v[80:83], v[28:31]
  v_add_u32_dpp v184, v9, v5 row_newbcast:5 row_mask:0xf bank_mask:0xf
  s_waitcnt vmcnt(7)
  buffer_load_dwordx4 v[68:71], v184, s[48:51], 0 offen nt
  v_and_b32_dpp v244, v252, v240 row_newbcast:10 row_mask:0xf bank_mask:0xf
  v_and_b32_dpp v245, v252, v241 row_newbcast:10 row_mask:0xf bank_mask:0xf
  v_and_b32_dpp v246, v252, v242 row_newbcast:10 row_mask:0xf bank_mask:0xf
  v_and_b32_dpp v247, v252, v243 row_newbcast:10 row_mask:0xf bank_mask:0xf
  v_mfma_f32_16x16x32_bf16 v[28:31], v[248:251], v[84:87], v[28:31]
  v_add_u32_dpp v183, v9, v5 row_newbcast:6 row_mask:0xf bank_mask:0xf
  s_waitcnt vmcnt(7)
  buffer_load_dwordx4 v[72:75], v183, s[48:51], 0 offen nt
  v_and_b32_dpp v248, v252, v240 row_newbcast:11 row_mask:0xf bank_mask:0xf
  v_and_b32_dpp v249, v252, v241 row_newbcast:11 row_mask:0xf bank_mask:0xf
  v_and_b32_dpp v250, v252, v242 row_newbcast:11 row_mask:0xf bank_mask:0xf
  v_and_b32_dpp v251, v252, v243 row_newbcast:11 row_mask:0xf bank_mask:0xf
  v_mfma_f32_16x16x32_bf16 v[28:31], v[244:247], v[88:91], v[28:31]
  v_add_u32_dpp v184, v9, v5 row_newbcast:7 row_mask:0xf bank_mask:0xf
  s_waitcnt vmcnt(7)
  buffer_load_dwordx4 v[76:79], v184, s[48:51], 0 offen nt
  v_and_b32_dpp v244, v252, v240 row_newbcast:12 row_mask:0xf bank_mask:0xf
  v_and_b32_dpp v245, v252, v241 row_newbcast:12 row_mask:0xf bank_mask:0xf
  v_and_b32_dpp v246, v252, v242 row_newbcast:12 row_mask:0xf bank_mask:0xf
  v_and_b32_dpp v247, v252, v243 row_newbcast:12 row_mask:0xf bank_mask:0xf
  v_mfma_f32_16x16x32_bf16 v[28:31], v[248:251], v[92:95], v[28:31]
  ds_read_b64 v[178:179], v176 offset:48
  v_add_u32_dpp v183, v9, v5 row_newbcast:8 row_mask:0xf bank_mask:0xf
  s_waitcnt vmcnt(7)
  buffer_load_dwordx4 v[80:83], v183, s[48:51], 0 offen nt
  v_and_b32_dpp v248, v252, v240 row_newbcast:13 row_mask:0xf bank_mask:0xf
  v_and_b32_dpp v249, v252, v241 row_newbcast:13 row_mask:0xf bank_mask:0xf
  v_and_b32_dpp v250, v252, v242 row_newbcast:13 row_mask:0xf bank_mask:0xf
  v_and_b32_dpp v251, v252, v243 row_newbcast:13 row_mask:0xf bank_mask:0xf
  v_mfma_f32_16x16x32_bf16 v[28:31], v[244:247], v[96:99], v[28:31]
  v_add_u32_dpp v184, v9, v5 row_newbcast:9 row_mask:0xf bank_mask:0xf
  s_waitcnt vmcnt(7)
  buffer_load_dwordx4 v[84:87], v184, s[48:51], 0 offen nt
  v_and_b32_dpp v244, v252, v240 row_newbcast:14 row_mask:0xf bank_mask:0xf
  v_and_b32_dpp v245, v252, v241 row_newbcast:14 row_mask:0xf bank_mask:0xf
  v_and_b32_dpp v246, v252, v242 row_newbcast:14 row_mask:0xf bank_mask:0xf
  v_and_b32_dpp v247, v252, v243 row_newbcast:14 row_mask:0xf bank_mask:0xf
  v_mfma_f32_16x16x32_bf16 v[28:31], v[248:251], v[100:103], v[28:31]
  s_waitcnt lgkmcnt(0)
  v_readfirstlane_b32 s40, v178
  v_readfirstlane_b32 s92, v179
  v_add_u32_dpp v183, v9, v5 row_newbcast:10 row_mask:0xf bank_mask:0xf
  s_waitcnt vmcnt(7)
  buffer_load_dwordx4 v[88:91], v183, s[48:51], 0 offen nt
  v_and_b32_dpp v248, v252, v240 row_newbcast:15 row_mask:0xf bank_mask:0xf
  v_and_b32_dpp v249, v252, v241 row_newbcast:15 row_mask:0xf bank_mask:0xf
  v_and_b32_dpp v250, v252, v242 row_newbcast:15 row_mask:0xf bank_mask:0xf
  v_and_b32_dpp v251, v252, v243 row_newbcast:15 row_mask:0xf bank_mask:0xf
  v_mfma_f32_16x16x32_bf16 v[28:31], v[244:247], v[104:107], v[28:31]
  s_cmp_lg_u32 s40, 0
  s_cselect_b32 s63, s40, s63
  v_mov_b32 v252, v253
  v_add_u32_dpp v184, v9, v5 row_newbcast:11 row_mask:0xf bank_mask:0xf
  s_waitcnt vmcnt(7)
  buffer_load_dwordx4 v[92:95], v184, s[48:51], 0 offen nt
  v_and_b32_dpp v244, v252, v240 row_newbcast:0 row_mask:0xf bank_mask:0xf
  v_and_b32_dpp v245, v252, v241 row_newbcast:0 row_mask:0xf bank_mask:0xf
  v_and_b32_dpp v246, v252, v242 row_newbcast:0 row_mask:0xf bank_mask:0xf
  v_and_b32_dpp v247, v252, v243 row_newbcast:0 row_mask:0xf bank_mask:0xf
  v_mfma_f32_16x16x32_bf16 v[28:31], v[248:251], v[108:111], v[28:31]
  s_branch L_vloop
L_vdone:
  v_mov_b32 v178, 0xff
  s_mov_b64 exec, 1
  ds_write_b32 v180, v178
  s_mov_b64 exec, -1
  v_mov_b32 v10, 26908
  s_mov_b32 s71, 0x200000
L_lw49:
  ds_read_b32 v11, v10
  s_sub_u32 s71, s71, 1
  s_cbranch_scc1 L_lwd50
  s_waitcnt lgkmcnt(0)
  v_readfirstlane_b32 s40, v11
  s_nop 0
  s_cmp_lt_u32 s40, 4
  s_cbranch_scc1 L_lw49
L_lwd50:
  s_waitcnt lgkmcnt(0)
  s_lshl_b32 s40, s36, 14
  s_add_u32 s40, s40, 65536
  v_lshl_add_u32 v10, v1, 4, s40
  ds_read_b128 v[112:115], v10 offset:0
  ds_read_b128 v[116:119], v10 offset:1024
  ds_read_b128 v[120:123], v10 offset:2048
  ds_read_b128 v[124:127], v10 offset:3072
  ds_read_b128 v[128:131], v10 offset:4096
  ds_read_b128 v[132:135], v10 offset:5120
  ds_read_b128 v[136:139], v10 offset:6144
  ds_read_b128 v[140:143], v10 offset:7168
  ds_read_b128 v[144:147], v10 offset:8192
  ds_read_b128 v[148:151], v10 offset:9216
  ds_read_b128 v[152:155], v10 offset:10240
  ds_read_b128 v[156:159], v10 offset:11264
  ds_read_b128 v[160:163], v10 offset:12288
  ds_read_b128 v[164:167], v10 offset:13312
  ds_read_b128 v[168:171], v10 offset:14336
  ds_read_b128 v[172:175], v10 offset:15360
  v_add_u32_dpp v183, v9, v5 row_newbcast:12 row_mask:0xf bank_mask:0xf
  s_waitcnt vmcnt(7)
  buffer_load_dwordx4 v[96:99], v183, s[48:51], 0 offen nt
  v_and_b32_dpp v248, v252, v240 row_newbcast:1 row_mask:0xf bank_mask:0xf
  v_and_b32_dpp v249, v252, v241 row_newbcast:1 row_mask:0xf bank_mask:0xf
  v_and_b32_dpp v250, v252, v242 row_newbcast:1 row_mask:0xf bank_mask:0xf
  v_and_b32_dpp v251, v252, v243 row_newbcast:1 row_mask:0xf bank_mask:0xf
  v_mfma_f32_16x16x32_bf16 v[28:31], v[244:247], v[48:51], v[28:31]
  v_add_u32_dpp v184, v9, v5 row_newbcast:13 row_mask:0xf bank_mask:0xf
  s_waitcnt vmcnt(7)
  buffer_load_dwordx4 v[100:103], v184, s[48:51], 0 offen nt
  v_and_b32_dpp v244, v252, v240 row_newbcast:2 row_mask:0xf bank_mask:0xf
  v_and_b32_dpp v245, v252, v241 row_newbcast:2 row_mask:0xf bank_mask:0xf
  v_and_b32_dpp v246, v252, v242 row_newbcast:2 row_mask:0xf bank_mask:0xf
  v_and_b32_dpp v247, v252, v243 row_newbcast:2 row_mask:0xf bank_mask:0xf
  v_mfma_f32_16x16x32_bf16 v[28:31], v[248:251], v[52:55], v[28:31]
  v_add_u32_dpp v183, v9, v5 row_newbcast:14 row_mask:0xf bank_mask:0xf
  s_waitcnt vmcnt(7)
  buffer_load_dwordx4 v[104:107], v183, s[48:51], 0 offen nt
  v_and_b32_dpp v248, v252, v240 row_newbcast:3 row_mask:0xf bank_mask:0xf
  v_and_b32_dpp v249, v252, v241 row_newbcast:3 row_mask:0xf bank_mask:0xf
  v_and_b32_dpp v250, v252, v242 row_newbcast:3 row_mask:0xf bank_mask:0xf
  v_and_b32_dpp v251, v252, v243 row_newbcast:3 row_mask:0xf bank_mask:0xf
  v_mfma_f32_16x16x32_bf16 v[28:31], v[244:247], v[56:59], v[28:31]
  v_add_u32_dpp v184, v9, v5 row_newbcast:15 row_mask:0xf bank_mask:0xf
  s_waitcnt vmcnt(7)
  buffer_load_dwordx4 v[108:111], v184, s[48:51], 0 offen nt
  v_and_b32_dpp v244, v252, v240 row_newbcast:4 row_mask:0xf bank_mask:0xf
  v_and_b32_dpp v245, v252, v241 row_newbcast:4 row_mask:0xf bank_mask:0xf
  v_and_b32_dpp v246, v252, v242 row_newbcast:4 row_mask:0xf bank_mask:0xf
  v_and_b32_dpp v247, v252, v243 row_newbcast:4 row_mask:0xf bank_mask:0xf
  v_mfma_f32_16x16x32_bf16 v[28:31], v[248:251], v[60:63], v[28:31]
  s_nop 1
  v_add_f32_dpp v8, v8, v8 row_ror:8 row_mask:0xf bank_mask:0xf
  s_nop 1
  v_add_f32_dpp v8, v8, v8 row_ror:4 row_mask:0xf bank_mask:0xf
  s_nop 1
  v_add_f32_dpp v8, v8, v8 row_ror:2 row_mask:0xf bank_mask:0xf
  s_nop 1
  v_add_f32_dpp v8, v8, v8 row_ror:1 row_mask:0xf bank_mask:0xf
  s_nop 1
  v_add_f32_dpp v8, v8, v8 row_bcast:15 row_mask:0xa bank_mask:0xf
  s_nop 1
  v_add_f32_dpp v8, v8, v8 row_bcast:31 row_mask:0xc bank_mask:0xf
  s_nop 0
  v_readlane_b32 s69, v8, 63
  s_nop 1
  v_lshlrev_b32 v10, 5, v3
  v_lshl_add_u32 v10, v2, 4, v10
  s_lshl_b32 s40, s3, 9
  v_add_u32 v10, s40, v10
  s_lshl_b32 s40, s3, 2
  v_mov_b32 v32, s40
  v_mov_b32 v34, s69
  s_mov_b64 exec, 1
  ds_write_b32 v32, v34 offset:29200
  s_mov_b64 exec, -1
  s_waitcnt vmcnt(11)
  v_and_b32_dpp v248, v252, v240 row_newbcast:5 row_mask:0xf bank_mask:0xf
  v_and_b32_dpp v249, v252, v241 row_newbcast:5 row_mask:0xf bank_mask:0xf
  v_and_b32_dpp v250, v252, v242 row_newbcast:5 row_mask:0xf bank_mask:0xf
  v_and_b32_dpp v251, v252, v243 row_newbcast:5 row_mask:0xf bank_mask:0xf
  v_mfma_f32_16x16x32_bf16 v[28:31], v[244:247], v[64:67], v[28:31]
  s_waitcnt vmcnt(10)
  v_and_b32_dpp v244, v252, v240 row_newbcast:6 row_mask:0xf bank_mask:0xf
  v_and_b32_dpp v245, v252, v241 row_newbcast:6 row_mask:0xf bank_mask:0xf
  v_and_b32_dpp v246, v252, v242 row_newbcast:6 row_mask:0xf bank_mask:0xf
  v_and_b32_dpp v247, v252, v243 row_newbcast:6 row_mask:0xf bank_mask:0xf
  v_mfma_f32_16x16x32_bf16 v[28:31], v[248:251], v[68:71], v[28:31]
  s_waitcnt vmcnt(9)
  v_and_b32_dpp v248, v252, v240 row_newbcast:7 row_mask:0xf bank_mask:0xf
  v_and_b32_dpp v249, v252, v241 row_newbcast:7 row_mask:0xf bank_mask:0xf
  v_and_b32_dpp v250, v252, v242 row_newbcast:7 row_mask:0xf bank_mask:0xf
  v_and_b32_dpp v251, v252, v243 row_newbcast:7 row_mask:0xf bank_mask:0xf
  v_mfma_f32_16x16x32_bf16 v[28:31], v[244:247], v[72:75], v[28:31]
  s_waitcnt vmcnt(8)
  v_and_b32_dpp v244, v252, v240 row_newbcast:8 row_mask:0xf bank_mask:0xf
  v_and_b32_dpp v245, v252, v241 row_newbcast:8 row_mask:0xf bank_mask:0xf
  v_and_b32_dpp v246, v252, v242 row_newbcast:8 row_mask:0xf bank_mask:0xf
  v_and_b32_dpp v247, v252, v243 row_newbcast:8 row_mask:0xf bank_mask:0xf
  v_mfma_f32_16x16x32_bf16 v[28:31], v[248:251], v[76:79], v[28:31]
  s_waitcnt vmcnt(7)
  v_and_b32_dpp v248, v252, v240 row_newbcast:9 row_mask:0xf bank_mask:0xf
  v_and_b32_dpp v249, v252, v241 row_newbcast:9 row_mask:0xf bank_mask:0xf
  v_and_b32_dpp v250, v252, v242 row_newbcast:9 row_mask:0xf bank_mask:0xf
  v_and_b32_dpp v251, v252, v243 row_newbcast:9 row_mask:0xf bank_mask:0xf
  v_mfma_f32_16x16x32_bf16 v[28:31], v[244:247], v[80:83], v[28:31]
  s_waitcnt vmcnt(6)
  v_and_b32_dpp v244, v252, v240 row_newbcast:10 row_mask:0xf bank_mask:0xf
  v_and_b32_dpp v245, v252, v241 row_newbcast:10 row_mask:0xf bank_mask:0xf
  v_and_b32_dpp v246, v252, v242 row_newbcast:10 row_mask:0xf bank_mask:0xf
  v_and_b32_dpp v247, v252, v243 row_newbcast:10 row_mask:0xf bank_mask:0xf
  v_mfma_f32_16x16x32_bf16 v[28:31], v[248:251], v[84:87], v[28:31]
  s_waitcnt vmcnt(5)
  v_and_b32_dpp v248, v252, v240 row_newbcast:11 row_mask:0xf bank_mask:0xf
  v_and_b32_dpp v249, v252, v241 row_newbcast:11 row_mask:0xf bank_mask:0xf
  v_and_b32_dpp v250, v252, v242 row_newbcast:11 row_mask:0xf bank_mask:0xf
  v_and_b32_dpp v251, v252, v243 row_newbcast:11 row_mask:0xf bank_mask:0xf
  v_mfma_f32_16x16x32_bf16 v[28:31], v[244:247], v[88:91], v[28:31]
  s_waitcnt vmcnt(4)
  v_and_b32_dpp v244, v252, v240 row_newbcast:12 row_mask:0xf bank_mask:0xf
  v_and_b32_dpp v245, v252, v241 row_newbcast:12 row_mask:0xf bank_mask:0xf
  v_and_b32_dpp v246, v252, v242 row_newbcast:12 row_mask:0xf bank_mask:0xf
  v_and_b32_dpp v247, v252, v243 row_newbcast:12 row_mask:0xf bank_mask:0xf
  v_mfma_f32_16x16x32_bf16 v[28:31], v[248:251], v[92:95], v[28:31]
  s_waitcnt vmcnt(3)
  v_and_b32_dpp v248, v252, v240 row_newbcast:13 row_mask:0xf bank_mask:0xf
  v_and_b32_dpp v249, v252, v241 row_newbcast:13 row_mask:0xf bank_mask:0xf
  v_and_b32_dpp v250, v252, v242 row_newbcast:13 row_mask:0xf bank_mask:0xf
  v_and_b32_dpp v251, v252, v243 row_newbcast:13 row_mask:0xf bank_mask:0xf
  v_mfma_f32_16x16x32_bf16 v[28:31], v[244:247], v[96:99], v[28:31]
  s_waitcnt vmcnt(2)
  v_and_b32_dpp v244, v252, v240 row_newbcast:14 row_mask:0xf bank_mask:0xf
  v_and_b32_dpp v245, v252, v241 row_newbcast:14 row_mask:0xf bank_mask:0xf
  v_and_b32_dpp v246, v252, v242 row_newbcast:14 row_mask:0xf bank_mask:0xf
  v_and_b32_dpp v247, v252, v243 row_newbcast:14 row_mask:0xf bank_mask:0xf
  v_mfma_f32_16x16x32_bf16 v[28:31], v[248:251], v[100:103], v[28:31]
  s_waitcnt vmcnt(1)
  v_and_b32_dpp v248, v252, v240 row_newbcast:15 row_mask:0xf bank_mask:0xf
  v_and_b32_dpp v249, v252, v241 row_newbcast:15 row_mask:0xf bank_mask:0xf
  v_and_b32_dpp v250, v252, v242 row_newbcast:15 row_mask:0xf bank_mask:0xf
  v_and_b32_dpp v251, v252, v243 row_newbcast:15 row_mask:0xf bank_mask:0xf
  v_mfma_f32_16x16x32_bf16 v[28:31], v[244:247], v[104:107], v[28:31]
  s_waitcnt vmcnt(0)
  s_nop 1
  v_mfma_f32_16x16x32_bf16 v[28:31], v[248:251], v[108:111], v[28:31]
  s_mov_b32 exec_lo, -1
  s_mov_b32 exec_hi, 0x0
  s_nop 5
  ds_write_b128 v10, v[28:31] offset:27136
  s_mov_b64 exec, -1
  s_waitcnt lgkmcnt(0)
  s_barrier
L_dry0:
  s_lshl_b32 s40, s34, 1
  v_add_u32 v48, s40, v3
  v_and_b32 v48, 15, v48
  v_lshlrev_b32 v48, 4, v48
  v_lshl_add_u32 v48, v2, 2, v48
  v_mov_b32 v49, 29184
  ds_read_b128 v[56:59], v49 offset:16
  ds_read_b32 v60, v48 offset:27136
  ds_read_b32 v61, v48 offset:27648
  ds_read_b32 v62, v48 offset:28160
  ds_read_b32 v63, v48 offset:28672
  s_waitcnt lgkmcnt(4)
  v_add_f32 v51, v56, v57
  v_add_f32 v52, v58, v59
  v_add_f32 v51, v51, v52
  v_rcp_f32 v51, v51
  s_waitcnt lgkmcnt(0)
  v_add_f32 v50, v60, v61
  v_add_f32 v52, v62, v63
  v_add_f32 v50, v50, v52
  v_mul_f32 v50, v50, v51
  v_cvt_pk_bf16_f32 v252, v50, v50
  s_waitcnt vmcnt(0)
  s_nop 0
  v_and_b32_dpp v244, v252, v240 row_newbcast:0 row_mask:0xf bank_mask:0xf
  v_and_b32_dpp v245, v252, v241 row_newbcast:0 row_mask:0xf bank_mask:0xf
  v_and_b32_dpp v246, v252, v242 row_newbcast:0 row_mask:0xf bank_mask:0xf
  v_and_b32_dpp v247, v252, v243 row_newbcast:0 row_mask:0xf bank_mask:0xf
  v_and_b32_dpp v248, v252, v240 row_newbcast:1 row_mask:0xf bank_mask:0xf
  v_and_b32_dpp v249, v252, v241 row_newbcast:1 row_mask:0xf bank_mask:0xf
  v_and_b32_dpp v250, v252, v242 row_newbcast:1 row_mask:0xf bank_mask:0xf
  v_and_b32_dpp v251, v252, v243 row_newbcast:1 row_mask:0xf bank_mask:0xf
  v_mfma_f32_16x16x32_bf16 v[44:47], v[244:247], v[112:115], 0
  v_and_b32_dpp v244, v252, v240 row_newbcast:2 row_mask:0xf bank_mask:0xf
  v_and_b32_dpp v245, v252, v241 row_newbcast:2 row_mask:0xf bank_mask:0xf
  v_and_b32_dpp v246, v252, v242 row_newbcast:2 row_mask:0xf bank_mask:0xf
  v_and_b32_dpp v247, v252, v243 row_newbcast:2 row_mask:0xf bank_mask:0xf
  v_mfma_f32_16x16x32_bf16 v[44:47], v[248:251], v[116:119], v[44:47]
  v_and_b32_dpp v248, v252, v240 row_newbcast:3 row_mask:0xf bank_mask:0xf
  v_and_b32_dpp v249, v252, v241 row_newbcast:3 row_mask:0xf bank_mask:0xf
  v_and_b32_dpp v250, v252, v242 row_newbcast:3 row_mask:0xf bank_mask:0xf
  v_and_b32_dpp v251, v252, v243 row_newbcast:3 row_mask:0xf bank_mask:0xf
  v_mfma_f32_16x16x32_bf16 v[44:47], v[244:247], v[120:123], v[44:47]
  v_and_b32_dpp v244, v252, v240 row_newbcast:4 row_mask:0xf bank_mask:0xf
  v_and_b32_dpp v245, v252, v241 row_newbcast:4 row_mask:0xf bank_mask:0xf
  v_and_b32_dpp v246, v252, v242 row_newbcast:4 row_mask:0xf bank_mask:0xf
  v_and_b32_dpp v247, v252, v243 row_newbcast:4 row_mask:0xf bank_mask:0xf
  v_mfma_f32_16x16x32_bf16 v[44:47], v[248:251], v[124:127], v[44:47]
  v_and_b32_dpp v248, v252, v240 row_newbcast:5 row_mask:0xf bank_mask:0xf
  v_and_b32_dpp v249, v252, v241 row_newbcast:5 row_mask:0xf bank_mask:0xf
  v_and_b32_dpp v250, v252, v242 row_newbcast:5 row_mask:0xf bank_mask:0xf
  v_and_b32_dpp v251, v252, v243 row_newbcast:5 row_mask:0xf bank_mask:0xf
  v_mfma_f32_16x16x32_bf16 v[44:47], v[244:247], v[128:131], v[44:47]
  v_and_b32_dpp v244, v252, v240 row_newbcast:6 row_mask:0xf bank_mask:0xf
  v_and_b32_dpp v245, v252, v241 row_newbcast:6 row_mask:0xf bank_mask:0xf
  v_and_b32_dpp v246, v252, v242 row_newbcast:6 row_mask:0xf bank_mask:0xf
  v_and_b32_dpp v247, v252, v243 row_newbcast:6 row_mask:0xf bank_mask:0xf
  v_mfma_f32_16x16x32_bf16 v[44:47], v[248:251], v[132:135], v[44:47]
  v_and_b32_dpp v248, v252, v240 row_newbcast:7 row_mask:0xf bank_mask:0xf
  v_and_b32_dpp v249, v252, v241 row_newbcast:7 row_mask:0xf bank_mask:0xf
  v_and_b32_dpp v250, v252, v242 row_newbcast:7 row_mask:0xf bank_mask:0xf
  v_and_b32_dpp v251, v252, v243 row_newbcast:7 row_mask:0xf bank_mask:0xf
  v_mfma_f32_16x16x32_bf16 v[44:47], v[244:247], v[136:139], v[44:47]
  v_and_b32_dpp v244, v252, v240 row_newbcast:8 row_mask:0xf bank_mask:0xf
  v_and_b32_dpp v245, v252, v241 row_newbcast:8 row_mask:0xf bank_mask:0xf
  v_and_b32_dpp v246, v252, v242 row_newbcast:8 row_mask:0xf bank_mask:0xf
  v_and_b32_dpp v247, v252, v243 row_newbcast:8 row_mask:0xf bank_mask:0xf
  v_mfma_f32_16x16x32_bf16 v[44:47], v[248:251], v[140:143], v[44:47]
  v_and_b32_dpp v248, v252, v240 row_newbcast:9 row_mask:0xf bank_mask:0xf
  v_and_b32_dpp v249, v252, v241 row_newbcast:9 row_mask:0xf bank_mask:0xf
  v_and_b32_dpp v250, v252, v242 row_newbcast:9 row_mask:0xf bank_mask:0xf
  v_and_b32_dpp v251, v252, v243 row_newbcast:9 row_mask:0xf bank_mask:0xf
  v_mfma_f32_16x16x32_bf16 v[44:47], v[244:247], v[144:147], v[44:47]
  v_and_b32_dpp v244, v252, v240 row_newbcast:10 row_mask:0xf bank_mask:0xf
  v_and_b32_dpp v245, v252, v241 row_newbcast:10 row_mask:0xf bank_mask:0xf
  v_and_b32_dpp v246, v252, v242 row_newbcast:10 row_mask:0xf bank_mask:0xf
  v_and_b32_dpp v247, v252, v243 row_newbcast:10 row_mask:0xf bank_mask:0xf
  v_mfma_f32_16x16x32_bf16 v[44:47], v[248:251], v[148:151], v[44:47]
  v_and_b32_dpp v248, v252, v240 row_newbcast:11 row_mask:0xf bank_mask:0xf
  v_and_b32_dpp v249, v252, v241 row_newbcast:11 row_mask:0xf bank_mask:0xf
  v_and_b32_dpp v250, v252, v242 row_newbcast:11 row_mask:0xf bank_mask:0xf
  v_and_b32_dpp v251, v252, v243 row_newbcast:11 row_mask:0xf bank_mask:0xf
  v_mfma_f32_16x16x32_bf16 v[44:47], v[244:247], v[152:155], v[44:47]
  v_and_b32_dpp v244, v252, v240 row_newbcast:12 row_mask:0xf bank_mask:0xf
  v_and_b32_dpp v245, v252, v241 row_newbcast:12 row_mask:0xf bank_mask:0xf
  v_and_b32_dpp v246, v252, v242 row_newbcast:12 row_mask:0xf bank_mask:0xf
  v_and_b32_dpp v247, v252, v243 row_newbcast:12 row_mask:0xf bank_mask:0xf
  v_mfma_f32_16x16x32_bf16 v[44:47], v[248:251], v[156:159], v[44:47]
  v_and_b32_dpp v248, v252, v240 row_newbcast:13 row_mask:0xf bank_mask:0xf
  v_and_b32_dpp v249, v252, v241 row_newbcast:13 row_mask:0xf bank_mask:0xf
  v_and_b32_dpp v250, v252, v242 row_newbcast:13 row_mask:0xf bank_mask:0xf
  v_and_b32_dpp v251, v252, v243 row_newbcast:13 row_mask:0xf bank_mask:0xf
  v_mfma_f32_16x16x32_bf16 v[44:47], v[244:247], v[160:163], v[44:47]
  v_and_b32_dpp v244, v252, v240 row_newbcast:14 row_mask:0xf bank_mask:0xf
  v_and_b32_dpp v245, v252, v241 row_newbcast:14 row_mask:0xf bank_mask:0xf
  v_and_b32_dpp v246, v252, v242 row_newbcast:14 row_mask:0xf bank_mask:0xf
  v_and_b32_dpp v247, v252, v243 row_newbcast:14 row_mask:0xf bank_mask:0xf
  v_mfma_f32_16x16x32_bf16 v[44:47], v[248:251], v[164:167], v[44:47]
  v_and_b32_dpp v248, v252, v240 row_newbcast:15 row_mask:0xf bank_mask:0xf
  v_and_b32_dpp v249, v252, v241 row_newbcast:15 row_mask:0xf bank_mask:0xf
  v_and_b32_dpp v250, v252, v242 row_newbcast:15 row_mask:0xf bank_mask:0xf
  v_and_b32_dpp v251, v252, v243 row_newbcast:15 row_mask:0xf bank_mask:0xf
  v_mfma_f32_16x16x32_bf16 v[44:47], v[244:247], v[168:171], v[44:47]
  s_nop 1
  v_mfma_f32_16x16x32_bf16 v[44:47], v[248:251], v[172:175], v[44:47]
  s_nop 7
  s_nop 1
  v_lshlrev_b32 v48, 5, v3
  v_lshl_add_u32 v48, v2, 4, v48
  s_lshl_b32 s40, s36, 9
  v_add_u32 v48, s40, v48
  s_mov_b32 exec_hi, 0x0
  ds_write_b128 v48, v[44:47] offset:29696
  s_mov_b64 exec, s[100:101]
  v_lshlrev_b32 v56, 2, v0
  v_lshrrev_b32 v57, 3, v0
  v_lshlrev_b32 v57, 4, v57
  v_bfe_u32 v58, v0, 1, 2
  v_lshl_add_u32 v57, v58, 10, v57
  v_and_b32 v58, 1, v0
  v_lshl_add_u32 v57, v58, 3, v57
  s_lshl_b32 s40, s34, 12
  s_add_u32 s40, s40, 131072
  v_add_u32 v57, s40, v57
  s_mov_b32 s56, 0x44800000
  s_mov_b32 s57, 0x3b800000
  s_mov_b32 s58, 0
  s_mov_b32 s59, 0x40f00000
  s_waitcnt lgkmcnt(0)
  s_cbranch_execz L_nb81
  s_barrier
L_nb81:
  ds_read_b32 v49, v56 offset:29696
  ds_read_b32 v50, v56 offset:31744
  s_waitcnt lgkmcnt(0)
  v_add_f32 v49, v49, v50
  v_cmp_gt_f32 vcc, s56, |v49|
  v_cmp_le_f32 s[40:41], s57, |v49|
  v_cvt_f64_f32 v[50:51], v49
  s_cmp_eq_u64 s[40:41], 0
  s_cselect_b64 vcc, 0, vcc
  v_add_f64 v[50:51], v[50:51], s[58:59]
  s_cmp_eq_u64 vcc, -1
  s_cbranch_scc1 L_opf0
  s_lshl_b32 s40, s34, 11
  s_add_u32 s40, s40, 163840
  v_add_u32 v56, s40, v56
  global_atomic_add_f32 v56, v49, s[30:31] sc1
  v_mov_b32 v50, 0
  v_mov_b32 v51, 0x41504000
  s_waitcnt vmcnt(0)
L_opf0:
  global_atomic_add_f64 v57, v[50:51], s[30:31] sc1
  s_cbranch_execz L_dry1
  s_endpgm
L_helper:
  v_mov_b32 v4, 0
  v_lshlrev_b32 v5, 2, v1
  ds_write_b32 v5, v4 offset:26880
  s_waitcnt lgkmcnt(0)
  s_load_dword s72, s[30:31], 0
  s_mov_b32 s73, 0xbfb8aa3b
  s_lshl_b32 s38, s34, 1
  v_add_u32 v6, s38, v3
  v_and_b32 v6, 15, v6
  v_lshl_add_u32 v6, v2, 4, v6
  v_lshlrev_b32 v6, 2, v6
  s_lshl_b32 s38, s36, 8
  v_add_u32 v6, s38, v6
  s_mov_b32 s48, s10
  s_mov_b32 s49, s11
  s_mov_b32 s50, 0x400000
  s_mov_b32 s51, 0x20000
  v_lshlrev_b32 v10, 18, v2
  v_lshl_add_u32 v10, v3, 4, v10
  v_add_u32 v11, 8192, v10
  s_cmp_ge_u32 s2, 32
  s_cbranch_scc1 L_noprod1
  v_and_b32 v8, 7, v3
  v_lshlrev_b32 v8, 10, v8
  v_lshrrev_b32 v9, 3, v3
  v_lshl_add_u32 v8, v9, 7, v8
  v_lshl_add_u32 v8, v2, 4, v8
  s_lshl_b32 s38, s36, 8
  v_add_u32 v8, s38, v8
  global_load_dwordx4 v[64:67], v8, s[22:23]
  global_load_dwordx4 v[68:71], v8, s[22:23] offset:64
  s_mov_b32 s44, s24
  s_mov_b32 s45, s25
  s_mov_b32 s46, 0x300000
  s_mov_b32 s47, 0x20000
  v_mul_u32_u24 v9, 49152, v2
  v_lshl_add_u32 v9, v3, 2, v9
  s_mul_i32 s38, s36, 786432
  s_lshl_b32 s39, s35, 6
  s_add_u32 s38, s38, s39
  buffer_load_dword v72, v9, s[44:47], s38 offen
  s_add_u32 s38, s38, 6144
  buffer_load_dword v73, v9, s[44:47], s38 offen
  s_add_u32 s38, s38, 6144
  buffer_load_dword v74, v9, s[44:47], s38 offen
  s_add_u32 s38, s38, 6144
  buffer_load_dword v75, v9, s[44:47], s38 offen
  s_add_u32 s38, s38, 6144
  buffer_load_dword v76, v9, s[44:47], s38 offen
  s_add_u32 s38, s38, 6144
  buffer_load_dword v77, v9, s[44:47], s38 offen
  s_add_u32 s38, s38, 6144
  buffer_load_dword v78, v9, s[44:47], s38 offen
  s_add_u32 s38, s38, 6144
  buffer_load_dword v79, v9, s[44:47], s38 offen
  s_add_u32 s38, s38, 153600
  buffer_load_dword v80, v9, s[44:47], s38 offen
  s_add_u32 s38, s38, 6144
  buffer_load_dword v81, v9, s[44:47], s38 offen
  s_add_u32 s38, s38, 6144
  buffer_load_dword v82, v9, s[44:47], s38 offen
  s_add_u32 s38, s38, 6144
  buffer_load_dword v83, v9, s[44:47], s38 offen
  s_add_u32 s38, s38, 6144
  buffer_load_dword v84, v9, s[44:47], s38 offen
  s_add_u32 s38, s38, 6144
  buffer_load_dword v85, v9, s[44:47], s38 offen
  s_add_u32 s38, s38, 6144
  buffer_load_dword v86, v9, s[44:47], s38 offen
  s_add_u32 s38, s38, 6144
  buffer_load_dword v87, v9, s[44:47], s38 offen
  s_add_u32 s38, s38, 153600
  buffer_load_dword v88, v9, s[44:47], s38 offen
  s_add_u32 s38, s38, 6144
  buffer_load_dword v89, v9, s[44:47], s38 offen
  s_add_u32 s38, s38, 6144
  buffer_load_dword v90, v9, s[44:47], s38 offen
  s_add_u32 s38, s38, 6144
  buffer_load_dword v91, v9, s[44:47], s38 offen
  s_add_u32 s38, s38, 6144
  buffer_load_dword v92, v9, s[44:47], s38 offen
  s_add_u32 s38, s38, 6144
  buffer_load_dword v93, v9, s[44:47], s38 offen
  s_add_u32 s38, s38, 6144
  buffer_load_dword v94, v9, s[44:47], s38 offen
  s_add_u32 s38, s38, 6144
  buffer_load_dword v95, v9, s[44:47], s38 offen
  s_add_u32 s38, s38, 153600
  buffer_load_dword v96, v9, s[44:47], s38 offen
  s_add_u32 s38, s38, 6144
  buffer_load_dword v97, v9, s[44:47], s38 offen
  s_add_u32 s38, s38, 6144
  buffer_load_dword v98, v9, s[44:47], s38 offen
  s_add_u32 s38, s38, 6144
  buffer_load_dword v99, v9, s[44:47], s38 offen
  s_add_u32 s38, s38, 6144
  buffer_load_dword v100, v9, s[44:47], s38 offen
  s_add_u32 s38, s38, 6144
  buffer_load_dword v101, v9, s[44:47], s38 offen
  s_add_u32 s38, s38, 6144
  buffer_load_dword v102, v9, s[44:47], s38 offen
  s_add_u32 s38, s38, 6144
  buffer_load_dword v103, v9, s[44:47], s38 offen
  s_lshl_b32 s37, s34, 10
  v_lshlrev_b32 v4, 4, v1
  v_add_u32 v4, s37, v4
  global_load_dwordx4 v[52:55], v4, s[4:5]
  v_add_u32 v7, s37, v6
  global_load_dword v56, v7, s[4:5]
  v_mov_b32 v16, 0
  v_mov_b32 v17, 0
  s_lshl_b32 s38, s2, 2
  s_add_u32 s38, s38, s36
  s_mul_i32 s39, s38, 384
  s_add_u32 s39, s39, 131072
  v_lshl_add_u32 v13, v1, 3, s39
  s_mov_b32 s39, 2048
  v_writelane_b32 v13, s39, 48
  s_cmp_eq_u32 s38, 0
  s_mov_b32 s39, 0xffff
  s_cselect_b32 exec_hi, 0x1ffff, s39
  global_store_dwordx2 v13, v[16:17], s[30:31] sc1
  s_mov_b64 exec, -1
  v_mov_b32 v12, 0xffff
  v_mov_b32 v13, 0xffff0000
  v_cmp_eq_u32 vcc, 0, v3
  v_cmp_eq_u32 s[40:41], 1, v3
  s_nop 1
  v_cndmask_b32 v32, 0, v12, vcc
  v_cndmask_b32 v32, v32, v13, s[40:41]
  v_cmp_eq_u32 vcc, 2, v3
  v_cmp_eq_u32 s[40:41], 3, v3
  s_nop 1
  v_cndmask_b32 v33, 0, v12, vcc
  v_cndmask_b32 v33, v33, v13, s[40:41]
  v_cmp_eq_u32 vcc, 4, v3
  v_cmp_eq_u32 s[40:41], 5, v3
  s_nop 1
  v_cndmask_b32 v34, 0, v12, vcc
  v_cndmask_b32 v34, v34, v13, s[40:41]
  v_cmp_eq_u32 vcc, 6, v3
  v_cmp_eq_u32 s[40:41], 7, v3
  s_nop 1
  v_cndmask_b32 v35, 0, v12, vcc
  v_cndmask_b32 v35, v35, v13, s[40:41]
  s_waitcnt vmcnt(35)
  v_lshlrev_b32 v14, 16, v64
  v_and_b32 v15, 0xffff0000, v64
  v_mul_f32 v16, 0xbfb8aa3b, v14
  v_mul_f32 v17, 0xbfb8aa3b, v15
  v_fma_f32 v18, v14, s73, -v16
  v_fma_f32 v19, v15, s73, -v17
  v_fmac_f32 v18, 0xb2a57060, v14
  v_min_f32 v16, 0x42fc0000, v16
  v_fmac_f32 v19, 0xb2a57060, v15
  v_min_f32 v17, 0x42fc0000, v17
  v_exp_f32 v16, v16
  v_exp_f32 v17, v17
  v_mul_f32 v18, 0x3f317218, v18
  v_mul_f32 v19, 0x3f317218, v19
  v_fmac_f32 v16, v16, v18
  v_fmac_f32 v17, v17, v19
  v_add_f32 v16, 1.0, v16
  v_add_f32 v17, 1.0, v17
  v_rcp_f32 v18, v16
  v_rcp_f32 v19, v17
  s_nop 0
  v_mul_f32 v20, v14, v18
  v_mul_f32 v21, v15, v19
  v_fma_f32 v14, -v20, v16, v14
  v_fma_f32 v15, -v21, v17, v15
  v_fma_f32 v14, v14, v18, v20
  v_fma_f32 v15, v15, v19, v21
  v_cvt_pk_bf16_f32 v64, v14, v15
  v_lshlrev_b32 v14, 16, v65
  v_and_b32 v15, 0xffff0000, v65
  v_mul_f32 v16, 0xbfb8aa3b, v14
  v_mul_f32 v17, 0xbfb8aa3b, v15
  v_fma_f32 v18, v14, s73, -v16
  v_fma_f32 v19, v15, s73, -v17
  v_fmac_f32 v18, 0xb2a57060, v14
  v_min_f32 v16, 0x42fc0000, v16
  v_fmac_f32 v19, 0xb2a57060, v15
  v_min_f32 v17, 0x42fc0000, v17
  v_exp_f32 v16, v16
  v_exp_f32 v17, v17
  v_mul_f32 v18, 0x3f317218, v18
  v_mul_f32 v19, 0x3f317218, v19
  v_fmac_f32 v16, v16, v18
  v_fmac_f32 v17, v17, v19
  v_add_f32 v16, 1.0, v16
  v_add_f32 v17, 1.0, v17
  v_rcp_f32 v18, v16
  v_rcp_f32 v19, v17
  s_nop 0
  v_mul_f32 v20, v14, v18
  v_mul_f32 v21, v15, v19
  v_fma_f32 v14, -v20, v16, v14
  v_fma_f32 v15, -v21, v17, v15
  v_fma_f32 v14, v14, v18, v20
  v_fma_f32 v15, v15, v19, v21
  v_cvt_pk_bf16_f32 v65, v14, v15
  v_lshlrev_b32 v14, 16, v66
  v_and_b32 v15, 0xffff0000, v66
  v_mul_f32 v16, 0xbfb8aa3b, v14
  v_mul_f32 v17, 0xbfb8aa3b, v15
  v_fma_f32 v18, v14, s73, -v16
  v_fma_f32 v19, v15, s73, -v17
  v_fmac_f32 v18, 0xb2a57060, v14
  v_min_f32 v16, 0x42fc0000, v16
  v_fmac_f32 v19, 0xb2a57060, v15
  v_min_f32 v17, 0x42fc0000, v17
  v_exp_f32 v16, v16
  v_exp_f32 v17, v17
  v_mul_f32 v18, 0x3f317218, v18
  v_mul_f32 v19, 0x3f317218, v19
  v_fmac_f32 v16, v16, v18
  v_fmac_f32 v17, v17, v19
  v_add_f32 v16, 1.0, v16
  v_add_f32 v17, 1.0, v17
  v_rcp_f32 v18, v16
  v_rcp_f32 v19, v17
  s_nop 0
  v_mul_f32 v20, v14, v18
  v_mul_f32 v21, v15, v19
  v_fma_f32 v14, -v20, v16, v14
  v_fma_f32 v15, -v21, v17, v15
  v_fma_f32 v14, v14, v18, v20
  v_fma_f32 v15, v15, v19, v21
  v_cvt_pk_bf16_f32 v66, v14, v15
  v_lshlrev_b32 v14, 16, v67
  v_and_b32 v15, 0xffff0000, v67
  v_mul_f32 v16, 0xbfb8aa3b, v14
  v_mul_f32 v17, 0xbfb8aa3b, v15
  v_fma_f32 v18, v14, s73, -v16
  v_fma_f32 v19, v15, s73, -v17
  v_fmac_f32 v18, 0xb2a57060, v14
  v_min_f32 v16, 0x42fc0000, v16
  v_fmac_f32 v19, 0xb2a57060, v15
  v_min_f32 v17, 0x42fc0000, v17
  v_exp_f32 v16, v16
  v_exp_f32 v17, v17
  v_mul_f32 v18, 0x3f317218, v18
  v_mul_f32 v19, 0x3f317218, v19
  v_fmac_f32 v16, v16, v18
  v_fmac_f32 v17, v17, v19
  v_add_f32 v16, 1.0, v16
  v_add_f32 v17, 1.0, v17
  v_rcp_f32 v18, v16
  v_rcp_f32 v19, v17
  s_nop 0
  v_mul_f32 v20, v14, v18
  v_mul_f32 v21, v15, v19
  v_fma_f32 v14, -v20, v16, v14
  v_fma_f32 v15, -v21, v17, v15
  v_fma_f32 v14, v14, v18, v20
  v_fma_f32 v15, v15, v19, v21
  v_cvt_pk_bf16_f32 v67, v14, v15
  v_lshlrev_b32 v14, 16, v68
  v_and_b32 v15, 0xffff0000, v68
  v_mul_f32 v16, 0xbfb8aa3b, v14
  v_mul_f32 v17, 0xbfb8aa3b, v15
  v_fma_f32 v18, v14, s73, -v16
  v_fma_f32 v19, v15, s73, -v17
  v_fmac_f32 v18, 0xb2a57060, v14
  v_min_f32 v16, 0x42fc0000, v16
  v_fmac_f32 v19, 0xb2a57060, v15
  v_min_f32 v17, 0x42fc0000, v17
  v_exp_f32 v16, v16
  v_exp_f32 v17, v17
  v_mul_f32 v18, 0x3f317218, v18
  v_mul_f32 v19, 0x3f317218, v19
  v_fmac_f32 v16, v16, v18
  v_fmac_f32 v17, v17, v19
  v_add_f32 v16, 1.0, v16
  v_add_f32 v17, 1.0, v17
  v_rcp_f32 v18, v16
  v_rcp_f32 v19, v17
  s_nop 0
  v_mul_f32 v20, v14, v18
  v_mul_f32 v21, v15, v19
  v_fma_f32 v14, -v20, v16, v14
  v_fma_f32 v15, -v21, v17, v15
  v_fma_f32 v14, v14, v18, v20
  v_fma_f32 v15, v15, v19, v21
  v_cvt_pk_bf16_f32 v68, v14, v15
  v_lshlrev_b32 v14, 16, v69
  v_and_b32 v15, 0xffff0000, v69
  v_mul_f32 v16, 0xbfb8aa3b, v14
  v_mul_f32 v17, 0xbfb8aa3b, v15
  v_fma_f32 v18, v14, s73, -v16
  v_fma_f32 v19, v15, s73, -v17
  v_fmac_f32 v18, 0xb2a57060, v14
  v_min_f32 v16, 0x42fc0000, v16
  v_fmac_f32 v19, 0xb2a57060, v15
  v_min_f32 v17, 0x42fc0000, v17
  v_exp_f32 v16, v16
  v_exp_f32 v17, v17
  v_mul_f32 v18, 0x3f317218, v18
  v_mul_f32 v19, 0x3f317218, v19
  v_fmac_f32 v16, v16, v18
  v_fmac_f32 v17, v17, v19
  v_add_f32 v16, 1.0, v16
  v_add_f32 v17, 1.0, v17
  v_rcp_f32 v18, v16
  v_rcp_f32 v19, v17
  s_nop 0
  v_mul_f32 v20, v14, v18
  v_mul_f32 v21, v15, v19
  v_fma_f32 v14, -v20, v16, v14
  v_fma_f32 v15, -v21, v17, v15
  v_fma_f32 v14, v14, v18, v20
  v_fma_f32 v15, v15, v19, v21
  v_cvt_pk_bf16_f32 v69, v14, v15
  v_lshlrev_b32 v14, 16, v70
  v_and_b32 v15, 0xffff0000, v70
  v_mul_f32 v16, 0xbfb8aa3b, v14
  v_mul_f32 v17, 0xbfb8aa3b, v15
  v_fma_f32 v18, v14, s73, -v16
  v_fma_f32 v19, v15, s73, -v17
  v_fmac_f32 v18, 0xb2a57060, v14
  v_min_f32 v16, 0x42fc0000, v16
  v_fmac_f32 v19, 0xb2a57060, v15
  v_min_f32 v17, 0x42fc0000, v17
  v_exp_f32 v16, v16
  v_exp_f32 v17, v17
  v_mul_f32 v18, 0x3f317218, v18
  v_mul_f32 v19, 0x3f317218, v19
  v_fmac_f32 v16, v16, v18
  v_fmac_f32 v17, v17, v19
  v_add_f32 v16, 1.0, v16
  v_add_f32 v17, 1.0, v17
  v_rcp_f32 v18, v16
  v_rcp_f32 v19, v17
  s_nop 0
  v_mul_f32 v20, v14, v18
  v_mul_f32 v21, v15, v19
  v_fma_f32 v14, -v20, v16, v14
  v_fma_f32 v15, -v21, v17, v15
  v_fma_f32 v14, v14, v18, v20
  v_fma_f32 v15, v15, v19, v21
  v_cvt_pk_bf16_f32 v70, v14, v15
  v_lshlrev_b32 v14, 16, v71
  v_and_b32 v15, 0xffff0000, v71
  v_mul_f32 v16, 0xbfb8aa3b, v14
  v_mul_f32 v17, 0xbfb8aa3b, v15
  v_fma_f32 v18, v14, s73, -v16
  v_fma_f32 v19, v15, s73, -v17
  v_fmac_f32 v18, 0xb2a57060, v14
  v_min_f32 v16, 0x42fc0000, v16
  v_fmac_f32 v19, 0xb2a57060, v15
  v_min_f32 v17, 0x42fc0000, v17
  v_exp_f32 v16, v16
  v_exp_f32 v17, v17
  v_mul_f32 v18, 0x3f317218, v18
  v_mul_f32 v19, 0x3f317218, v19
  v_fmac_f32 v16, v16, v18
  v_fmac_f32 v17, v17, v19
  v_add_f32 v16, 1.0, v16
  v_add_f32 v17, 1.0, v17
  v_rcp_f32 v18, v16
  v_rcp_f32 v19, v17
  s_nop 0
  v_mul_f32 v20, v14, v18
  v_mul_f32 v21, v15, v19
  v_fma_f32 v14, -v20, v16, v14
  v_fma_f32 v15, -v21, v17, v15
  v_fma_f32 v14, v14, v18, v20
  v_fma_f32 v15, v15, v19, v21
  v_cvt_pk_bf16_f32 v71, v14, v15
  v_mov_b32 v12, 0x05040100
  v_mov_b32 v13, 0x07060302
  s_waitcnt vmcnt(27)
  v_perm_b32 v104, v73, v72, v12
  v_perm_b32 v105, v75, v74, v12
  v_perm_b32 v106, v77, v76, v12
  v_perm_b32 v107, v79, v78, v12
  v_perm_b32 v108, v73, v72, v13
  v_perm_b32 v109, v75, v74, v13
  v_perm_b32 v110, v77, v76, v13
  v_perm_b32 v111, v79, v78, v13
  s_nop 1
  v_mfma_f32_16x16x32_bf16 v[112:115], v[64:67], v[104:107], 0
  v_mfma_f32_16x16x32_bf16 v[116:119], v[64:67], v[108:111], 0
  s_waitcnt vmcnt(19)
  v_perm_b32 v104, v81, v80, v12
  v_perm_b32 v105, v83, v82, v12
  v_perm_b32 v106, v85, v84, v12
  v_perm_b32 v107, v87, v86, v12
  v_perm_b32 v108, v81, v80, v13
  v_perm_b32 v109, v83, v82, v13
  v_perm_b32 v110, v85, v84, v13
  v_perm_b32 v111, v87, v86, v13
  s_nop 1
  v_mfma_f32_16x16x32_bf16 v[112:115], v[68:71], v[104:107], v[112:115]
  v_mfma_f32_16x16x32_bf16 v[116:119], v[68:71], v[108:111], v[116:119]
  s_waitcnt vmcnt(11)
  v_perm_b32 v104, v89, v88, v12
  v_perm_b32 v105, v91, v90, v12
  v_perm_b32 v106, v93, v92, v12
  v_perm_b32 v107, v95, v94, v12
  v_perm_b32 v108, v89, v88, v13
  v_perm_b32 v109, v91, v90, v13
  v_perm_b32 v110, v93, v92, v13
  v_perm_b32 v111, v95, v94, v13
  s_nop 1
  v_mfma_f32_16x16x32_bf16 v[120:123], v[64:67], v[104:107], 0
  v_mfma_f32_16x16x32_bf16 v[124:127], v[64:67], v[108:111], 0
  s_waitcnt vmcnt(3)
  v_perm_b32 v104, v97, v96, v12
  v_perm_b32 v105, v99, v98, v12
  v_perm_b32 v106, v101, v100, v12
  v_perm_b32 v107, v103, v102, v12
  v_perm_b32 v108, v97, v96, v13
  v_perm_b32 v109, v99, v98, v13
  v_perm_b32 v110, v101, v100, v13
  v_perm_b32 v111, v103, v102, v13
  s_nop 1
  v_mfma_f32_16x16x32_bf16 v[120:123], v[68:71], v[104:107], v[120:123]
  v_mfma_f32_16x16x32_bf16 v[124:127], v[68:71], v[108:111], v[124:127]
  s_barrier
  v_cmp_gt_u32 vcc, 2, v2
  v_lshrrev_b32 v12, 1, v2
  s_lshl_b32 s38, s36, 1
  v_add_u32 v12, s38, v12
  v_lshlrev_b32 v12, 10, v12
  v_and_b32 v13, 1, v2
  v_lshl_add_u32 v12, v13, 9, v12
  v_lshl_add_u32 v12, v3, 3, v12
  v_cndmask_b32 v16, v120, v112, vcc
  v_cndmask_b32 v18, v121, v113, vcc
  v_cndmask_b32 v20, v122, v114, vcc
  v_cndmask_b32 v22, v123, v115, vcc
  v_cndmask_b32 v17, v124, v116, vcc
  v_cndmask_b32 v19, v125, v117, vcc
  v_cndmask_b32 v21, v126, v118, vcc
  v_cndmask_b32 v23, v127, v119, vcc
  ds_write_b64 v12, v[16:17] offset:16384
  ds_write_b64 v12, v[18:19] offset:16512
  ds_write_b64 v12, v[20:21] offset:16640
  ds_write_b64 v12, v[22:23] offset:16768
  s_waitcnt vmcnt(0)
  s_waitcnt lgkmcnt(0)
  s_mul_i32 s72, s72, 0x9e3779b1
  s_add_u32 s72, s72, 0x7f4a7c15
  s_waitcnt lgkmcnt(0)
  v_mov_b32 v12, 26880
  v_mov_b32 v13, 1
  s_mov_b64 exec, 1
  ds_add_u32 v12, v13
  s_mov_b64 exec, -1
  s_cmp_lg_u32 s36, 0
  s_cbranch_scc1 L_prod_pub
  v_lshrrev_b32 v14, 3, v1
  v_mul_u32_u24 v14, 12288, v14
  v_and_b32 v15, 7, v1
  v_lshl_add_u32 v14, v15, 4, v14
  s_lshl_b32 s38, s35, 7
  s_add_u32 s38, s38, 4096
  v_add_u32 v14, s38, v14
  v_mov_b32 v17, s72
  v_mov_b32 v19, s72
  v_mov_b32 v12, 26880
  s_mov_b32 s71, 0x200000
L_lw51:
  ds_read_b32 v13, v12
  s_sub_u32 s71, s71, 1
  s_cbranch_scc1 L_lwd52
  s_waitcnt lgkmcnt(0)
  v_readfirstlane_b32 s40, v13
  s_nop 0
  s_cmp_lt_u32 s40, 4
  s_cbranch_scc1 L_lw51
L_lwd52:
  s_waitcnt lgkmcnt(0)
  v_lshlrev_b32 v12, 4, v1
  ds_read_b128 v[72:75], v12 offset:16384
  ds_read_b128 v[76:79], v12 offset:17408
  ds_read_b128 v[80:83], v12 offset:18432
  ds_read_b128 v[84:87], v12 offset:19456
  ds_read_b128 v[88:91], v12 offset:20480
  ds_read_b128 v[92:95], v12 offset:21504
  ds_read_b128 v[96:99], v12 offset:22528
  ds_read_b128 v[100:103], v12 offset:23552
  s_waitcnt lgkmcnt(6)
  v_add_f32 v72, v72, v76
  v_add_f32 v73, v73, v77
  v_add_f32 v74, v74, v78
  v_add_f32 v75, v75, v79
  s_waitcnt lgkmcnt(5)
  v_add_f32 v72, v72, v80
  v_add_f32 v73, v73, v81
  v_add_f32 v74, v74, v82
  v_add_f32 v75, v75, v83
  s_waitcnt lgkmcnt(4)
  v_add_f32 v72, v72, v84
  v_add_f32 v73, v73, v85
  v_add_f32 v74, v74, v86
  v_add_f32 v75, v75, v87
  s_waitcnt lgkmcnt(3)
  v_add_f32 v72, v72, v88
  v_add_f32 v73, v73, v89
  v_add_f32 v74, v74, v90
  v_add_f32 v75, v75, v91
  s_waitcnt lgkmcnt(2)
  v_add_f32 v72, v72, v92
  v_add_f32 v73, v73, v93
  v_add_f32 v74, v74, v94
  v_add_f32 v75, v75, v95
  s_waitcnt lgkmcnt(1)
  v_add_f32 v72, v72, v96
  v_add_f32 v73, v73, v97
  v_add_f32 v74, v74, v98
  v_add_f32 v75, v75, v99
  s_waitcnt lgkmcnt(0)
  v_add_f32 v72, v72, v100
  v_add_f32 v73, v73, v101
  v_add_f32 v74, v74, v102
  v_add_f32 v75, v75, v103
  v_cvt_pk_bf16_f32 v16, v72, v73
  v_cvt_pk_bf16_f32 v18, v74, v75
  global_store_dwordx4 v14, v[16:19], s[30:31] sc1
L_prod_pub:
  s_lshl_b32 s38, s36, 20
  s_lshl_b32 s39, s33, 8
  s_add_u32 s38, s38, s39
  s_lshl_b32 s39, s34, 15
  s_add_u32 s41, s38, s39
  s_waitcnt vmcnt(4)
  buffer_load_dwordx4 v[128:131], v10, s[48:51], s41 offen
  buffer_load_dwordx4 v[192:195], v11, s[48:51], s41 offen
  s_add_u32 s39, s39, 16384
  s_and_b32 s39, s39, 0x3ffff
  s_add_u32 s41, s38, s39
  s_waitcnt vmcnt(4)
  buffer_load_dwordx4 v[132:135], v10, s[48:51], s41 offen
  buffer_load_dwordx4 v[196:199], v11, s[48:51], s41 offen
  s_add_u32 s39, s39, 16384
  s_and_b32 s39, s39, 0x3ffff
  s_add_u32 s41, s38, s39
  s_waitcnt vmcnt(4)
  buffer_load_dwordx4 v[136:139], v10, s[48:51], s41 offen
  buffer_load_dwordx4 v[200:203], v11, s[48:51], s41 offen
  s_add_u32 s39, s39, 16384
  s_and_b32 s39, s39, 0x3ffff
  s_add_u32 s41, s38, s39
  s_waitcnt vmcnt(4)
  buffer_load_dwordx4 v[140:143], v10, s[48:51], s41 offen
  buffer_load_dwordx4 v[204:207], v11, s[48:51], s41 offen
  s_add_u32 s39, s39, 16384
  s_and_b32 s39, s39, 0x3ffff
  s_add_u32 s41, s38, s39
  s_waitcnt vmcnt(4)
  buffer_load_dwordx4 v[144:147], v10, s[48:51], s41 offen
  buffer_load_dwordx4 v[208:211], v11, s[48:51], s41 offen
  s_add_u32 s39, s39, 16384
  s_and_b32 s39, s39, 0x3ffff
  s_add_u32 s41, s38, s39
  s_waitcnt vmcnt(4)
  buffer_load_dwordx4 v[148:151], v10, s[48:51], s41 offen
  buffer_load_dwordx4 v[212:215], v11, s[48:51], s41 offen
  s_add_u32 s39, s39, 16384
  s_and_b32 s39, s39, 0x3ffff
  s_add_u32 s41, s38, s39
  s_waitcnt vmcnt(4)
  buffer_load_dwordx4 v[152:155], v10, s[48:51], s41 offen
  buffer_load_dwordx4 v[216:219], v11, s[48:51], s41 offen
  s_add_u32 s39, s39, 16384
  s_and_b32 s39, s39, 0x3ffff
  s_add_u32 s41, s38, s39
  s_waitcnt vmcnt(4)
  buffer_load_dwordx4 v[156:159], v10, s[48:51], s41 offen
  buffer_load_dwordx4 v[220:223], v11, s[48:51], s41 offen
  s_add_u32 s39, s39, 16384
  s_and_b32 s39, s39, 0x3ffff
  s_add_u32 s41, s38, s39
  s_waitcnt vmcnt(4)
  buffer_load_dwordx4 v[160:163], v10, s[48:51], s41 offen
  buffer_load_dwordx4 v[224:227], v11, s[48:51], s41 offen
  s_add_u32 s39, s39, 16384
  s_and_b32 s39, s39, 0x3ffff
  s_add_u32 s41, s38, s39
  s_waitcnt vmcnt(4)
  buffer_load_dwordx4 v[164:167], v10, s[48:51], s41 offen
  buffer_load_dwordx4 v[228:231], v11, s[48:51], s41 offen
  s_add_u32 s39, s39, 16384
  s_and_b32 s39, s39, 0x3ffff
  s_add_u32 s41, s38, s39
  s_waitcnt vmcnt(4)
  buffer_load_dwordx4 v[168:171], v10, s[48:51], s41 offen
  buffer_load_dwordx4 v[232:235], v11, s[48:51], s41 offen
  s_add_u32 s39, s39, 16384
  s_and_b32 s39, s39, 0x3ffff
  s_add_u32 s41, s38, s39
  s_waitcnt vmcnt(4)
  buffer_load_dwordx4 v[172:175], v10, s[48:51], s41 offen
  buffer_load_dwordx4 v[236:239], v11, s[48:51], s41 offen
  s_add_u32 s39, s39, 16384
  s_and_b32 s39, s39, 0x3ffff
  s_add_u32 s41, s38, s39
  s_waitcnt vmcnt(4)
  buffer_load_dwordx4 v[176:179], v10, s[48:51], s41 offen
  buffer_load_dwordx4 v[240:243], v11, s[48:51], s41 offen
  s_add_u32 s39, s39, 16384
  s_and_b32 s39, s39, 0x3ffff
  s_add_u32 s41, s38, s39
  s_waitcnt vmcnt(4)
  buffer_load_dwordx4 v[180:183], v10, s[48:51], s41 offen
  buffer_load_dwordx4 v[244:247], v11, s[48:51], s41 offen
  s_add_u32 s39, s39, 16384
  s_and_b32 s39, s39, 0x3ffff
  s_add_u32 s41, s38, s39
  s_waitcnt vmcnt(4)
  buffer_load_dwordx4 v[184:187], v10, s[48:51], s41 offen
  buffer_load_dwordx4 v[248:251], v11, s[48:51], s41 offen
  s_add_u32 s39, s39, 16384
  s_and_b32 s39, s39, 0x3ffff
  s_add_u32 s41, s38, s39
  s_waitcnt vmcnt(4)
  buffer_load_dwordx4 v[188:191], v10, s[48:51], s41 offen
  buffer_load_dwordx4 v[252:255], v11, s[48:51], s41 offen
  s_branch L_pre_done
L_noprod1:
  s_barrier
  s_lshl_b32 s37, s34, 10
  v_lshlrev_b32 v4, 4, v1
  v_add_u32 v4, s37, v4
  global_load_dwordx4 v[52:55], v4, s[4:5]
  v_add_u32 v7, s37, v6
  global_load_dword v56, v7, s[4:5]
  s_lshl_b32 s38, s36, 20
  s_lshl_b32 s39, s33, 8
  s_add_u32 s38, s38, s39
  s_lshl_b32 s39, s34, 15
  s_add_u32 s41, s38, s39
  s_waitcnt vmcnt(4)
  buffer_load_dwordx4 v[128:131], v10, s[48:51], s41 offen
  buffer_load_dwordx4 v[192:195], v11, s[48:51], s41 offen
  s_add_u32 s39, s39, 16384
  s_and_b32 s39, s39, 0x3ffff
  s_add_u32 s41, s38, s39
  s_waitcnt vmcnt(4)
  buffer_load_dwordx4 v[132:135], v10, s[48:51], s41 offen
  buffer_load_dwordx4 v[196:199], v11, s[48:51], s41 offen
  s_add_u32 s39, s39, 16384
  s_and_b32 s39, s39, 0x3ffff
  s_add_u32 s41, s38, s39
  s_waitcnt vmcnt(4)
  buffer_load_dwordx4 v[136:139], v10, s[48:51], s41 offen
  buffer_load_dwordx4 v[200:203], v11, s[48:51], s41 offen
  s_add_u32 s39, s39, 16384
  s_and_b32 s39, s39, 0x3ffff
  s_add_u32 s41, s38, s39
  s_waitcnt vmcnt(4)
  buffer_load_dwordx4 v[140:143], v10, s[48:51], s41 offen
  buffer_load_dwordx4 v[204:207], v11, s[48:51], s41 offen
  s_add_u32 s39, s39, 16384
  s_and_b32 s39, s39, 0x3ffff
  s_add_u32 s41, s38, s39
  s_waitcnt vmcnt(4)
  buffer_load_dwordx4 v[144:147], v10, s[48:51], s41 offen
  buffer_load_dwordx4 v[208:211], v11, s[48:51], s41 offen
  s_add_u32 s39, s39, 16384
  s_and_b32 s39, s39, 0x3ffff
  s_add_u32 s41, s38, s39
  s_waitcnt vmcnt(4)
  buffer_load_dwordx4 v[148:151], v10, s[48:51], s41 offen
  buffer_load_dwordx4 v[212:215], v11, s[48:51], s41 offen
  s_add_u32 s39, s39, 16384
  s_and_b32 s39, s39, 0x3ffff
  s_add_u32 s41, s38, s39
  s_waitcnt vmcnt(4)
  buffer_load_dwordx4 v[152:155], v10, s[48:51], s41 offen
  buffer_load_dwordx4 v[216:219], v11, s[48:51], s41 offen
  s_add_u32 s39, s39, 16384
  s_and_b32 s39, s39, 0x3ffff
  s_add_u32 s41, s38, s39
  s_waitcnt vmcnt(4)
  buffer_load_dwordx4 v[156:159], v10, s[48:51], s41 offen
  buffer_load_dwordx4 v[220:223], v11, s[48:51], s41 offen
  s_add_u32 s39, s39, 16384
  s_and_b32 s39, s39, 0x3ffff
  s_add_u32 s41, s38, s39
  s_waitcnt vmcnt(4)
  buffer_load_dwordx4 v[160:163], v10, s[48:51], s41 offen
  buffer_load_dwordx4 v[224:227], v11, s[48:51], s41 offen
  s_add_u32 s39, s39, 16384
  s_and_b32 s39, s39, 0x3ffff
  s_add_u32 s41, s38, s39
  s_waitcnt vmcnt(4)
  buffer_load_dwordx4 v[164:167], v10, s[48:51], s41 offen
  buffer_load_dwordx4 v[228:231], v11, s[48:51], s41 offen
  s_add_u32 s39, s39, 16384
  s_and_b32 s39, s39, 0x3ffff
  s_add_u32 s41, s38, s39
  s_waitcnt vmcnt(4)
  buffer_load_dwordx4 v[168:171], v10, s[48:51], s41 offen
  buffer_load_dwordx4 v[232:235], v11, s[48:51], s41 offen
  s_add_u32 s39, s39, 16384
  s_and_b32 s39, s39, 0x3ffff
  s_add_u32 s41, s38, s39
  s_waitcnt vmcnt(4)
  buffer_load_dwordx4 v[172:175], v10, s[48:51], s41 offen
  buffer_load_dwordx4 v[236:239], v11, s[48:51], s41 offen
  s_add_u32 s39, s39, 16384
  s_and_b32 s39, s39, 0x3ffff
  s_add_u32 s41, s38, s39
  s_waitcnt vmcnt(4)
  buffer_load_dwordx4 v[176:179], v10, s[48:51], s41 offen
  buffer_load_dwordx4 v[240:243], v11, s[48:51], s41 offen
  s_add_u32 s39, s39, 16384
  s_and_b32 s39, s39, 0x3ffff
  s_add_u32 s41, s38, s39
  s_waitcnt vmcnt(4)
  buffer_load_dwordx4 v[180:183], v10, s[48:51], s41 offen
  buffer_load_dwordx4 v[244:247], v11, s[48:51], s41 offen
  s_add_u32 s39, s39, 16384
  s_and_b32 s39, s39, 0x3ffff
  s_add_u32 s41, s38, s39
  s_waitcnt vmcnt(4)
  buffer_load_dwordx4 v[184:187], v10, s[48:51], s41 offen
  buffer_load_dwordx4 v[248:251], v11, s[48:51], s41 offen
  s_add_u32 s39, s39, 16384
  s_and_b32 s39, s39, 0x3ffff
  s_add_u32 s41, s38, s39
  s_waitcnt vmcnt(4)
  buffer_load_dwordx4 v[188:191], v10, s[48:51], s41 offen
  buffer_load_dwordx4 v[252:255], v11, s[48:51], s41 offen
  v_mov_b32 v12, 0xffff
  v_mov_b32 v13, 0xffff0000
  v_cmp_eq_u32 vcc, 0, v3
  v_cmp_eq_u32 s[40:41], 1, v3
  s_nop 1
  v_cndmask_b32 v32, 0, v12, vcc
  v_cndmask_b32 v32, v32, v13, s[40:41]
  v_cmp_eq_u32 vcc, 2, v3
  v_cmp_eq_u32 s[40:41], 3, v3
  s_nop 1
  v_cndmask_b32 v33, 0, v12, vcc
  v_cndmask_b32 v33, v33, v13, s[40:41]
  v_cmp_eq_u32 vcc, 4, v3
  v_cmp_eq_u32 s[40:41], 5, v3
  s_nop 1
  v_cndmask_b32 v34, 0, v12, vcc
  v_cndmask_b32 v34, v34, v13, s[40:41]
  v_cmp_eq_u32 vcc, 6, v3
  v_cmp_eq_u32 s[40:41], 7, v3
  s_nop 1
  v_cndmask_b32 v35, 0, v12, vcc
  v_cndmask_b32 v35, v35, v13, s[40:41]
  s_waitcnt vmcnt(32)
  s_waitcnt lgkmcnt(0)
  s_mul_i32 s72, s72, 0x9e3779b1
  s_add_u32 s72, s72, 0x7f4a7c15
L_pre_done:
  v_lshlrev_b32 v12, 16, v52
  v_and_b32 v13, 0xffff0000, v52
  v_lshlrev_b32 v14, 16, v53
  v_and_b32 v15, 0xffff0000, v53
  v_lshlrev_b32 v16, 16, v54
  v_and_b32 v17, 0xffff0000, v54
  v_lshlrev_b32 v18, 16, v55
  v_and_b32 v19, 0xffff0000, v55
  v_add_f32 v20, v12, v13
  v_add_f32 v20, v20, v14
  v_add_f32 v20, v20, v15
  v_add_f32 v20, v20, v16
  v_add_f32 v20, v20, v17
  v_add_f32 v20, v20, v18
  v_add_f32 v20, v20, v19
  s_nop 1
  v_add_f32_dpp v20, v20, v20 row_ror:8 row_mask:0xf bank_mask:0xf
  s_nop 1
  v_add_f32_dpp v20, v20, v20 row_ror:4 row_mask:0xf bank_mask:0xf
  s_nop 1
  v_add_f32_dpp v20, v20, v20 row_ror:2 row_mask:0xf bank_mask:0xf
  s_nop 1
  v_add_f32_dpp v20, v20, v20 row_ror:1 row_mask:0xf bank_mask:0xf
  s_nop 1
  v_add_f32_dpp v20, v20, v20 row_bcast:15 row_mask:0xa bank_mask:0xf
  s_nop 1
  v_add_f32_dpp v20, v20, v20 row_bcast:31 row_mask:0xc bank_mask:0xf
  s_nop 0
  v_readlane_b32 s40, v20, 63
  s_nop 1
  v_mov_b32 v21, 0x3b000000
  v_mul_f32 v21, s40, v21
  v_sub_f32 v22, v12, v21
  v_mul_f32 v20, v22, v22
  v_sub_f32 v22, v13, v21
  v_fmac_f32 v20, v22, v22
  v_sub_f32 v22, v14, v21
  v_fmac_f32 v20, v22, v22
  v_sub_f32 v22, v15, v21
  v_fmac_f32 v20, v22, v22
  v_sub_f32 v22, v16, v21
  v_fmac_f32 v20, v22, v22
  v_sub_f32 v22, v17, v21
  v_fmac_f32 v20, v22, v22
  v_sub_f32 v22, v18, v21
  v_fmac_f32 v20, v22, v22
  v_sub_f32 v22, v19, v21
  v_fmac_f32 v20, v22, v22
  s_nop 1
  v_add_f32_dpp v20, v20, v20 row_ror:8 row_mask:0xf bank_mask:0xf
  s_nop 1
  v_add_f32_dpp v20, v20, v20 row_ror:4 row_mask:0xf bank_mask:0xf
  s_nop 1
  v_add_f32_dpp v20, v20, v20 row_ror:2 row_mask:0xf bank_mask:0xf
  s_nop 1
  v_add_f32_dpp v20, v20, v20 row_ror:1 row_mask:0xf bank_mask:0xf
  s_nop 1
  v_add_f32_dpp v20, v20, v20 row_bcast:15 row_mask:0xa bank_mask:0xf
  s_nop 1
  v_add_f32_dpp v20, v20, v20 row_bcast:31 row_mask:0xc bank_mask:0xf
  s_nop 0
  v_readlane_b32 s40, v20, 63
  s_nop 1
  v_cvt_pk_bf16_f32 v21, v21, v21
  v_and_b32 v21, 0xffff0000, v21
  v_mov_b32 v20, 0x3b000000
  v_mul_f32 v20, s40, v20
  v_cvt_pk_bf16_f32 v20, v20, v20
  v_and_b32 v20, 0xffff0000, v20
  v_add_f32 v20, 0x3727c5ac, v20
  v_cvt_pk_bf16_f32 v20, v20, v20
  v_and_b32 v20, 0xffff0000, v20
  v_sqrt_f32 v20, v20
  s_nop 0
  v_cvt_pk_bf16_f32 v20, v20, v20
  v_and_b32 v20, 0xffff0000, v20
  v_rcp_f32 v20, v20
  s_nop 0
  v_and_b32 v57, 0xffff0000, v56
  v_lshlrev_b32 v56, 16, v56
  v_sub_f32 v56, v56, v21
  v_cvt_pk_bf16_f32 v56, v56, v56
  v_and_b32 v56, 0xffff0000, v56
  v_mul_f32 v56, v56, v20
  v_cvt_pk_bf16_f32 v56, v56, v56
  v_and_b32 v56, 0xffff0000, v56
  v_sub_f32 v57, v57, v21
  v_cvt_pk_bf16_f32 v57, v57, v57
  v_and_b32 v57, 0xffff0000, v57
  v_mul_f32 v57, v57, v20
  v_cvt_pk_bf16_f32 v57, v57, v57
  v_and_b32 v57, 0xffff0000, v57
  s_mul_i32 s38, s34, 12288
  s_add_u32 s38, s38, 4096
  v_lshl_add_u32 v7, v6, 1, s38
  s_mov_b32 s71, 524288
L_sca:
  global_load_dwordx2 v[58:59], v7, s[30:31] sc1
  global_load_dwordx2 v[60:61], v7, s[30:31] offset:2048 sc1
  s_waitcnt vmcnt(0)
  v_cmp_ne_u32 vcc, s72, v59
  v_cmp_ne_u32 s[40:41], s72, v61
  s_sub_u32 s71, s71, 1
  s_cbranch_scc1 L_scad
  s_or_b64 s[40:41], s[40:41], vcc
  s_cbranch_scc1 L_sca
L_scad:
  v_and_b32 v59, 0xffff0000, v58
  v_lshlrev_b32 v58, 16, v58
  v_and_b32 v61, 0xffff0000, v60
  v_lshlrev_b32 v60, 16, v60
  v_add_f32 v60, 1.0, v60
  v_cvt_pk_bf16_f32 v60, v60, v60
  v_and_b32 v60, 0xffff0000, v60
  v_mul_f32 v56, v56, v60
  v_cvt_pk_bf16_f32 v56, v56, v56
  v_and_b32 v56, 0xffff0000, v56
  v_add_f32 v56, v56, v58
  v_cvt_pk_bf16_f32 v44, v56, v56
  v_add_f32 v61, 1.0, v61
  v_cvt_pk_bf16_f32 v61, v61, v61
  v_and_b32 v61, 0xffff0000, v61
  v_mul_f32 v57, v57, v61
  v_cvt_pk_bf16_f32 v57, v57, v57
  v_and_b32 v57, 0xffff0000, v57
  v_add_f32 v57, v57, v59
  v_cvt_pk_bf16_f32 v45, v57, v57
  s_nop 1
  v_and_b32_dpp v36, v44, v32 row_newbcast:0 row_mask:0xf bank_mask:0xf
  v_and_b32_dpp v37, v44, v33 row_newbcast:0 row_mask:0xf bank_mask:0xf
  v_and_b32_dpp v38, v44, v34 row_newbcast:0 row_mask:0xf bank_mask:0xf
  v_and_b32_dpp v39, v44, v35 row_newbcast:0 row_mask:0xf bank_mask:0xf
  v_and_b32_dpp v40, v44, v32 row_newbcast:1 row_mask:0xf bank_mask:0xf
  v_and_b32_dpp v41, v44, v33 row_newbcast:1 row_mask:0xf bank_mask:0xf
  v_and_b32_dpp v42, v44, v34 row_newbcast:1 row_mask:0xf bank_mask:0xf
  v_and_b32_dpp v43, v44, v35 row_newbcast:1 row_mask:0xf bank_mask:0xf
  v_mfma_f32_16x16x32_bf16 v[48:51], v[36:39], v[128:131], 0
  v_and_b32_dpp v36, v44, v32 row_newbcast:2 row_mask:0xf bank_mask:0xf
  v_and_b32_dpp v37, v44, v33 row_newbcast:2 row_mask:0xf bank_mask:0xf
  v_and_b32_dpp v38, v44, v34 row_newbcast:2 row_mask:0xf bank_mask:0xf
  v_and_b32_dpp v39, v44, v35 row_newbcast:2 row_mask:0xf bank_mask:0xf
  v_mfma_f32_16x16x32_bf16 v[48:51], v[40:43], v[132:135], v[48:51]
  v_and_b32_dpp v40, v44, v32 row_newbcast:3 row_mask:0xf bank_mask:0xf
  v_and_b32_dpp v41, v44, v33 row_newbcast:3 row_mask:0xf bank_mask:0xf
  v_and_b32_dpp v42, v44, v34 row_newbcast:3 row_mask:0xf bank_mask:0xf
  v_and_b32_dpp v43, v44, v35 row_newbcast:3 row_mask:0xf bank_mask:0xf
  v_mfma_f32_16x16x32_bf16 v[48:51], v[36:39], v[136:139], v[48:51]
  v_and_b32_dpp v36, v44, v32 row_newbcast:4 row_mask:0xf bank_mask:0xf
  v_and_b32_dpp v37, v44, v33 row_newbcast:4 row_mask:0xf bank_mask:0xf
  v_and_b32_dpp v38, v44, v34 row_newbcast:4 row_mask:0xf bank_mask:0xf
  v_and_b32_dpp v39, v44, v35 row_newbcast:4 row_mask:0xf bank_mask:0xf
  v_mfma_f32_16x16x32_bf16 v[48:51], v[40:43], v[140:143], v[48:51]
  v_and_b32_dpp v40, v44, v32 row_newbcast:5 row_mask:0xf bank_mask:0xf
  v_and_b32_dpp v41, v44, v33 row_newbcast:5 row_mask:0xf bank_mask:0xf
  v_and_b32_dpp v42, v44, v34 row_newbcast:5 row_mask:0xf bank_mask:0xf
  v_and_b32_dpp v43, v44, v35 row_newbcast:5 row_mask:0xf bank_mask:0xf
  v_mfma_f32_16x16x32_bf16 v[48:51], v[36:39], v[144:147], v[48:51]
  v_and_b32_dpp v36, v44, v32 row_newbcast:6 row_mask:0xf bank_mask:0xf
  v_and_b32_dpp v37, v44, v33 row_newbcast:6 row_mask:0xf bank_mask:0xf
  v_and_b32_dpp v38, v44, v34 row_newbcast:6 row_mask:0xf bank_mask:0xf
  v_and_b32_dpp v39, v44, v35 row_newbcast:6 row_mask:0xf bank_mask:0xf
  v_mfma_f32_16x16x32_bf16 v[48:51], v[40:43], v[148:151], v[48:51]
  v_and_b32_dpp v40, v44, v32 row_newbcast:7 row_mask:0xf bank_mask:0xf
  v_and_b32_dpp v41, v44, v33 row_newbcast:7 row_mask:0xf bank_mask:0xf
  v_and_b32_dpp v42, v44, v34 row_newbcast:7 row_mask:0xf bank_mask:0xf
  v_and_b32_dpp v43, v44, v35 row_newbcast:7 row_mask:0xf bank_mask:0xf
  v_mfma_f32_16x16x32_bf16 v[48:51], v[36:39], v[152:155], v[48:51]
  v_and_b32_dpp v36, v44, v32 row_newbcast:8 row_mask:0xf bank_mask:0xf
  v_and_b32_dpp v37, v44, v33 row_newbcast:8 row_mask:0xf bank_mask:0xf
  v_and_b32_dpp v38, v44, v34 row_newbcast:8 row_mask:0xf bank_mask:0xf
  v_and_b32_dpp v39, v44, v35 row_newbcast:8 row_mask:0xf bank_mask:0xf
  v_mfma_f32_16x16x32_bf16 v[48:51], v[40:43], v[156:159], v[48:51]
  v_and_b32_dpp v40, v44, v32 row_newbcast:9 row_mask:0xf bank_mask:0xf
  v_and_b32_dpp v41, v44, v33 row_newbcast:9 row_mask:0xf bank_mask:0xf
  v_and_b32_dpp v42, v44, v34 row_newbcast:9 row_mask:0xf bank_mask:0xf
  v_and_b32_dpp v43, v44, v35 row_newbcast:9 row_mask:0xf bank_mask:0xf
  v_mfma_f32_16x16x32_bf16 v[48:51], v[36:39], v[160:163], v[48:51]
  v_and_b32_dpp v36, v44, v32 row_newbcast:10 row_mask:0xf bank_mask:0xf
  v_and_b32_dpp v37, v44, v33 row_newbcast:10 row_mask:0xf bank_mask:0xf
  v_and_b32_dpp v38, v44, v34 row_newbcast:10 row_mask:0xf bank_mask:0xf
  v_and_b32_dpp v39, v44, v35 row_newbcast:10 row_mask:0xf bank_mask:0xf
  v_mfma_f32_16x16x32_bf16 v[48:51], v[40:43], v[164:167], v[48:51]
  v_and_b32_dpp v40, v44, v32 row_newbcast:11 row_mask:0xf bank_mask:0xf
  v_and_b32_dpp v41, v44, v33 row_newbcast:11 row_mask:0xf bank_mask:0xf
  v_and_b32_dpp v42, v44, v34 row_newbcast:11 row_mask:0xf bank_mask:0xf
  v_and_b32_dpp v43, v44, v35 row_newbcast:11 row_mask:0xf bank_mask:0xf
  v_mfma_f32_16x16x32_bf16 v[48:51], v[36:39], v[168:171], v[48:51]
  v_and_b32_dpp v36, v44, v32 row_newbcast:12 row_mask:0xf bank_mask:0xf
  v_and_b32_dpp v37, v44, v33 row_newbcast:12 row_mask:0xf bank_mask:0xf
  v_and_b32_dpp v38, v44, v34 row_newbcast:12 row_mask:0xf bank_mask:0xf
  v_and_b32_dpp v39, v44, v35 row_newbcast:12 row_mask:0xf bank_mask:0xf
  v_mfma_f32_16x16x32_bf16 v[48:51], v[40:43], v[172:175], v[48:51]
  v_and_b32_dpp v40, v44, v32 row_newbcast:13 row_mask:0xf bank_mask:0xf
  v_and_b32_dpp v41, v44, v33 row_newbcast:13 row_mask:0xf bank_mask:0xf
  v_and_b32_dpp v42, v44, v34 row_newbcast:13 row_mask:0xf bank_mask:0xf
  v_and_b32_dpp v43, v44, v35 row_newbcast:13 row_mask:0xf bank_mask:0xf
  v_mfma_f32_16x16x32_bf16 v[48:51], v[36:39], v[176:179], v[48:51]
  v_and_b32_dpp v36, v44, v32 row_newbcast:14 row_mask:0xf bank_mask:0xf
  v_and_b32_dpp v37, v44, v33 row_newbcast:14 row_mask:0xf bank_mask:0xf
  v_and_b32_dpp v38, v44, v34 row_newbcast:14 row_mask:0xf bank_mask:0xf
  v_and_b32_dpp v39, v44, v35 row_newbcast:14 row_mask:0xf bank_mask:0xf
  v_mfma_f32_16x16x32_bf16 v[48:51], v[40:43], v[180:183], v[48:51]
  v_and_b32_dpp v40, v44, v32 row_newbcast:15 row_mask:0xf bank_mask:0xf
  v_and_b32_dpp v41, v44, v33 row_newbcast:15 row_mask:0xf bank_mask:0xf
  v_and_b32_dpp v42, v44, v34 row_newbcast:15 row_mask:0xf bank_mask:0xf
  v_and_b32_dpp v43, v44, v35 row_newbcast:15 row_mask:0xf bank_mask:0xf
  v_mfma_f32_16x16x32_bf16 v[48:51], v[36:39], v[184:187], v[48:51]
  v_and_b32_dpp v36, v45, v32 row_newbcast:0 row_mask:0xf bank_mask:0xf
  v_and_b32_dpp v37, v45, v33 row_newbcast:0 row_mask:0xf bank_mask:0xf
  v_and_b32_dpp v38, v45, v34 row_newbcast:0 row_mask:0xf bank_mask:0xf
  v_and_b32_dpp v39, v45, v35 row_newbcast:0 row_mask:0xf bank_mask:0xf
  v_mfma_f32_16x16x32_bf16 v[48:51], v[40:43], v[188:191], v[48:51]
  v_and_b32_dpp v40, v45, v32 row_newbcast:1 row_mask:0xf bank_mask:0xf
  v_and_b32_dpp v41, v45, v33 row_newbcast:1 row_mask:0xf bank_mask:0xf
  v_and_b32_dpp v42, v45, v34 row_newbcast:1 row_mask:0xf bank_mask:0xf
  v_and_b32_dpp v43, v45, v35 row_newbcast:1 row_mask:0xf bank_mask:0xf
  v_mfma_f32_16x16x32_bf16 v[48:51], v[36:39], v[192:195], v[48:51]
  v_and_b32_dpp v36, v45, v32 row_newbcast:2 row_mask:0xf bank_mask:0xf
  v_and_b32_dpp v37, v45, v33 row_newbcast:2 row_mask:0xf bank_mask:0xf
  v_and_b32_dpp v38, v45, v34 row_newbcast:2 row_mask:0xf bank_mask:0xf
  v_and_b32_dpp v39, v45, v35 row_newbcast:2 row_mask:0xf bank_mask:0xf
  v_mfma_f32_16x16x32_bf16 v[48:51], v[40:43], v[196:199], v[48:51]
  v_and_b32_dpp v40, v45, v32 row_newbcast:3 row_mask:0xf bank_mask:0xf
  v_and_b32_dpp v41, v45, v33 row_newbcast:3 row_mask:0xf bank_mask:0xf
  v_and_b32_dpp v42, v45, v34 row_newbcast:3 row_mask:0xf bank_mask:0xf
  v_and_b32_dpp v43, v45, v35 row_newbcast:3 row_mask:0xf bank_mask:0xf
  v_mfma_f32_16x16x32_bf16 v[48:51], v[36:39], v[200:203], v[48:51]
  v_and_b32_dpp v36, v45, v32 row_newbcast:4 row_mask:0xf bank_mask:0xf
  v_and_b32_dpp v37, v45, v33 row_newbcast:4 row_mask:0xf bank_mask:0xf
  v_and_b32_dpp v38, v45, v34 row_newbcast:4 row_mask:0xf bank_mask:0xf
  v_and_b32_dpp v39, v45, v35 row_newbcast:4 row_mask:0xf bank_mask:0xf
  v_mfma_f32_16x16x32_bf16 v[48:51], v[40:43], v[204:207], v[48:51]
  v_and_b32_dpp v40, v45, v32 row_newbcast:5 row_mask:0xf bank_mask:0xf
  v_and_b32_dpp v41, v45, v33 row_newbcast:5 row_mask:0xf bank_mask:0xf
  v_and_b32_dpp v42, v45, v34 row_newbcast:5 row_mask:0xf bank_mask:0xf
  v_and_b32_dpp v43, v45, v35 row_newbcast:5 row_mask:0xf bank_mask:0xf
  v_mfma_f32_16x16x32_bf16 v[48:51], v[36:39], v[208:211], v[48:51]
  v_and_b32_dpp v36, v45, v32 row_newbcast:6 row_mask:0xf bank_mask:0xf
  v_and_b32_dpp v37, v45, v33 row_newbcast:6 row_mask:0xf bank_mask:0xf
  v_and_b32_dpp v38, v45, v34 row_newbcast:6 row_mask:0xf bank_mask:0xf
  v_and_b32_dpp v39, v45, v35 row_newbcast:6 row_mask:0xf bank_mask:0xf
  v_mfma_f32_16x16x32_bf16 v[48:51], v[40:43], v[212:215], v[48:51]
  v_and_b32_dpp v40, v45, v32 row_newbcast:7 row_mask:0xf bank_mask:0xf
  v_and_b32_dpp v41, v45, v33 row_newbcast:7 row_mask:0xf bank_mask:0xf
  v_and_b32_dpp v42, v45, v34 row_newbcast:7 row_mask:0xf bank_mask:0xf
  v_and_b32_dpp v43, v45, v35 row_newbcast:7 row_mask:0xf bank_mask:0xf
  v_mfma_f32_16x16x32_bf16 v[48:51], v[36:39], v[216:219], v[48:51]
  v_and_b32_dpp v36, v45, v32 row_newbcast:8 row_mask:0xf bank_mask:0xf
  v_and_b32_dpp v37, v45, v33 row_newbcast:8 row_mask:0xf bank_mask:0xf
  v_and_b32_dpp v38, v45, v34 row_newbcast:8 row_mask:0xf bank_mask:0xf
  v_and_b32_dpp v39, v45, v35 row_newbcast:8 row_mask:0xf bank_mask:0xf
  v_mfma_f32_16x16x32_bf16 v[48:51], v[40:43], v[220:223], v[48:51]
  v_and_b32_dpp v40, v45, v32 row_newbcast:9 row_mask:0xf bank_mask:0xf
  v_and_b32_dpp v41, v45, v33 row_newbcast:9 row_mask:0xf bank_mask:0xf
  v_and_b32_dpp v42, v45, v34 row_newbcast:9 row_mask:0xf bank_mask:0xf
  v_and_b32_dpp v43, v45, v35 row_newbcast:9 row_mask:0xf bank_mask:0xf
  v_mfma_f32_16x16x32_bf16 v[48:51], v[36:39], v[224:227], v[48:51]
  v_and_b32_dpp v36, v45, v32 row_newbcast:10 row_mask:0xf bank_mask:0xf
  v_and_b32_dpp v37, v45, v33 row_newbcast:10 row_mask:0xf bank_mask:0xf
  v_and_b32_dpp v38, v45, v34 row_newbcast:10 row_mask:0xf bank_mask:0xf
  v_and_b32_dpp v39, v45, v35 row_newbcast:10 row_mask:0xf bank_mask:0xf
  v_mfma_f32_16x16x32_bf16 v[48:51], v[40:43], v[228:231], v[48:51]
  v_and_b32_dpp v40, v45, v32 row_newbcast:11 row_mask:0xf bank_mask:0xf
  v_and_b32_dpp v41, v45, v33 row_newbcast:11 row_mask:0xf bank_mask:0xf
  v_and_b32_dpp v42, v45, v34 row_newbcast:11 row_mask:0xf bank_mask:0xf
  v_and_b32_dpp v43, v45, v35 row_newbcast:11 row_mask:0xf bank_mask:0xf
  v_mfma_f32_16x16x32_bf16 v[48:51], v[36:39], v[232:235], v[48:51]
  v_and_b32_dpp v36, v45, v32 row_newbcast:12 row_mask:0xf bank_mask:0xf
  v_and_b32_dpp v37, v45, v33 row_newbcast:12 row_mask:0xf bank_mask:0xf
  v_and_b32_dpp v38, v45, v34 row_newbcast:12 row_mask:0xf bank_mask:0xf
  v_and_b32_dpp v39, v45, v35 row_newbcast:12 row_mask:0xf bank_mask:0xf
  v_mfma_f32_16x16x32_bf16 v[48:51], v[40:43], v[236:239], v[48:51]
  v_and_b32_dpp v40, v45, v32 row_newbcast:13 row_mask:0xf bank_mask:0xf
  v_and_b32_dpp v41, v45, v33 row_newbcast:13 row_mask:0xf bank_mask:0xf
  v_and_b32_dpp v42, v45, v34 row_newbcast:13 row_mask:0xf bank_mask:0xf
  v_and_b32_dpp v43, v45, v35 row_newbcast:13 row_mask:0xf bank_mask:0xf
  v_mfma_f32_16x16x32_bf16 v[48:51], v[36:39], v[240:243], v[48:51]
  v_and_b32_dpp v36, v45, v32 row_newbcast:14 row_mask:0xf bank_mask:0xf
  v_and_b32_dpp v37, v45, v33 row_newbcast:14 row_mask:0xf bank_mask:0xf
  v_and_b32_dpp v38, v45, v34 row_newbcast:14 row_mask:0xf bank_mask:0xf
  v_and_b32_dpp v39, v45, v35 row_newbcast:14 row_mask:0xf bank_mask:0xf
  v_mfma_f32_16x16x32_bf16 v[48:51], v[40:43], v[244:247], v[48:51]
  v_and_b32_dpp v40, v45, v32 row_newbcast:15 row_mask:0xf bank_mask:0xf
  v_and_b32_dpp v41, v45, v33 row_newbcast:15 row_mask:0xf bank_mask:0xf
  v_and_b32_dpp v42, v45, v34 row_newbcast:15 row_mask:0xf bank_mask:0xf
  v_and_b32_dpp v43, v45, v35 row_newbcast:15 row_mask:0xf bank_mask:0xf
  v_mfma_f32_16x16x32_bf16 v[48:51], v[36:39], v[248:251], v[48:51]
  s_nop 1
  v_mfma_f32_16x16x32_bf16 v[48:51], v[40:43], v[252:255], v[48:51]
  s_nop 7
  s_nop 1
  v_lshlrev_b32 v12, 5, v3
  v_lshl_add_u32 v12, v2, 4, v12
  s_lshl_b32 s38, s36, 9
  v_add_u32 v12, s38, v12
  s_mov_b32 exec_lo, -1
  s_mov_b32 exec_hi, 0x0
  ds_write_b128 v12, v[48:51] offset:24576
  s_mov_b64 exec, -1
  s_waitcnt lgkmcnt(0)
  v_mov_b32 v12, 26884
  v_mov_b32 v13, 1
  s_mov_b64 exec, 1
  ds_add_u32 v12, v13
  s_mov_b64 exec, -1
  s_cmp_lg_u32 s36, 0
  s_cbranch_scc1 L_qdone
  v_mov_b32 v12, 26884
  s_mov_b32 s71, 0x200000
L_lw53:
  ds_read_b32 v13, v12
  s_sub_u32 s71, s71, 1
  s_cbranch_scc1 L_lwd54
  s_waitcnt lgkmcnt(0)
  v_readfirstlane_b32 s40, v13
  s_nop 0
  s_cmp_lt_u32 s40, 4
  s_cbranch_scc1 L_lw53
L_lwd54:
  s_waitcnt lgkmcnt(0)
  v_and_b32 v12, 31, v1
  v_lshlrev_b32 v12, 4, v12
  ds_read_b128 v[16:19], v12 offset:24576
  ds_read_b128 v[20:23], v12 offset:25088
  ds_read_b128 v[24:27], v12 offset:25600
  ds_read_b128 v[28:31], v12 offset:26112
  s_waitcnt lgkmcnt(2)
  v_add_f32 v16, v16, v20
  v_add_f32 v17, v17, v21
  v_add_f32 v18, v18, v22
  v_add_f32 v19, v19, v23
  s_waitcnt lgkmcnt(1)
  v_add_f32 v16, v16, v24
  v_add_f32 v17, v17, v25
  v_add_f32 v18, v18, v26
  v_add_f32 v19, v19, v27
  s_waitcnt lgkmcnt(0)
  v_add_f32 v16, v16, v28
  v_add_f32 v17, v17, v29
  v_add_f32 v18, v18, v30
  v_add_f32 v19, v19, v31
  v_cvt_pk_bf16_f32 v14, v16, v17
  v_cvt_pk_bf16_f32 v15, v18, v19
  v_lshrrev_b32 v12, 1, v12
  ds_write_b64 v12, v[14:15] offset:26624
  s_waitcnt lgkmcnt(0)
L_qdone:
  s_barrier
  s_sub_u32 s38, s2, 32
  s_cmp_ge_u32 s38, 64
  s_cbranch_scc1 L_late_done
  v_and_b32 v8, 7, v3
  v_lshlrev_b32 v8, 10, v8
  v_lshrrev_b32 v9, 3, v3
  v_lshl_add_u32 v8, v9, 7, v8
  v_lshl_add_u32 v8, v2, 4, v8
  s_lshl_b32 s38, s36, 8
  v_add_u32 v8, s38, v8
  global_load_dwordx4 v[64:67], v8, s[22:23]
  global_load_dwordx4 v[68:71], v8, s[22:23] offset:64
  s_mov_b32 s44, s24
  s_mov_b32 s45, s25
  s_mov_b32 s46, 0x300000
  s_mov_b32 s47, 0x20000
  v_mul_u32_u24 v9, 49152, v2
  v_lshl_add_u32 v9, v3, 2, v9
  s_mul_i32 s38, s36, 786432
  s_lshl_b32 s39, s35, 6
  s_add_u32 s38, s38, s39
  s_waitcnt vmcnt(8)
  buffer_load_dword v72, v9, s[44:47], s38 offen
  s_add_u32 s38, s38, 6144
  s_waitcnt vmcnt(8)
  buffer_load_dword v73, v9, s[44:47], s38 offen
  s_add_u32 s38, s38, 6144
  s_waitcnt vmcnt(8)
  buffer_load_dword v74, v9, s[44:47], s38 offen
  s_add_u32 s38, s38, 6144
  s_waitcnt vmcnt(8)
  buffer_load_dword v75, v9, s[44:47], s38 offen
  s_add_u32 s38, s38, 6144
  s_waitcnt vmcnt(8)
  buffer_load_dword v76, v9, s[44:47], s38 offen
  s_add_u32 s38, s38, 6144
  s_waitcnt vmcnt(8)
  buffer_load_dword v77, v9, s[44:47], s38 offen
  s_add_u32 s38, s38, 6144
  s_waitcnt vmcnt(8)
  buffer_load_dword v78, v9, s[44:47], s38 offen
  s_add_u32 s38, s38, 6144
  s_waitcnt vmcnt(8)
  buffer_load_dword v79, v9, s[44:47], s38 offen
  s_add_u32 s38, s38, 153600
  s_waitcnt vmcnt(8)
  buffer_load_dword v80, v9, s[44:47], s38 offen
  s_add_u32 s38, s38, 6144
  s_waitcnt vmcnt(8)
  buffer_load_dword v81, v9, s[44:47], s38 offen
  s_add_u32 s38, s38, 6144
  s_waitcnt vmcnt(8)
  buffer_load_dword v82, v9, s[44:47], s38 offen
  s_add_u32 s38, s38, 6144
  s_waitcnt vmcnt(8)
  buffer_load_dword v83, v9, s[44:47], s38 offen
  s_add_u32 s38, s38, 6144
  s_waitcnt vmcnt(8)
  buffer_load_dword v84, v9, s[44:47], s38 offen
  s_add_u32 s38, s38, 6144
  s_waitcnt vmcnt(8)
  buffer_load_dword v85, v9, s[44:47], s38 offen
  s_add_u32 s38, s38, 6144
  s_waitcnt vmcnt(8)
  buffer_load_dword v86, v9, s[44:47], s38 offen
  s_add_u32 s38, s38, 6144
  s_waitcnt vmcnt(8)
  buffer_load_dword v87, v9, s[44:47], s38 offen
  s_add_u32 s38, s38, 153600
  s_waitcnt vmcnt(8)
  buffer_load_dword v88, v9, s[44:47], s38 offen
  s_add_u32 s38, s38, 6144
  s_waitcnt vmcnt(8)
  buffer_load_dword v89, v9, s[44:47], s38 offen
  s_add_u32 s38, s38, 6144
  s_waitcnt vmcnt(8)
  buffer_load_dword v90, v9, s[44:47], s38 offen
  s_add_u32 s38, s38, 6144
  s_waitcnt vmcnt(8)
  buffer_load_dword v91, v9, s[44:47], s38 offen
  s_add_u32 s38, s38, 6144
  s_waitcnt vmcnt(8)
  buffer_load_dword v92, v9, s[44:47], s38 offen
  s_add_u32 s38, s38, 6144
  s_waitcnt vmcnt(8)
  buffer_load_dword v93, v9, s[44:47], s38 offen
  s_add_u32 s38, s38, 6144
  s_waitcnt vmcnt(8)
  buffer_load_dword v94, v9, s[44:47], s38 offen
  s_add_u32 s38, s38, 6144
  s_waitcnt vmcnt(8)
  buffer_load_dword v95, v9, s[44:47], s38 offen
  s_add_u32 s38, s38, 153600
  s_waitcnt vmcnt(8)
  buffer_load_dword v96, v9, s[44:47], s38 offen
  s_add_u32 s38, s38, 6144
  s_waitcnt vmcnt(8)
  buffer_load_dword v97, v9, s[44:47], s38 offen
  s_add_u32 s38, s38, 6144
  s_waitcnt vmcnt(8)
  buffer_load_dword v98, v9, s[44:47], s38 offen
  s_add_u32 s38, s38, 6144
  s_waitcnt vmcnt(8)
  buffer_load_dword v99, v9, s[44:47], s38 offen
  s_add_u32 s38, s38, 6144
  s_waitcnt vmcnt(8)
  buffer_load_dword v100, v9, s[44:47], s38 offen
  s_add_u32 s38, s38, 6144
  s_waitcnt vmcnt(8)
  buffer_load_dword v101, v9, s[44:47], s38 offen
  s_add_u32 s38, s38, 6144
  s_waitcnt vmcnt(8)
  buffer_load_dword v102, v9, s[44:47], s38 offen
  s_add_u32 s38, s38, 6144
  s_waitcnt vmcnt(8)
  buffer_load_dword v103, v9, s[44:47], s38 offen
  s_waitcnt vmcnt(32)
  v_lshlrev_b32 v14, 16, v64
  v_and_b32 v15, 0xffff0000, v64
  v_mul_f32 v16, 0xbfb8aa3b, v14
  v_mul_f32 v17, 0xbfb8aa3b, v15
  v_fma_f32 v18, v14, s73, -v16
  v_fma_f32 v19, v15, s73, -v17
  v_fmac_f32 v18, 0xb2a57060, v14
  v_min_f32 v16, 0x42fc0000, v16
  v_fmac_f32 v19, 0xb2a57060, v15
  v_min_f32 v17, 0x42fc0000, v17
  v_exp_f32 v16, v16
  v_exp_f32 v17, v17
  v_mul_f32 v18, 0x3f317218, v18
  v_mul_f32 v19, 0x3f317218, v19
  v_fmac_f32 v16, v16, v18
  v_fmac_f32 v17, v17, v19
  v_add_f32 v16, 1.0, v16
  v_add_f32 v17, 1.0, v17
  v_rcp_f32 v18, v16
  v_rcp_f32 v19, v17
  s_nop 0
  v_mul_f32 v20, v14, v18
  v_mul_f32 v21, v15, v19
  v_fma_f32 v14, -v20, v16, v14
  v_fma_f32 v15, -v21, v17, v15
  v_fma_f32 v14, v14, v18, v20
  v_fma_f32 v15, v15, v19, v21
  v_cvt_pk_bf16_f32 v64, v14, v15
  v_lshlrev_b32 v14, 16, v65
  v_and_b32 v15, 0xffff0000, v65
  v_mul_f32 v16, 0xbfb8aa3b, v14
  v_mul_f32 v17, 0xbfb8aa3b, v15
  v_fma_f32 v18, v14, s73, -v16
  v_fma_f32 v19, v15, s73, -v17
  v_fmac_f32 v18, 0xb2a57060, v14
  v_min_f32 v16, 0x42fc0000, v16
  v_fmac_f32 v19, 0xb2a57060, v15
  v_min_f32 v17, 0x42fc0000, v17
  v_exp_f32 v16, v16
  v_exp_f32 v17, v17
  v_mul_f32 v18, 0x3f317218, v18
  v_mul_f32 v19, 0x3f317218, v19
  v_fmac_f32 v16, v16, v18
  v_fmac_f32 v17, v17, v19
  v_add_f32 v16, 1.0, v16
  v_add_f32 v17, 1.0, v17
  v_rcp_f32 v18, v16
  v_rcp_f32 v19, v17
  s_nop 0
  v_mul_f32 v20, v14, v18
  v_mul_f32 v21, v15, v19
  v_fma_f32 v14, -v20, v16, v14
  v_fma_f32 v15, -v21, v17, v15
  v_fma_f32 v14, v14, v18, v20
  v_fma_f32 v15, v15, v19, v21
  v_cvt_pk_bf16_f32 v65, v14, v15
  v_lshlrev_b32 v14, 16, v66
  v_and_b32 v15, 0xffff0000, v66
  v_mul_f32 v16, 0xbfb8aa3b, v14
  v_mul_f32 v17, 0xbfb8aa3b, v15
  v_fma_f32 v18, v14, s73, -v16
  v_fma_f32 v19, v15, s73, -v17
  v_fmac_f32 v18, 0xb2a57060, v14
  v_min_f32 v16, 0x42fc0000, v16
  v_fmac_f32 v19, 0xb2a57060, v15
  v_min_f32 v17, 0x42fc0000, v17
  v_exp_f32 v16, v16
  v_exp_f32 v17, v17
  v_mul_f32 v18, 0x3f317218, v18
  v_mul_f32 v19, 0x3f317218, v19
  v_fmac_f32 v16, v16, v18
  v_fmac_f32 v17, v17, v19
  v_add_f32 v16, 1.0, v16
  v_add_f32 v17, 1.0, v17
  v_rcp_f32 v18, v16
  v_rcp_f32 v19, v17
  s_nop 0
  v_mul_f32 v20, v14, v18
  v_mul_f32 v21, v15, v19
  v_fma_f32 v14, -v20, v16, v14
  v_fma_f32 v15, -v21, v17, v15
  v_fma_f32 v14, v14, v18, v20
  v_fma_f32 v15, v15, v19, v21
  v_cvt_pk_bf16_f32 v66, v14, v15
  v_lshlrev_b32 v14, 16, v67
  v_and_b32 v15, 0xffff0000, v67
  v_mul_f32 v16, 0xbfb8aa3b, v14
  v_mul_f32 v17, 0xbfb8aa3b, v15
  v_fma_f32 v18, v14, s73, -v16
  v_fma_f32 v19, v15, s73, -v17
  v_fmac_f32 v18, 0xb2a57060, v14
  v_min_f32 v16, 0x42fc0000, v16
  v_fmac_f32 v19, 0xb2a57060, v15
  v_min_f32 v17, 0x42fc0000, v17
  v_exp_f32 v16, v16
  v_exp_f32 v17, v17
  v_mul_f32 v18, 0x3f317218, v18
  v_mul_f32 v19, 0x3f317218, v19
  v_fmac_f32 v16, v16, v18
  v_fmac_f32 v17, v17, v19
  v_add_f32 v16, 1.0, v16
  v_add_f32 v17, 1.0, v17
  v_rcp_f32 v18, v16
  v_rcp_f32 v19, v17
  s_nop 0
  v_mul_f32 v20, v14, v18
  v_mul_f32 v21, v15, v19
  v_fma_f32 v14, -v20, v16, v14
  v_fma_f32 v15, -v21, v17, v15
  v_fma_f32 v14, v14, v18, v20
  v_fma_f32 v15, v15, v19, v21
  v_cvt_pk_bf16_f32 v67, v14, v15
  v_lshlrev_b32 v14, 16, v68
  v_and_b32 v15, 0xffff0000, v68
  v_mul_f32 v16, 0xbfb8aa3b, v14
  v_mul_f32 v17, 0xbfb8aa3b, v15
  v_fma_f32 v18, v14, s73, -v16
  v_fma_f32 v19, v15, s73, -v17
  v_fmac_f32 v18, 0xb2a57060, v14
  v_min_f32 v16, 0x42fc0000, v16
  v_fmac_f32 v19, 0xb2a57060, v15
  v_min_f32 v17, 0x42fc0000, v17
  v_exp_f32 v16, v16
  v_exp_f32 v17, v17
  v_mul_f32 v18, 0x3f317218, v18
  v_mul_f32 v19, 0x3f317218, v19
  v_fmac_f32 v16, v16, v18
  v_fmac_f32 v17, v17, v19
  v_add_f32 v16, 1.0, v16
  v_add_f32 v17, 1.0, v17
  v_rcp_f32 v18, v16
  v_rcp_f32 v19, v17
  s_nop 0
  v_mul_f32 v20, v14, v18
  v_mul_f32 v21, v15, v19
  v_fma_f32 v14, -v20, v16, v14
  v_fma_f32 v15, -v21, v17, v15
  v_fma_f32 v14, v14, v18, v20
  v_fma_f32 v15, v15, v19, v21
  v_cvt_pk_bf16_f32 v68, v14, v15
  v_lshlrev_b32 v14, 16, v69
  v_and_b32 v15, 0xffff0000, v69
  v_mul_f32 v16, 0xbfb8aa3b, v14
  v_mul_f32 v17, 0xbfb8aa3b, v15
  v_fma_f32 v18, v14, s73, -v16
  v_fma_f32 v19, v15, s73, -v17
  v_fmac_f32 v18, 0xb2a57060, v14
  v_min_f32 v16, 0x42fc0000, v16
  v_fmac_f32 v19, 0xb2a57060, v15
  v_min_f32 v17, 0x42fc0000, v17
  v_exp_f32 v16, v16
  v_exp_f32 v17, v17
  v_mul_f32 v18, 0x3f317218, v18
  v_mul_f32 v19, 0x3f317218, v19
  v_fmac_f32 v16, v16, v18
  v_fmac_f32 v17, v17, v19
  v_add_f32 v16, 1.0, v16
  v_add_f32 v17, 1.0, v17
  v_rcp_f32 v18, v16
  v_rcp_f32 v19, v17
  s_nop 0
  v_mul_f32 v20, v14, v18
  v_mul_f32 v21, v15, v19
  v_fma_f32 v14, -v20, v16, v14
  v_fma_f32 v15, -v21, v17, v15
  v_fma_f32 v14, v14, v18, v20
  v_fma_f32 v15, v15, v19, v21
  v_cvt_pk_bf16_f32 v69, v14, v15
  v_lshlrev_b32 v14, 16, v70
  v_and_b32 v15, 0xffff0000, v70
  v_mul_f32 v16, 0xbfb8aa3b, v14
  v_mul_f32 v17, 0xbfb8aa3b, v15
  v_fma_f32 v18, v14, s73, -v16
  v_fma_f32 v19, v15, s73, -v17
  v_fmac_f32 v18, 0xb2a57060, v14
  v_min_f32 v16, 0x42fc0000, v16
  v_fmac_f32 v19, 0xb2a57060, v15
  v_min_f32 v17, 0x42fc0000, v17
  v_exp_f32 v16, v16
  v_exp_f32 v17, v17
  v_mul_f32 v18, 0x3f317218, v18
  v_mul_f32 v19, 0x3f317218, v19
  v_fmac_f32 v16, v16, v18
  v_fmac_f32 v17, v17, v19
  v_add_f32 v16, 1.0, v16
  v_add_f32 v17, 1.0, v17
  v_rcp_f32 v18, v16
  v_rcp_f32 v19, v17
  s_nop 0
  v_mul_f32 v20, v14, v18
  v_mul_f32 v21, v15, v19
  v_fma_f32 v14, -v20, v16, v14
  v_fma_f32 v15, -v21, v17, v15
  v_fma_f32 v14, v14, v18, v20
  v_fma_f32 v15, v15, v19, v21
  v_cvt_pk_bf16_f32 v70, v14, v15
  v_lshlrev_b32 v14, 16, v71
  v_and_b32 v15, 0xffff0000, v71
  v_mul_f32 v16, 0xbfb8aa3b, v14
  v_mul_f32 v17, 0xbfb8aa3b, v15
  v_fma_f32 v18, v14, s73, -v16
  v_fma_f32 v19, v15, s73, -v17
  v_fmac_f32 v18, 0xb2a57060, v14
  v_min_f32 v16, 0x42fc0000, v16
  v_fmac_f32 v19, 0xb2a57060, v15
  v_min_f32 v17, 0x42fc0000, v17
  v_exp_f32 v16, v16
  v_exp_f32 v17, v17
  v_mul_f32 v18, 0x3f317218, v18
  v_mul_f32 v19, 0x3f317218, v19
  v_fmac_f32 v16, v16, v18
  v_fmac_f32 v17, v17, v19
  v_add_f32 v16, 1.0, v16
  v_add_f32 v17, 1.0, v17
  v_rcp_f32 v18, v16
  v_rcp_f32 v19, v17
  s_nop 0
  v_mul_f32 v20, v14, v18
  v_mul_f32 v21, v15, v19
  v_fma_f32 v14, -v20, v16, v14
  v_fma_f32 v15, -v21, v17, v15
  v_fma_f32 v14, v14, v18, v20
  v_fma_f32 v15, v15, v19, v21
  v_cvt_pk_bf16_f32 v71, v14, v15
  v_mov_b32 v12, 0x05040100
  v_mov_b32 v13, 0x07060302
  s_waitcnt vmcnt(24)
  v_perm_b32 v104, v73, v72, v12
  v_perm_b32 v105, v75, v74, v12
  v_perm_b32 v106, v77, v76, v12
  v_perm_b32 v107, v79, v78, v12
  v_perm_b32 v108, v73, v72, v13
  v_perm_b32 v109, v75, v74, v13
  v_perm_b32 v110, v77, v76, v13
  v_perm_b32 v111, v79, v78, v13
  s_nop 1
  v_mfma_f32_16x16x32_bf16 v[112:115], v[64:67], v[104:107], 0
  v_mfma_f32_16x16x32_bf16 v[116:119], v[64:67], v[108:111], 0
  s_waitcnt vmcnt(16)
  v_perm_b32 v104, v81, v80, v12
  v_perm_b32 v105, v83, v82, v12
  v_perm_b32 v106, v85, v84, v12
  v_perm_b32 v107, v87, v86, v12
  v_perm_b32 v108, v81, v80, v13
  v_perm_b32 v109, v83, v82, v13
  v_perm_b32 v110, v85, v84, v13
  v_perm_b32 v111, v87, v86, v13
  s_nop 1
  v_mfma_f32_16x16x32_bf16 v[112:115], v[68:71], v[104:107], v[112:115]
  v_mfma_f32_16x16x32_bf16 v[116:119], v[68:71], v[108:111], v[116:119]
  s_waitcnt vmcnt(8)
  v_perm_b32 v104, v89, v88, v12
  v_perm_b32 v105, v91, v90, v12
  v_perm_b32 v106, v93, v92, v12
  v_perm_b32 v107, v95, v94, v12
  v_perm_b32 v108, v89, v88, v13
  v_perm_b32 v109, v91, v90, v13
  v_perm_b32 v110, v93, v92, v13
  v_perm_b32 v111, v95, v94, v13
  s_nop 1
  v_mfma_f32_16x16x32_bf16 v[120:123], v[64:67], v[104:107], 0
  v_mfma_f32_16x16x32_bf16 v[124:127], v[64:67], v[108:111], 0
  s_waitcnt vmcnt(0)
  v_perm_b32 v104, v97, v96, v12
  v_perm_b32 v105, v99, v98, v12
  v_perm_b32 v106, v101, v100, v12
  v_perm_b32 v107, v103, v102, v12
  v_perm_b32 v108, v97, v96, v13
  v_perm_b32 v109, v99, v98, v13
  v_perm_b32 v110, v101, v100, v13
  v_perm_b32 v111, v103, v102, v13
  s_nop 1
  v_mfma_f32_16x16x32_bf16 v[120:123], v[68:71], v[104:107], v[120:123]
  v_mfma_f32_16x16x32_bf16 v[124:127], v[68:71], v[108:111], v[124:127]
  v_cmp_gt_u32 vcc, 2, v2
  v_lshrrev_b32 v12, 1, v2
  s_lshl_b32 s38, s36, 1
  v_add_u32 v12, s38, v12
  v_lshlrev_b32 v12, 10, v12
  v_and_b32 v13, 1, v2
  v_lshl_add_u32 v12, v13, 9, v12
  v_lshl_add_u32 v12, v3, 3, v12
  v_cndmask_b32 v16, v120, v112, vcc
  v_cndmask_b32 v18, v121, v113, vcc
  v_cndmask_b32 v20, v122, v114, vcc
  v_cndmask_b32 v22, v123, v115, vcc
  v_cndmask_b32 v17, v124, v116, vcc
  v_cndmask_b32 v19, v125, v117, vcc
  v_cndmask_b32 v21, v126, v118, vcc
  v_cndmask_b32 v23, v127, v119, vcc
  ds_write_b64 v12, v[16:17] offset:16384
  ds_write_b64 v12, v[18:19] offset:16512
  ds_write_b64 v12, v[20:21] offset:16640
  ds_write_b64 v12, v[22:23] offset:16768
  s_waitcnt lgkmcnt(0)
  v_mov_b32 v12, 26880
  v_mov_b32 v13, 1
  s_mov_b64 exec, 1
  ds_add_u32 v12, v13
  s_mov_b64 exec, -1
  s_cmp_lg_u32 s36, 0
  s_cbranch_scc1 L_late_done
  v_lshrrev_b32 v14, 3, v1
  v_mul_u32_u24 v14, 12288, v14
  v_and_b32 v15, 7, v1
  v_lshl_add_u32 v14, v15, 4, v14
  s_lshl_b32 s38, s35, 7
  s_add_u32 s38, s38, 4096
  v_add_u32 v14, s38, v14
  v_mov_b32 v17, s72
  v_mov_b32 v19, s72
  v_mov_b32 v12, 26880
  s_mov_b32 s71, 0x200000
L_lw55:
  ds_read_b32 v13, v12
  s_sub_u32 s71, s71, 1
  s_cbranch_scc1 L_lwd56
  s_waitcnt lgkmcnt(0)
  v_readfirstlane_b32 s40, v13
  s_nop 0
  s_cmp_lt_u32 s40, 4
  s_cbranch_scc1 L_lw55
L_lwd56:
  s_waitcnt lgkmcnt(0)
  v_lshlrev_b32 v12, 4, v1
  ds_read_b128 v[72:75], v12 offset:16384
  ds_read_b128 v[76:79], v12 offset:17408
  ds_read_b128 v[80:83], v12 offset:18432
  ds_read_b128 v[84:87], v12 offset:19456
  ds_read_b128 v[88:91], v12 offset:20480
  ds_read_b128 v[92:95], v12 offset:21504
  ds_read_b128 v[96:99], v12 offset:22528
  ds_read_b128 v[100:103], v12 offset:23552
  s_waitcnt lgkmcnt(6)
  v_add_f32 v72, v72, v76
  v_add_f32 v73, v73, v77
  v_add_f32 v74, v74, v78
  v_add_f32 v75, v75, v79
  s_waitcnt lgkmcnt(5)
  v_add_f32 v72, v72, v80
  v_add_f32 v73, v73, v81
  v_add_f32 v74, v74, v82
  v_add_f32 v75, v75, v83
  s_waitcnt lgkmcnt(4)
  v_add_f32 v72, v72, v84
  v_add_f32 v73, v73, v85
  v_add_f32 v74, v74, v86
  v_add_f32 v75, v75, v87
  s_waitcnt lgkmcnt(3)
  v_add_f32 v72, v72, v88
  v_add_f32 v73, v73, v89
  v_add_f32 v74, v74, v90
  v_add_f32 v75, v75, v91
  s_waitcnt lgkmcnt(2)
  v_add_f32 v72, v72, v92
  v_add_f32 v73, v73, v93
  v_add_f32 v74, v74, v94
  v_add_f32 v75, v75, v95
  s_waitcnt lgkmcnt(1)
  v_add_f32 v72, v72, v96
  v_add_f32 v73, v73, v97
  v_add_f32 v74, v74, v98
  v_add_f32 v75, v75, v99
  s_waitcnt lgkmcnt(0)
  v_add_f32 v72, v72, v100
  v_add_f32 v73, v73, v101
  v_add_f32 v74, v74, v102
  v_add_f32 v75, v75, v103
  v_cvt_pk_bf16_f32 v16, v72, v73
  v_cvt_pk_bf16_f32 v18, v74, v75
  global_store_dwordx4 v14, v[16:19], s[30:31] sc1
L_late_done:
  v_mov_b32 v20, 26896
  s_mov_b32 s71, 0x200000
L_lw57:
  ds_read_b32 v21, v20
  s_sub_u32 s71, s71, 1
  s_cbranch_scc1 L_lwd58
  s_waitcnt lgkmcnt(0)
  v_readfirstlane_b32 s40, v21
  s_nop 0
  s_cmp_lt_u32 s40, 4
  s_cbranch_scc1 L_lw57
L_lwd58:
  s_waitcnt lgkmcnt(0)
  s_sub_u32 s40, s2, 96
  s_cmp_lt_u32 s40, 49
  s_cselect_b32 s69, 1, 0
  s_mov_b32 s92, 0
  s_mov_b32 s96, 0
  s_mov_b32 s98, 0
  s_mov_b32 s42, 0x7f
  s_mov_b32 s93, 0
  s_mov_b32 s61, 0
  s_mov_b32 s62, 0
  s_mov_b32 s63, 0x3f800000
  s_mov_b32 s68, 0
  v_mov_b32 v12, 26880
  v_mov_b32 v6, 0x3f400000
  s_cmp_eq_u32 s36, 1
  s_cbranch_scc1 L_ctl
  s_mov_b32 s71, 0x200000
L_rw:
  ds_read_b32 v14, v12 offset:60
  s_sub_u32 s71, s71, 1
  s_waitcnt lgkmcnt(0)
  v_readfirstlane_b32 s42, v14
  s_cbranch_scc1 L_role
  s_sleep 4
  s_cmp_eq_u32 s42, 0
  s_cbranch_scc1 L_rw
L_role:
  s_sub_u32 s42, s42, 1
  s_cmp_ge_u32 s42, 43
  s_cbranch_scc1 L_noffn1
  v_cmp_gt_u32 vcc, 8, v3
  v_mov_b32 v12, s18
  v_mov_b32 v13, s19
  v_mov_b32 v14, s16
  v_mov_b32 v15, s17
  v_cndmask_b32 v12, v12, v14, vcc
  v_cndmask_b32 v13, v13, v15, vcc
  v_mul_u32_u24 v14, 22016, v2
  v_and_b32 v15, 7, v3
  v_lshl_add_u32 v14, v15, 3, v14
  s_mul_i32 s38, s36, 352256
  s_lshl_b32 s39, s42, 6
  s_add_u32 s38, s38, s39
  v_add_u32 v14, s38, v14
  v_mov_b32 v15, 0
  v_lshl_add_u64 v[12:13], v[14:15], 0, v[12:13]
  s_mov_b32 s52, 2752
  s_mov_b32 s53, 0
  s_mov_b32 s54, 68800
  s_mov_b32 s55, 0
  v_mov_b32 v16, 0x05040100
  v_mov_b32 v17, 0x07060302
  v_lshlrev_b32 v18, 4, v1
  s_lshl_b32 s38, s36, 12
  s_add_u32 s38, s38, 65536
  v_add_u32 v18, s38, v18
  s_waitcnt vmcnt(3)
  global_load_dwordx2 v[96:97], v[12:13], off
  v_lshl_add_u64 v[12:13], v[12:13], 0, s[52:53]
  s_waitcnt vmcnt(3)
  global_load_dwordx2 v[98:99], v[12:13], off
  v_lshl_add_u64 v[12:13], v[12:13], 0, s[52:53]
  s_waitcnt vmcnt(3)
  global_load_dwordx2 v[100:101], v[12:13], off
  v_lshl_add_u64 v[12:13], v[12:13], 0, s[52:53]
  s_waitcnt vmcnt(3)
  global_load_dwordx2 v[102:103], v[12:13], off
  v_lshl_add_u64 v[12:13], v[12:13], 0, s[52:53]
  s_waitcnt vmcnt(3)
  global_load_dwordx2 v[104:105], v[12:13], off
  v_lshl_add_u64 v[12:13], v[12:13], 0, s[52:53]
  s_waitcnt vmcnt(3)
  global_load_dwordx2 v[106:107], v[12:13], off
  v_lshl_add_u64 v[12:13], v[12:13], 0, s[52:53]
  s_waitcnt vmcnt(3)
  global_load_dwordx2 v[108:109], v[12:13], off
  v_lshl_add_u64 v[12:13], v[12:13], 0, s[52:53]
  s_waitcnt vmcnt(3)
  global_load_dwordx2 v[110:111], v[12:13], off
  v_lshl_add_u64 v[12:13], v[12:13], 0, s[54:55]
  s_waitcnt vmcnt(0)
  v_perm_b32 v112, v98, v96, v16
  v_perm_b32 v113, v102, v100, v16
  v_perm_b32 v114, v106, v104, v16
  v_perm_b32 v115, v110, v108, v16
  ds_write_b128 v18, v[112:115] offset:0
  v_perm_b32 v116, v98, v96, v17
  v_perm_b32 v117, v102, v100, v17
  v_perm_b32 v118, v106, v104, v17
  v_perm_b32 v119, v110, v108, v17
  ds_write_b128 v18, v[116:119] offset:16384
  v_perm_b32 v120, v99, v97, v16
  v_perm_b32 v121, v103, v101, v16
  v_perm_b32 v122, v107, v105, v16
  v_perm_b32 v123, v111, v109, v16
  ds_write_b128 v18, v[120:123] offset:32768
  v_perm_b32 v124, v99, v97, v17
  v_perm_b32 v125, v103, v101, v17
  v_perm_b32 v126, v107, v105, v17
  v_perm_b32 v127, v111, v109, v17
  ds_write_b128 v18, v[124:127] offset:49152
  s_waitcnt lgkmcnt(0)
  s_waitcnt vmcnt(3)
  global_load_dwordx2 v[96:97], v[12:13], off
  v_lshl_add_u64 v[12:13], v[12:13], 0, s[52:53]
  s_waitcnt vmcnt(3)
  global_load_dwordx2 v[98:99], v[12:13], off
  v_lshl_add_u64 v[12:13], v[12:13], 0, s[52:53]
  s_waitcnt vmcnt(3)
  global_load_dwordx2 v[100:101], v[12:13], off
  v_lshl_add_u64 v[12:13], v[12:13], 0, s[52:53]
  s_waitcnt vmcnt(3)
  global_load_dwordx2 v[102:103], v[12:13], off
  v_lshl_add_u64 v[12:13], v[12:13], 0, s[52:53]
  s_waitcnt vmcnt(3)
  global_load_dwordx2 v[104:105], v[12:13], off
  v_lshl_add_u64 v[12:13], v[12:13], 0, s[52:53]
  s_waitcnt vmcnt(3)
  global_load_dwordx2 v[106:107], v[12:13], off
  v_lshl_add_u64 v[12:13], v[12:13], 0, s[52:53]
  s_waitcnt vmcnt(3)
  global_load_dwordx2 v[108:109], v[12:13], off
  v_lshl_add_u64 v[12:13], v[12:13], 0, s[52:53]
  s_waitcnt vmcnt(3)
  global_load_dwordx2 v[110:111], v[12:13], off
  v_lshl_add_u64 v[12:13], v[12:13], 0, s[54:55]
  s_waitcnt vmcnt(0)
  v_perm_b32 v112, v98, v96, v16
  v_perm_b32 v113, v102, v100, v16
  v_perm_b32 v114, v106, v104, v16
  v_perm_b32 v115, v110, v108, v16
  ds_write_b128 v18, v[112:115] offset:1024
  v_perm_b32 v116, v98, v96, v17
  v_perm_b32 v117, v102, v100, v17
  v_perm_b32 v118, v106, v104, v17
  v_perm_b32 v119, v110, v108, v17
  ds_write_b128 v18, v[116:119] offset:17408
  v_perm_b32 v120, v99, v97, v16
  v_perm_b32 v121, v103, v101, v16
  v_perm_b32 v122, v107, v105, v16
  v_perm_b32 v123, v111, v109, v16
  ds_write_b128 v18, v[120:123] offset:33792
  v_perm_b32 v124, v99, v97, v17
  v_perm_b32 v125, v103, v101, v17
  v_perm_b32 v126, v107, v105, v17
  v_perm_b32 v127, v111, v109, v17
  ds_write_b128 v18, v[124:127] offset:50176
  s_waitcnt lgkmcnt(0)
  s_waitcnt vmcnt(3)
  global_load_dwordx2 v[96:97], v[12:13], off
  v_lshl_add_u64 v[12:13], v[12:13], 0, s[52:53]
  s_waitcnt vmcnt(3)
  global_load_dwordx2 v[98:99], v[12:13], off
  v_lshl_add_u64 v[12:13], v[12:13], 0, s[52:53]
  s_waitcnt vmcnt(3)
  global_load_dwordx2 v[100:101], v[12:13], off
  v_lshl_add_u64 v[12:13], v[12:13], 0, s[52:53]
  s_waitcnt vmcnt(3)
  global_load_dwordx2 v[102:103], v[12:13], off
  v_lshl_add_u64 v[12:13], v[12:13], 0, s[52:53]
  s_waitcnt vmcnt(3)
  global_load_dwordx2 v[104:105], v[12:13], off
  v_lshl_add_u64 v[12:13], v[12:13], 0, s[52:53]
  s_waitcnt vmcnt(3)
  global_load_dwordx2 v[106:107], v[12:13], off
  v_lshl_add_u64 v[12:13], v[12:13], 0, s[52:53]
  s_waitcnt vmcnt(3)
  global_load_dwordx2 v[108:109], v[12:13], off
  v_lshl_add_u64 v[12:13], v[12:13], 0, s[52:53]
  s_waitcnt vmcnt(3)
  global_load_dwordx2 v[110:111], v[12:13], off
  v_lshl_add_u64 v[12:13], v[12:13], 0, s[54:55]
  s_waitcnt vmcnt(0)
  v_perm_b32 v112, v98, v96, v16
  v_perm_b32 v113, v102, v100, v16
  v_perm_b32 v114, v106, v104, v16
  v_perm_b32 v115, v110, v108, v16
  ds_write_b128 v18, v[112:115] offset:2048
  v_perm_b32 v116, v98, v96, v17
  v_perm_b32 v117, v102, v100, v17
  v_perm_b32 v118, v106, v104, v17
  v_perm_b32 v119, v110, v108, v17
  ds_write_b128 v18, v[116:119] offset:18432
  v_perm_b32 v120, v99, v97, v16
  v_perm_b32 v121, v103, v101, v16
  v_perm_b32 v122, v107, v105, v16
  v_perm_b32 v123, v111, v109, v16
  ds_write_b128 v18, v[120:123] offset:34816
  v_perm_b32 v124, v99, v97, v17
  v_perm_b32 v125, v103, v101, v17
  v_perm_b32 v126, v107, v105, v17
  v_perm_b32 v127, v111, v109, v17
  ds_write_b128 v18, v[124:127] offset:51200
  s_waitcnt lgkmcnt(0)
  s_waitcnt vmcnt(3)
  global_load_dwordx2 v[96:97], v[12:13], off
  v_lshl_add_u64 v[12:13], v[12:13], 0, s[52:53]
  s_waitcnt vmcnt(3)
  global_load_dwordx2 v[98:99], v[12:13], off
  v_lshl_add_u64 v[12:13], v[12:13], 0, s[52:53]
  s_waitcnt vmcnt(3)
  global_load_dwordx2 v[100:101], v[12:13], off
  v_lshl_add_u64 v[12:13], v[12:13], 0, s[52:53]
  s_waitcnt vmcnt(3)
  global_load_dwordx2 v[102:103], v[12:13], off
  v_lshl_add_u64 v[12:13], v[12:13], 0, s[52:53]
  s_waitcnt vmcnt(3)
  global_load_dwordx2 v[104:105], v[12:13], off
  v_lshl_add_u64 v[12:13], v[12:13], 0, s[52:53]
  s_waitcnt vmcnt(3)
  global_load_dwordx2 v[106:107], v[12:13], off
  v_lshl_add_u64 v[12:13], v[12:13], 0, s[52:53]
  s_waitcnt vmcnt(3)
  global_load_dwordx2 v[108:109], v[12:13], off
  v_lshl_add_u64 v[12:13], v[12:13], 0, s[52:53]
  s_waitcnt vmcnt(3)
  global_load_dwordx2 v[110:111], v[12:13], off
  s_waitcnt vmcnt(0)
  v_perm_b32 v112, v98, v96, v16
  v_perm_b32 v113, v102, v100, v16
  v_perm_b32 v114, v106, v104, v16
  v_perm_b32 v115, v110, v108, v16
  ds_write_b128 v18, v[112:115] offset:3072
  v_perm_b32 v116, v98, v96, v17
  v_perm_b32 v117, v102, v100, v17
  v_perm_b32 v118, v106, v104, v17
  v_perm_b32 v119, v110, v108, v17
  ds_write_b128 v18, v[116:119] offset:19456
  v_perm_b32 v120, v99, v97, v16
  v_perm_b32 v121, v103, v101, v16
  v_perm_b32 v122, v107, v105, v16
  v_perm_b32 v123, v111, v109, v16
  ds_write_b128 v18, v[120:123] offset:35840
  v_perm_b32 v124, v99, v97, v17
  v_perm_b32 v125, v103, v101, v17
  v_perm_b32 v126, v107, v105, v17
  v_perm_b32 v127, v111, v109, v17
  ds_write_b128 v18, v[124:127] offset:52224
  s_waitcnt lgkmcnt(0)
  s_waitcnt lgkmcnt(0)
  v_mov_b32 v12, 26888
  v_mov_b32 v13, 1
  s_mov_b64 exec, 1
  ds_add_u32 v12, v13
  s_mov_b64 exec, -1
  v_lshlrev_b32 v12, 13, v2
  v_lshl_add_u32 v12, v3, 4, v12
  s_lshl_b32 s38, s42, 15
  s_lshl_b32 s39, s36, 8
  s_add_u32 s38, s38, s39
  v_add_u32 v12, s38, v12
  v_add_u32 v13, 4096, v12
  s_waitcnt vmcnt(3)
  global_load_dwordx4 v[96:99], v12, s[20:21] offset:0
  s_waitcnt vmcnt(3)
  global_load_dwordx4 v[100:103], v12, s[20:21] offset:1024
  s_waitcnt vmcnt(3)
  global_load_dwordx4 v[104:107], v12, s[20:21] offset:2048
  s_waitcnt vmcnt(3)
  global_load_dwordx4 v[108:111], v12, s[20:21] offset:3072
  s_waitcnt vmcnt(3)
  global_load_dwordx4 v[112:115], v13, s[20:21] offset:0
  s_waitcnt vmcnt(3)
  global_load_dwordx4 v[116:119], v13, s[20:21] offset:1024
  s_waitcnt vmcnt(3)
  global_load_dwordx4 v[120:123], v13, s[20:21] offset:2048
  s_waitcnt vmcnt(3)
  global_load_dwordx4 v[124:127], v13, s[20:21] offset:3072
  s_waitcnt vmcnt(0)
  v_perm_b32 v64, v100, v96, v16
  v_perm_b32 v65, v108, v104, v16
  v_perm_b32 v66, v116, v112, v16
  v_perm_b32 v67, v124, v120, v16
  v_perm_b32 v68, v100, v96, v17
  v_perm_b32 v69, v108, v104, v17
  v_perm_b32 v70, v116, v112, v17
  v_perm_b32 v71, v124, v120, v17
  v_perm_b32 v72, v101, v97, v16
  v_perm_b32 v73, v109, v105, v16
  v_perm_b32 v74, v117, v113, v16
  v_perm_b32 v75, v125, v121, v16
  v_perm_b32 v76, v101, v97, v17
  v_perm_b32 v77, v109, v105, v17
  v_perm_b32 v78, v117, v113, v17
  v_perm_b32 v79, v125, v121, v17
  v_perm_b32 v80, v102, v98, v16
  v_perm_b32 v81, v110, v106, v16
  v_perm_b32 v82, v118, v114, v16
  v_perm_b32 v83, v126, v122, v16
  v_perm_b32 v84, v102, v98, v17
  v_perm_b32 v85, v110, v106, v17
  v_perm_b32 v86, v118, v114, v17
  v_perm_b32 v87, v126, v122, v17
  v_perm_b32 v88, v103, v99, v16
  v_perm_b32 v89, v111, v107, v16
  v_perm_b32 v90, v119, v115, v16
  v_perm_b32 v91, v127, v123, v16
  v_perm_b32 v92, v103, v99, v17
  v_perm_b32 v93, v111, v107, v17
  v_perm_b32 v94, v119, v115, v17
  v_perm_b32 v95, v127, v123, v17
  v_lshlrev_b32 v12, 4, v1
  s_lshl_b32 s38, s36, 11
  v_add_u32 v13, s38, v12
  global_load_dwordx4 v[96:99], v13, s[4:5] offset:0
  global_load_dwordx4 v[112:115], v13, s[4:5] offset:1024
  s_mul_i32 s38, s36, 24576
  s_add_u32 s38, s38, 8192
  v_lshl_add_u32 v14, v1, 5, s38
  v_add_u32 v15, 2048, v14
  v_add_u32 v16, 4096, v14
  v_add_u32 v17, 12288, v14
  v_add_u32 v18, 14336, v14
  v_add_u32 v19, 16384, v14
  s_lshr_b32 s38, s42, 3
  s_and_b32 s38, s38, 3
  s_lshl_b32 s38, s38, 7
  s_and_b32 s39, s42, 7
  s_add_u32 s38, s38, s39
  s_and_b32 s39, s36, 1
  s_lshl_b32 s39, s39, 6
  s_add_u32 s43, s38, s39
  v_and_b32 v20, 7, v1
  v_lshl_add_u32 v20, v20, 3, s43
  v_mov_b32 v60, v20
  v_lshrrev_b32 v20, 1, v20
  v_lshlrev_b32 v20, 3, v20
  s_lshr_b32 s38, s36, 1
  s_mul_i32 s38, s38, 49152
  s_add_u32 s38, s38, 14336
  v_add_u32 v20, s38, v20
  v_add_u32 v21, 12288, v20
  v_add_u32 v22, 24576, v20
  v_add_u32 v23, 36864, v20
  s_mov_b32 s71, 524288
  global_load_dwordx4 v[192:195], v14, s[30:31]
  global_load_dwordx4 v[196:199], v14, s[30:31] offset:16
  global_load_dwordx4 v[200:203], v15, s[30:31]
  global_load_dwordx4 v[204:207], v15, s[30:31] offset:16
  global_load_dwordx4 v[208:211], v16, s[30:31]
  global_load_dwordx4 v[212:215], v16, s[30:31] offset:16
  global_load_dwordx4 v[216:219], v17, s[30:31]
  global_load_dwordx4 v[220:223], v17, s[30:31] offset:16
  global_load_dwordx4 v[224:227], v18, s[30:31]
  global_load_dwordx4 v[228:231], v18, s[30:31] offset:16
  global_load_dwordx4 v[232:235], v19, s[30:31]
  global_load_dwordx4 v[236:239], v19, s[30:31] offset:16
  global_load_dwordx2 v[240:241], v20, s[30:31]
  global_load_dwordx2 v[242:243], v21, s[30:31]
  global_load_dwordx2 v[244:245], v22, s[30:31]
  global_load_dwordx2 v[246:247], v23, s[30:31]
  s_branch L_prec
L_pre:
  global_load_dwordx4 v[192:195], v14, s[30:31] sc1
  global_load_dwordx4 v[196:199], v14, s[30:31] offset:16 sc1
  global_load_dwordx4 v[200:203], v15, s[30:31] sc1
  global_load_dwordx4 v[204:207], v15, s[30:31] offset:16 sc1
  global_load_dwordx4 v[208:211], v16, s[30:31] sc1
  global_load_dwordx4 v[212:215], v16, s[30:31] offset:16 sc1
  global_load_dwordx4 v[216:219], v17, s[30:31] sc1
  global_load_dwordx4 v[220:223], v17, s[30:31] offset:16 sc1
  global_load_dwordx4 v[224:227], v18, s[30:31] sc1
  global_load_dwordx4 v[228:231], v18, s[30:31] offset:16 sc1
  global_load_dwordx4 v[232:235], v19, s[30:31] sc1
  global_load_dwordx4 v[236:239], v19, s[30:31] offset:16 sc1
  global_load_dwordx2 v[240:241], v20, s[30:31] sc1
  global_load_dwordx2 v[242:243], v21, s[30:31] sc1
  global_load_dwordx2 v[244:245], v22, s[30:31] sc1
  global_load_dwordx2 v[246:247], v23, s[30:31] sc1
L_prec:
  s_waitcnt vmcnt(0)
  v_xor_b32 v12, s72, v193
  v_xor_b32 v13, s72, v195
  v_or_b32 v12, v12, v13
  v_xor_b32 v13, s72, v197
  v_or_b32 v12, v12, v13
  v_xor_b32 v13, s72, v199
  v_or_b32 v12, v12, v13
  v_xor_b32 v13, s72, v201
  v_or_b32 v12, v12, v13
  v_xor_b32 v13, s72, v203
  v_or_b32 v12, v12, v13
  v_xor_b32 v13, s72, v205
  v_or_b32 v12, v12, v13
  v_xor_b32 v13, s72, v207
  v_or_b32 v12, v12, v13
  v_xor_b32 v13, s72, v209
  v_or_b32 v12, v12, v13
  v_xor_b32 v13, s72, v211
  v_or_b32 v12, v12, v13
  v_xor_b32 v13, s72, v213
  v_or_b32 v12, v12, v13
  v_xor_b32 v13, s72, v215
  v_or_b32 v12, v12, v13
  v_xor_b32 v13, s72, v217
  v_or_b32 v12, v12, v13
  v_xor_b32 v13, s72, v219
  v_or_b32 v12, v12, v13
  v_xor_b32 v13, s72, v221
  v_or_b32 v12, v12, v13
  v_xor_b32 v13, s72, v223
  v_or_b32 v12, v12, v13
  v_xor_b32 v13, s72, v225
  v_or_b32 v12, v12, v13
  v_xor_b32 v13, s72, v227
  v_or_b32 v12, v12, v13
  v_xor_b32 v13, s72, v229
  v_or_b32 v12, v12, v13
  v_xor_b32 v13, s72, v231
  v_or_b32 v12, v12, v13
  v_xor_b32 v13, s72, v233
  v_or_b32 v12, v12, v13
  v_xor_b32 v13, s72, v235
  v_or_b32 v12, v12, v13
  v_xor_b32 v13, s72, v237
  v_or_b32 v12, v12, v13
  v_xor_b32 v13, s72, v239
  v_or_b32 v12, v12, v13
  v_xor_b32 v13, s72, v241
  v_or_b32 v12, v12, v13
  v_xor_b32 v13, s72, v243
  v_or_b32 v12, v12, v13
  v_xor_b32 v13, s72, v245
  v_or_b32 v12, v12, v13
  v_xor_b32 v13, s72, v247
  v_or_b32 v12, v12, v13
  v_cmp_ne_u32 vcc, 0, v12
  s_sub_u32 s71, s71, 1
  s_cbranch_scc1 L_pred
  s_cmp_lg_u64 vcc, 0
  s_cbranch_scc1 L_pre
L_pred:
  v_mov_b32 v100, v192
  v_mov_b32 v101, v194
  v_mov_b32 v102, v196
  v_mov_b32 v103, v198
  v_mov_b32 v104, v200
  v_mov_b32 v105, v202
  v_mov_b32 v106, v204
  v_mov_b32 v107, v206
  v_mov_b32 v108, v208
  v_mov_b32 v109, v210
  v_mov_b32 v110, v212
  v_mov_b32 v111, v214
  v_mov_b32 v116, v216
  v_mov_b32 v117, v218
  v_mov_b32 v118, v220
  v_mov_b32 v119, v222
  v_mov_b32 v120, v224
  v_mov_b32 v121, v226
  v_mov_b32 v122, v228
  v_mov_b32 v123, v230
  v_mov_b32 v124, v232
  v_mov_b32 v125, v234
  v_mov_b32 v126, v236
  v_mov_b32 v127, v238
  s_and_b32 s38, s42, 1
  s_lshl_b32 s38, s38, 4
  v_lshrrev_b32 v56, s38, v240
  v_lshlrev_b32 v56, 16, v56
  v_lshrrev_b32 v57, s38, v242
  v_lshlrev_b32 v57, 16, v57
  v_lshrrev_b32 v58, s38, v244
  v_lshlrev_b32 v58, 16, v58
  v_lshrrev_b32 v59, s38, v246
  v_lshlrev_b32 v59, 16, v59
  s_cmp_eq_u32 s36, 0
  s_cbranch_scc1 L_drygo
L_dryretA:
  v_mov_b32 v12, 26888
  s_mov_b32 s71, 0x200000
L_lw59:
  ds_read_b32 v13, v12
  s_sub_u32 s71, s71, 1
  s_cbranch_scc1 L_lwd60
  s_waitcnt lgkmcnt(0)
  v_readfirstlane_b32 s40, v13
  s_nop 0
  s_cmp_lt_u32 s40, 4
  s_cbranch_scc1 L_lw59
L_lwd60:
  s_waitcnt lgkmcnt(0)
  v_lshlrev_b32 v12, 4, v1
  s_lshl_b32 s38, s36, 14
  s_add_u32 s38, s38, 65536
  v_add_u32 v12, s38, v12
  ds_read_b128 v[192:195], v12 offset:0
  ds_read_b128 v[196:199], v12 offset:1024
  ds_read_b128 v[200:203], v12 offset:2048
  ds_read_b128 v[204:207], v12 offset:3072
  ds_read_b128 v[208:211], v12 offset:4096
  ds_read_b128 v[212:215], v12 offset:5120
  ds_read_b128 v[216:219], v12 offset:6144
  ds_read_b128 v[220:223], v12 offset:7168
  ds_read_b128 v[224:227], v12 offset:8192
  ds_read_b128 v[228:231], v12 offset:9216
  ds_read_b128 v[232:235], v12 offset:10240
  ds_read_b128 v[236:239], v12 offset:11264
  ds_read_b128 v[240:243], v12 offset:12288
  ds_read_b128 v[244:247], v12 offset:13312
  ds_read_b128 v[248:251], v12 offset:14336
  ds_read_b128 v[252:255], v12 offset:15360
  s_waitcnt lgkmcnt(0)
L_noffn1:
  s_cmp_lg_u32 s36, 0
  s_cbranch_scc1 L_nodry
  s_cmp_lt_u32 s42, 43
  s_cbranch_scc1 L_nodry
L_drygo:
  s_mov_b64 s[100:101], 0
  s_mov_b64 exec, 0
  s_branch L_dry0
L_dryret:
  s_mov_b64 s[100:101], -1
  s_mov_b64 exec, -1
  s_cmp_lt_u32 s42, 43
  s_cbranch_scc1 L_dryretA
L_nodry:
  s_mov_b32 s48, s12
  s_mov_b32 s49, s13
  v_lshlrev_b32 v10, 10, v2
  v_lshl_add_u32 v10, v3, 4, v10
  v_add_u32 v11, 0x10000, v10
  s_lshl_b32 s38, s33, 17
  s_lshl_b32 s39, s36, 8
  s_add_u32 s38, s38, s39
  s_lshl_b32 s39, s36, 14
  s_add_u32 m0, s39, 65536
  s_lshl_b32 s39, s34, 13
  v_mov_b32 v12, 26880
  s_cmp_lg_u32 s36, 1
  s_cbranch_scc1 L_noctl
L_ctl:
  s_lshr_b32 s60, s2, 2
  s_lshr_b32 s40, s2, 3
  s_xor_b32 s40, s40, s2
  s_and_b32 s40, s40, 3
  s_cmp_eq_u32 s40, 0
  s_cselect_b32 s64, 1, 0
  s_mov_b32 s66, 0x55aa55aa
  s_mov_b32 s67, 0x55aa55aa
  s_bitcmp1_b64 s[66:67], s60
  s_cselect_b32 s64, s64, 0
  s_lshr_b32 s40, s69, 1
  s_cmp_gt_u32 s64, s40
  s_cbranch_scc1 L_rset
  s_lshl_b32 s60, s60, 7
  s_add_u32 s60, s60, 1048576
  v_lshl_add_u32 v21, v1, 2, s60
  v_lshlrev_b32 v13, 7, v1
  v_add_u32 v13, 1048576, v13
  v_lshlrev_b32 v4, 4, v1
  v_mov_b32 v22, 0x7f800000
  s_mov_b32 s40, 0x402e8ba3
  v_writelane_b32 v22, s40, 0
  s_mov_b32 s40, 0x404ec4ec
  v_writelane_b32 v22, s40, 1
  s_mov_b32 s40, 0x406eeeef
  v_writelane_b32 v22, s40, 2
  s_mov_b32 s40, 0x40878788
  v_writelane_b32 v22, s40, 3
  s_mov_b32 s40, 0x40979436
  v_writelane_b32 v22, s40, 4
  s_mov_b32 s40, 0x40a79e7a
  v_writelane_b32 v22, s40, 5
  s_mov_b32 s40, 0x40b7a6f5
  v_writelane_b32 v22, s40, 6
  s_mov_b32 s40, 0x40cec4ec
  v_writelane_b32 v22, s40, 7
  s_mov_b32 s40, 0x40eeeeef
  v_writelane_b32 v22, s40, 8
  s_mov_b32 s40, 410
  v_writelane_b32 v5, s40, 0
  s_mov_b32 s40, 410
  v_writelane_b32 v5, s40, 1
  s_mov_b32 s40, 342
  v_writelane_b32 v5, s40, 2
  s_mov_b32 s40, 293
  v_writelane_b32 v5, s40, 3
  s_mov_b32 s40, 256
  v_writelane_b32 v5, s40, 4
  s_mov_b32 s40, 228
  v_writelane_b32 v5, s40, 5
  s_mov_b32 s40, 205
  v_writelane_b32 v5, s40, 6
  s_mov_b32 s40, 186
  v_writelane_b32 v5, s40, 7
  s_mov_b32 s40, 171
  v_writelane_b32 v5, s40, 8
  s_mov_b32 s40, 155
  v_writelane_b32 v5, s40, 9
  s_mov_b32 s40, 155
  v_writelane_b32 v5, s40, 10
  s_mov_b32 s40, 155
  v_writelane_b32 v5, s40, 11
  s_mov_b32 s40, 155
  v_writelane_b32 v5, s40, 12
  s_mov_b32 s40, 155
  v_writelane_b32 v5, s40, 13
  s_mov_b32 s40, 155
  v_writelane_b32 v5, s40, 14
  s_mov_b32 s40, 155
  v_writelane_b32 v5, s40, 15
  s_mov_b32 s71, 0x100000
L_wp61:
  ds_read_b128 v[16:19], v12 offset:32
  s_sub_u32 s71, s71, 1
  s_cbranch_scc1 L_wpd62
  s_waitcnt lgkmcnt(0)
  v_min3_u32 v16, v16, v17, v18
  v_min_u32 v16, v16, v19
  s_sleep 1
  v_readfirstlane_b32 s40, v16
  s_nop 0
  s_cmp_lt_u32 s40, 5
  s_cbranch_scc1 L_wp61
L_wpd62:
  s_waitcnt lgkmcnt(0)
  s_mov_b32 s71, 0x200000
  s_mov_b32 s94, 0
  s_mov_b32 s70, 0
  s_memrealtime s[74:75]
  s_waitcnt lgkmcnt(0)
  s_or_b32 s97, s74, 255
  s_cmp_eq_u32 s64, 0
  s_cselect_b32 s40, 0x40000000, 1
  s_add_u32 s97, s97, s40
L_tick:
  s_or_b32 s65, s74, 255
  s_add_u32 s65, s65, 1
L_cl:
  s_memrealtime s[74:75]
  ds_read_b32 v14, v12 offset:32
  s_sub_u32 s71, s71, 1
  s_waitcnt lgkmcnt(0)
  v_readfirstlane_b32 s56, v14
  s_cselect_b32 s40, 0x80, 0
  s_or_b32 s56, s56, s40
  s_cmp_ge_u32 s56, 0x80
  s_cbranch_scc1 L_tk_wo
  s_sub_u32 s40, s74, s97
  s_cmp_ge_i32 s40, 0
  s_cbranch_scc1 L_pub
  s_cmp_lg_u32 s56, s94
  s_cbranch_scc1 L_dec
  s_sub_u32 s40, s74, s65
  s_cmp_ge_i32 s40, 0
  s_cbranch_scc1 L_evt
  s_sleep 2
  s_branch L_cl
L_evt:
  s_cmp_eq_u32 s70, 1
  s_cbranch_scc1 L_ev1
  s_cmp_eq_u32 s70, 2
  s_cbranch_scc1 L_ev2
  s_and_b32 s40, s65, 256
  s_cmp_eq_u32 s61, 0
  s_cselect_b32 s40, 0, s40
  s_cmp_lg_u32 s40, 0
  s_cbranch_scc1 L_tk_wo
  s_bfe_u32 s95, s65, 0x50008
  s_lshl_b32 s95, s95, 13
  s_mov_b32 s70, 1
  s_add_u32 s65, s65, 130
  s_branch L_cl
L_pub:
  s_bfe_u32 s40, s97, 0x50008
  s_lshl_b32 s40, s40, 13
  v_add_u32 v23, s40, v21
  v_mov_b32 v14, s92
  s_mov_b32 exec_lo, -1
  s_mov_b32 exec_hi, 0x0
  global_store_dword v23, v14, s[30:31] sc1
  s_mov_b64 exec, -1
  s_add_u32 s96, s96, 1
  s_mov_b32 s40, 511
  s_cmp_lt_u32 s96, 3
  s_cselect_b32 s40, 255, s40
  s_or_b32 s97, s97, s40
  s_add_u32 s97, s97, 1
  s_branch L_cl
L_ev1:
  v_add_u32 v23, s95, v13
  s_mov_b32 s70, 2
  s_add_u32 s65, s74, 110
  s_sub_u32 s40, s74, 1
  v_mov_b32 v8, s40
  s_mov_b64 exec, s[66:67]
  global_load_dword v8, v23, s[30:31]
  s_mov_b64 exec, 1
  v_mov_b32 v23, 2048
  s_cmp_ge_u32 s69, 2
  s_cbranch_scc1 L_ev1a
  global_load_dword v9, v23, s[30:31] sc1
L_ev1a:
  s_mov_b64 exec, -1
  s_branch L_cl
L_ev2:
  s_mov_b32 s70, 0
  s_waitcnt vmcnt(0)
  v_subrev_u32 v16, s74, v8
  v_cmp_gt_u32 vcc, 0x4000, v16
  s_nop 1
  s_bcnt1_i32_b64 s58, vcc
  v_cndmask_b32 v16, 0, v16, vcc
  s_nop 1
  v_add_u32_dpp v16, v16, v16 row_ror:8 row_mask:0xf bank_mask:0xf
  s_nop 1
  v_add_u32_dpp v16, v16, v16 row_ror:4 row_mask:0xf bank_mask:0xf
  s_nop 1
  v_add_u32_dpp v16, v16, v16 row_ror:2 row_mask:0xf bank_mask:0xf
  s_nop 1
  v_add_u32_dpp v16, v16, v16 row_ror:1 row_mask:0xf bank_mask:0xf
  s_nop 1
  v_add_u32_dpp v16, v16, v16 row_bcast:15 row_mask:0xa bank_mask:0xf
  s_nop 1
  v_add_u32_dpp v16, v16, v16 row_bcast:31 row_mask:0xc bank_mask:0xf
  s_nop 0
  v_readlane_b32 s40, v16, 63
  s_nop 1
  v_readfirstlane_b32 s41, v9
  s_cmp_lt_u32 s69, 2
  s_cselect_b32 s41, s41, 0
  s_cmp_ge_u32 s41, 43
  s_cselect_b32 s69, 0, s69
  s_cselect_b32 s62, 6, s62
  s_cmp_lt_u32 s58, 8
  s_cbranch_scc1 L_tk_wo
  v_cvt_f32_u32 v16, s58
  v_rcp_f32 v16, v16
  v_cvt_f32_u32 v17, s40
  v_mul_f32 v17, v17, v16
  v_mul_f32 v16, 0x42000000, v16
  v_cvt_u32_f32 v17, v17
  v_add_f32 v6, 0x3dcccccd, v6
  v_readfirstlane_b32 s63, v16
  v_readfirstlane_b32 s61, v17
  s_sub_u32 s40, s74, 30
  s_add_u32 s61, s61, s40
  s_or_b32 s61, s61, 1
  s_mov_b32 s94, 0
  s_branch L_tk_wo
L_dec:
  s_mov_b32 s94, s56
  ds_read_b32 v15, v12 offset:56
  v_lshl_add_u32 v14, v14, 2, v12
  ds_read_b32 v14, v14 offset:124
  ds_read_b128 v[16:19], v4 offset:24576
  s_sub_u32 s54, s56, 1
  s_and_b32 s40, s68, 0xff
  s_cmp_lt_u32 s54, s40
  s_cselect_b32 s40, 8, 12
  s_lshr_b32 s55, s68, s40
  s_and_b32 s55, s55, 15
  s_add_u32 s55, s55, 1
  s_andn2_b32 s41, s74, 15
  s_or_b32 s41, s41, s55
  s_waitcnt lgkmcnt(1)
  v_readfirstlane_b32 s57, v15
  v_readfirstlane_b32 s60, v14
  s_nop 0
  s_cmp_eq_u32 s60, 0
  s_cselect_b32 s60, s41, s60
  s_cmp_lg_u32 s57, 0
  s_cbranch_scc1 L_tk_n
  ds_read_b128 v[24:27], v4 offset:0
  s_waitcnt lgkmcnt(1)
  v_max3_f32 v16, v16, v17, v18
  v_max_f32 v20, v16, v19
  ds_read_b128 v[16:19], v4 offset:1024
  s_nop 1
  v_max_f32_dpp v20, v20, v20 row_ror:8 row_mask:0xf bank_mask:0xf
  s_nop 1
  v_max_f32_dpp v20, v20, v20 row_ror:4 row_mask:0xf bank_mask:0xf
  s_nop 1
  v_max_f32_dpp v20, v20, v20 row_ror:2 row_mask:0xf bank_mask:0xf
  s_nop 1
  v_max_f32_dpp v20, v20, v20 row_ror:1 row_mask:0xf bank_mask:0xf
  s_nop 1
  v_max_f32_dpp v20, v20, v20 row_bcast:15 row_mask:0xa bank_mask:0xf
  s_nop 1
  v_max_f32_dpp v20, v20, v20 row_bcast:31 row_mask:0xc bank_mask:0xf
  s_nop 0
  v_readlane_b32 s58, v20, 63
  s_nop 1
  v_mov_b32 v20, 0xc2af5dc2
  v_add_f32 v20, s58, v20
  v_mov_b32 v15, 0
  s_waitcnt lgkmcnt(1)
  v_cmp_ge_f32 s[52:53], v24, v20
  v_cmp_ge_f32 s[54:55], v25, v20
  v_cmp_ge_f32 s[40:41], v26, v20
  v_cmp_ge_f32 vcc, v27, v20
  v_addc_co_u32 v15, s[52:53], 0, v15, s[52:53]
  v_addc_co_u32 v15, s[54:55], 0, v15, s[54:55]
  v_addc_co_u32 v15, s[40:41], 0, v15, s[40:41]
  v_addc_co_u32 v15, vcc, 0, v15, vcc
  ds_read_b128 v[24:27], v4 offset:2048
  s_waitcnt lgkmcnt(1)
  v_cmp_ge_f32 s[52:53], v16, v20
  v_cmp_ge_f32 s[54:55], v17, v20
  v_cmp_ge_f32 s[40:41], v18, v20
  v_cmp_ge_f32 vcc, v19, v20
  v_addc_co_u32 v15, s[52:53], 0, v15, s[52:53]
  v_addc_co_u32 v15, s[54:55], 0, v15, s[54:55]
  v_addc_co_u32 v15, s[40:41], 0, v15, s[40:41]
  v_addc_co_u32 v15, vcc, 0, v15, vcc
  ds_read_b128 v[16:19], v4 offset:3072
  s_waitcnt lgkmcnt(1)
  v_cmp_ge_f32 s[52:53], v24, v20
  v_cmp_ge_f32 s[54:55], v25, v20
  v_cmp_ge_f32 s[40:41], v26, v20
  v_cmp_ge_f32 vcc, v27, v20
  v_addc_co_u32 v15, s[52:53], 0, v15, s[52:53]
  v_addc_co_u32 v15, s[54:55], 0, v15, s[54:55]
  v_addc_co_u32 v15, s[40:41], 0, v15, s[40:41]
  v_addc_co_u32 v15, vcc, 0, v15, vcc
  s_waitcnt lgkmcnt(0)
  v_cmp_ge_f32 s[52:53], v16, v20
  v_cmp_ge_f32 s[54:55], v17, v20
  v_cmp_ge_f32 s[40:41], v18, v20
  v_cmp_ge_f32 vcc, v19, v20
  v_addc_co_u32 v15, s[52:53], 0, v15, s[52:53]
  v_addc_co_u32 v15, s[54:55], 0, v15, s[54:55]
  v_addc_co_u32 v15, s[40:41], 0, v15, s[40:41]
  v_addc_co_u32 v15, vcc, 0, v15, vcc
  s_nop 1
  v_add_u32_dpp v15, v15, v15 row_ror:8 row_mask:0xf bank_mask:0xf
  s_nop 1
  v_add_u32_dpp v15, v15, v15 row_ror:4 row_mask:0xf bank_mask:0xf
  s_nop 1
  v_add_u32_dpp v15, v15, v15 row_ror:2 row_mask:0xf bank_mask:0xf
  s_nop 1
  v_add_u32_dpp v15, v15, v15 row_ror:1 row_mask:0xf bank_mask:0xf
  s_nop 1
  v_add_u32_dpp v15, v15, v15 row_bcast:15 row_mask:0xa bank_mask:0xf
  s_nop 1
  v_add_u32_dpp v15, v15, v15 row_bcast:31 row_mask:0xc bank_mask:0xf
  s_nop 0
  v_readlane_b32 s57, v15, 63
  s_nop 1
  s_lshl_b32 s57, s57, 2
L_tk_n:
  s_sub_u32 s40, 17, s56
  s_lshl_b32 s40, s40, 8
  s_add_i32 s59, s57, s40
  s_cmp_gt_u32 s56, 16
  s_mov_b32 s40, 80
  s_cselect_b32 s40, 192, s40
  s_sub_i32 s59, s59, s40
  s_mul_i32 s59, s59, 228
  s_ashr_i32 s59, s59, 8
  s_add_u32 s92, s60, s59
  s_cmp_eq_u32 s61, 0
  s_cbranch_scc1 L_cl
  s_memrealtime s[74:75]
  s_and_b32 s55, s60, 15
  s_and_b32 s40, s68, 0xff
  s_cmp_lt_u32 s56, s40
  s_cselect_b32 s40, 8, 12
  s_lshr_b32 s54, s68, s40
  s_and_b32 s54, s54, 15
  s_add_u32 s54, s54, 1
  s_cmp_eq_u32 s68, 0
  s_cselect_b32 s54, s55, s54
  v_readlane_b32 s41, v5, s55
  s_nop 1
  v_readlane_b32 s58, v5, s54
  s_sub_i32 s59, s59, 228
  s_waitcnt lgkmcnt(0)
  s_sub_i32 s52, s74, s60
  s_max_i32 s53, s41, s52
  s_add_u32 s60, s60, s53
  s_mul_i32 s41, s41, 104
  s_add_u32 s52, s52, 15
  s_lshl_b32 s52, s52, 4
  s_cmp_gt_i32 s52, s41
  s_cselect_b32 s40, s58, 0
  s_cselect_b32 s41, 228, 0
  s_addc_u32 s55, s56, 0
  s_add_u32 s60, s60, s40
  s_sub_i32 s59, s59, s41
  s_max_i32 s59, s59, 16
  s_sub_i32 s40, s61, s60
  s_max_i32 s40, s40, 16
  s_mul_i32 s41, s59, 184
  s_lshr_b32 s41, s41, 8
  s_sub_i32 s41, s41, s40
  s_add_i32 s41, s41, 0
  s_cmp_lt_u32 s57, 2400
  s_cselect_b32 s41, -1, s41
  s_cmp_lt_i32 s41, 0
  s_cbranch_scc1 L_nreq
  s_sub_i32 s52, s74, s98
  s_cmp_eq_u32 s98, 0
  s_cselect_b32 s52, 0, s52
  s_cmp_lt_i32 s52, 0
  s_cbranch_scc1 L_nreq
  v_cvt_f32_u32 v14, s57
  v_rcp_f32 v14, v14
  s_sub_i32 s53, s56, 17
  s_max_i32 s53, s53, 0
  s_lshl_b32 s53, s53, 12
  v_cvt_f32_u32 v23, s53
  s_min_u32 s41, s41, 0x4000
  s_mul_i32 s41, s41, 655
  v_mul_f32 v14, v14, v23
  v_cvt_u32_f32 v14, v14
  s_lshr_b32 s41, s41, 16
  s_add_u32 s41, s41, 1
  s_min_u32 s41, s41, 3
  v_readfirstlane_b32 s53, v14
  s_min_u32 s52, s56, 17
  s_add_u32 s53, s53, s52
  s_add_u32 s53, s53, 4
  s_cmp_gt_u32 s53, 31
  s_cbranch_scc1 L_nreq
  s_add_u32 s52, s41, 5
  s_mul_i32 s52, s52, 150
  s_add_u32 s98, s74, s52
  s_or_b32 s98, s98, 1
  s_lshl2_add_u32 s53, s53, s41
  s_lshl_b32 s53, s53, 6
  s_and_b32 s52, s72, 0xffff0000
  s_or_b32 s53, s53, s52
  s_add_u32 s41, s74, 240
  s_bfe_u32 s41, s41, 0x60007
  s_and_b32 s52, s2, 7
  s_lshl3_add_u32 s52, s41, s52
  s_lshl_b32 s52, s52, 5
  s_lshr_b32 s41, s2, 3
  s_add_u32 s52, s52, s41
  s_lshl2_add_u32 s52, s52, 196608
  v_mov_b32 v23, s52
  v_mov_b32 v14, s53
  s_mov_b64 exec, 1
  global_store_dword v23, v14, s[30:31] sc1
  s_mov_b64 exec, -1
L_nreq:
  v_cvt_f32_u32 v16, s40
  v_rcp_f32 v16, v16
  v_cvt_f32_u32 v17, s59
  v_mov_b32 v18, 0x40900000
  v_mul_f32 v18, s63, v18
  v_mov_b32 v19, 0x40900000
  s_cmp_lt_u32 s40, 300
  s_cselect_b32 s41, 0x40600000, 0
  s_cmp_gt_u32 s56, 16
  s_cselect_b64 vcc, -1, 0
  v_mul_f32 v7, v17, v16
  v_log_f32 v17, v7
  v_cndmask_b32 v18, v19, v18, vcc
  v_mul_f32 v16, 0x3f800000, v17
  v_mul_f32 v17, 0x40400000, v17
  v_max_f32 v17, v16, v17
  v_exp_f32 v17, v17
  s_sub_u32 s54, s54, 1
  v_mul_f32 v17, v17, v18
  v_max_f32 v17, s41, v17
  v_cmp_ge_f32 vcc, v17, v22
  s_lshl_b32 s54, s54, 8
  s_or_b32 s54, s54, s55
  s_bcnt1_i32_b64 s40, vcc
  s_lshl_b32 s40, s40, 12
  s_or_b32 s68, s40, s54
  v_mov_b32 v15, s68
  ds_write_b32 v12, v15 offset:48
  s_cmp_ge_u32 s69, 2
  s_cbranch_scc1 L_cl
  v_cmp_lt_f32 vcc, v7, v6
  v_cmp_lt_f32 s[52:53], 1.0, v7
  s_nop 0
  s_cmp_lg_u64 vcc, 0
  s_cbranch_scc1 L_rtake
  s_cmp_eq_u32 s69, 1
  s_cselect_b64 s[52:53], 0, s[52:53]
  s_cmp_lg_u64 s[52:53], 0
  s_cbranch_scc1 L_rset
  s_branch L_cl
L_tk_wo:
  s_cmp_ge_u32 s69, 2
  s_cbranch_scc1 L_tk_wo1
  s_add_u32 s62, s62, 1
  s_cmp_lt_u32 s62, 6
  s_cbranch_scc1 L_tick
  s_cmp_eq_u32 s69, 0
  s_cbranch_scc1 L_rset
L_rtake:
  v_mov_b32 v14, 2048
  v_mov_b32 v15, 1
  s_mov_b64 exec, 1
  global_atomic_add v16, v14, v15, s[30:31] sc0 sc1
  s_waitcnt vmcnt(0)
  v_readfirstlane_b32 s42, v16
  s_mov_b64 exec, -1
  s_min_u32 s42, s42, 0x7e
  s_add_u32 s41, s68, 4096
  s_cmp_eq_u32 s68, 0
  s_cselect_b32 s41, 0, s41
  s_cmp_lt_u32 s42, 43
  s_cselect_b32 s68, s41, s68
  v_mov_b32 v15, s68
  ds_write_b32 v12, v15 offset:48
  s_add_u32 s42, s42, 1
L_rset:
  s_waitcnt vmcnt(0)
  v_mov_b32 v15, s42
  ds_write_b32 v12, v15 offset:60
  s_mov_b32 s69, 2
  s_mov_b32 s62, 0
  s_branch L_role
L_tk_wo1:
  s_cmp_ge_u32 s62, 8
  s_cbranch_scc1 L_tk_end
  s_cmp_lg_u32 s62, 0
  s_cbranch_scc1 L_tk_w0
  s_add_u32 s41, s38, s39
  buffer_load_dwordx4 v[128:131], v11, s[48:51], s41 offen
  buffer_load_dwordx4 v10, s[48:51], s41 offen lds
  s_add_u32 s39, s39, 4096
  s_and_b32 s39, s39, 0xffff
  s_add_u32 m0, m0, 1024
  s_add_u32 s41, s38, s39
  buffer_load_dwordx4 v[132:135], v11, s[48:51], s41 offen
  buffer_load_dwordx4 v10, s[48:51], s41 offen lds
  s_add_u32 s39, s39, 4096
  s_and_b32 s39, s39, 0xffff
  s_add_u32 m0, m0, 1024
L_tk_w0:
  s_cmp_lg_u32 s62, 1
  s_cbranch_scc1 L_tk_w1
  s_add_u32 s41, s38, s39
  buffer_load_dwordx4 v[136:139], v11, s[48:51], s41 offen
  buffer_load_dwordx4 v10, s[48:51], s41 offen lds
  s_add_u32 s39, s39, 4096
  s_and_b32 s39, s39, 0xffff
  s_add_u32 m0, m0, 1024
  s_add_u32 s41, s38, s39
  buffer_load_dwordx4 v[140:143], v11, s[48:51], s41 offen
  buffer_load_dwordx4 v10, s[48:51], s41 offen lds
  s_add_u32 s39, s39, 4096
  s_and_b32 s39, s39, 0xffff
  s_add_u32 m0, m0, 1024
L_tk_w1:
  s_cmp_lg_u32 s62, 2
  s_cbranch_scc1 L_tk_w2
  s_add_u32 s41, s38, s39
  buffer_load_dwordx4 v[144:147], v11, s[48:51], s41 offen
  buffer_load_dwordx4 v10, s[48:51], s41 offen lds
  s_add_u32 s39, s39, 4096
  s_and_b32 s39, s39, 0xffff
  s_add_u32 m0, m0, 1024
  s_add_u32 s41, s38, s39
  buffer_load_dwordx4 v[148:151], v11, s[48:51], s41 offen
  buffer_load_dwordx4 v10, s[48:51], s41 offen lds
  s_add_u32 s39, s39, 4096
  s_and_b32 s39, s39, 0xffff
  s_add_u32 m0, m0, 1024
L_tk_w2:
  s_cmp_lg_u32 s62, 3
  s_cbranch_scc1 L_tk_w3
  s_add_u32 s41, s38, s39
  buffer_load_dwordx4 v[152:155], v11, s[48:51], s41 offen
  buffer_load_dwordx4 v10, s[48:51], s41 offen lds
  s_add_u32 s39, s39, 4096
  s_and_b32 s39, s39, 0xffff
  s_add_u32 m0, m0, 1024
  s_add_u32 s41, s38, s39
  buffer_load_dwordx4 v[156:159], v11, s[48:51], s41 offen
  buffer_load_dwordx4 v10, s[48:51], s41 offen lds
  s_add_u32 s39, s39, 4096
  s_and_b32 s39, s39, 0xffff
  s_add_u32 m0, m0, 1024
L_tk_w3:
  s_cmp_lg_u32 s62, 4
  s_cbranch_scc1 L_tk_w4
  s_add_u32 s41, s38, s39
  buffer_load_dwordx4 v[160:163], v11, s[48:51], s41 offen
  buffer_load_dwordx4 v10, s[48:51], s41 offen lds
  s_add_u32 s39, s39, 4096
  s_and_b32 s39, s39, 0xffff
  s_add_u32 m0, m0, 1024
  s_add_u32 s41, s38, s39
  buffer_load_dwordx4 v[164:167], v11, s[48:51], s41 offen
  buffer_load_dwordx4 v10, s[48:51], s41 offen lds
  s_add_u32 s39, s39, 4096
  s_and_b32 s39, s39, 0xffff
  s_add_u32 m0, m0, 1024
L_tk_w4:
  s_cmp_lg_u32 s62, 5
  s_cbranch_scc1 L_tk_w5
  s_add_u32 s41, s38, s39
  buffer_load_dwordx4 v[168:171], v11, s[48:51], s41 offen
  buffer_load_dwordx4 v10, s[48:51], s41 offen lds
  s_add_u32 s39, s39, 4096
  s_and_b32 s39, s39, 0xffff
  s_add_u32 m0, m0, 1024
  s_add_u32 s41, s38, s39
  buffer_load_dwordx4 v[172:175], v11, s[48:51], s41 offen
  buffer_load_dwordx4 v10, s[48:51], s41 offen lds
  s_add_u32 s39, s39, 4096
  s_and_b32 s39, s39, 0xffff
  s_add_u32 m0, m0, 1024
L_tk_w5:
  s_cmp_lg_u32 s62, 6
  s_cbranch_scc1 L_tk_w6
  s_add_u32 s41, s38, s39
  buffer_load_dwordx4 v[176:179], v11, s[48:51], s41 offen
  buffer_load_dwordx4 v10, s[48:51], s41 offen lds
  s_add_u32 s39, s39, 4096
  s_and_b32 s39, s39, 0xffff
  s_add_u32 m0, m0, 1024
  s_add_u32 s41, s38, s39
  buffer_load_dwordx4 v[180:183], v11, s[48:51], s41 offen
  buffer_load_dwordx4 v10, s[48:51], s41 offen lds
  s_add_u32 s39, s39, 4096
  s_and_b32 s39, s39, 0xffff
  s_add_u32 m0, m0, 1024
L_tk_w6:
  s_cmp_lg_u32 s62, 7
  s_cbranch_scc1 L_tk_w7
  s_add_u32 s41, s38, s39
  buffer_load_dwordx4 v[184:187], v11, s[48:51], s41 offen
  buffer_load_dwordx4 v10, s[48:51], s41 offen lds
  s_add_u32 s39, s39, 4096
  s_and_b32 s39, s39, 0xffff
  s_add_u32 m0, m0, 1024
  s_add_u32 s41, s38, s39
  buffer_load_dwordx4 v[188:191], v11, s[48:51], s41 offen
  buffer_load_dwordx4 v10, s[48:51], s41 offen lds
  s_add_u32 s39, s39, 4096
  s_and_b32 s39, s39, 0xffff
  s_add_u32 m0, m0, 1024
  s_waitcnt vmcnt(0)
  s_waitcnt lgkmcnt(0)
  v_mov_b32 v14, 26908
  v_mov_b32 v15, 1
  s_mov_b64 exec, 1
  ds_add_u32 v14, v15
  s_mov_b64 exec, -1
L_tk_w7:
  s_add_u32 s62, s62, 1
  s_branch L_tick
L_tk_end:
  s_add_u32 s62, s62, 1
  s_cmp_lt_u32 s56, 0x80
  s_cbranch_scc1 L_tick
  s_waitcnt vmcnt(0)
  s_branch L_cmp_done
L_noctl:
  s_mov_b32 s71, 0x100000
  ds_read_b32 v15, v12 offset:32
  s_waitcnt lgkmcnt(0)
  v_readfirstlane_b32 s52, v15
  s_cmp_lg_u32 s36, 3
  s_cbranch_scc1 L_nh3
  s_mov_b32 s53, 0
  s_memrealtime s[54:55]
  s_and_b32 s66, s2, 7
  s_lshl_b32 s67, s66, 7
  s_add_u32 s67, s67, 196608
  v_lshl_add_u32 v16, v1, 2, s67
  v_lshlrev_b32 v17, 7, v1
  v_mov_b32 v23, 0
  v_mov_b32 v22, 1
  s_mov_b32 s58, 0x10000000
  s_mov_b32 s59, 0x20000
  s_lshr_b32 s68, s2, 3
L_h3l:
  s_memrealtime s[74:75]
  ds_read_b32 v14, v12 offset:32
  ds_read_b64 v[20:21], v12 offset:48
  s_sub_u32 s71, s71, 1
  s_cselect_b32 s41, 0x80, 0
  s_max_i32 s71, s71, 0
  s_waitcnt lgkmcnt(0)
  v_readfirstlane_b32 s40, v14
  v_readfirstlane_b32 s60, v20
  v_readfirstlane_b32 s61, v21
  s_or_b32 s40, s40, s41
  s_cmp_ge_u32 s53, 8
  s_cbranch_scc1 L_h3a
  s_cmp_lt_u32 s40, s52
  s_cbranch_scc1 L_h3b
  s_cmp_lg_u32 s53, 0
  s_cbranch_scc1 L_h3w0
  s_waitcnt vmcnt(2)
  s_add_u32 s41, s38, s39
  buffer_load_dwordx4 v[128:131], v11, s[48:51], s41 offen
  buffer_load_dwordx4 v10, s[48:51], s41 offen lds
  s_add_u32 s39, s39, 4096
  s_and_b32 s39, s39, 0xffff
  s_add_u32 m0, m0, 1024
  s_waitcnt vmcnt(2)
  s_add_u32 s41, s38, s39
  buffer_load_dwordx4 v[132:135], v11, s[48:51], s41 offen
  buffer_load_dwordx4 v10, s[48:51], s41 offen lds
  s_add_u32 s39, s39, 4096
  s_and_b32 s39, s39, 0xffff
  s_add_u32 m0, m0, 1024
L_h3w0:
  s_cmp_lg_u32 s53, 1
  s_cbranch_scc1 L_h3w1
  s_waitcnt vmcnt(2)
  s_add_u32 s41, s38, s39
  buffer_load_dwordx4 v[136:139], v11, s[48:51], s41 offen
  buffer_load_dwordx4 v10, s[48:51], s41 offen lds
  s_add_u32 s39, s39, 4096
  s_and_b32 s39, s39, 0xffff
  s_add_u32 m0, m0, 1024
  s_waitcnt vmcnt(2)
  s_add_u32 s41, s38, s39
  buffer_load_dwordx4 v[140:143], v11, s[48:51], s41 offen
  buffer_load_dwordx4 v10, s[48:51], s41 offen lds
  s_add_u32 s39, s39, 4096
  s_and_b32 s39, s39, 0xffff
  s_add_u32 m0, m0, 1024
L_h3w1:
  s_cmp_lg_u32 s53, 2
  s_cbranch_scc1 L_h3w2
  s_waitcnt vmcnt(2)
  s_add_u32 s41, s38, s39
  buffer_load_dwordx4 v[144:147], v11, s[48:51], s41 offen
  buffer_load_dwordx4 v10, s[48:51], s41 offen lds
  s_add_u32 s39, s39, 4096
  s_and_b32 s39, s39, 0xffff
  s_add_u32 m0, m0, 1024
  s_waitcnt vmcnt(2)
  s_add_u32 s41, s38, s39
  buffer_load_dwordx4 v[148:151], v11, s[48:51], s41 offen
  buffer_load_dwordx4 v10, s[48:51], s41 offen lds
  s_add_u32 s39, s39, 4096
  s_and_b32 s39, s39, 0xffff
  s_add_u32 m0, m0, 1024
L_h3w2:
  s_cmp_lg_u32 s53, 3
  s_cbranch_scc1 L_h3w3
  s_waitcnt vmcnt(2)
  s_add_u32 s41, s38, s39
  buffer_load_dwordx4 v[152:155], v11, s[48:51], s41 offen
  buffer_load_dwordx4 v10, s[48:51], s41 offen lds
  s_add_u32 s39, s39, 4096
  s_and_b32 s39, s39, 0xffff
  s_add_u32 m0, m0, 1024
  s_waitcnt vmcnt(2)
  s_add_u32 s41, s38, s39
  buffer_load_dwordx4 v[156:159], v11, s[48:51], s41 offen
  buffer_load_dwordx4 v10, s[48:51], s41 offen lds
  s_add_u32 s39, s39, 4096
  s_and_b32 s39, s39, 0xffff
  s_add_u32 m0, m0, 1024
L_h3w3:
  s_cmp_lg_u32 s53, 4
  s_cbranch_scc1 L_h3w4
  s_waitcnt vmcnt(2)
  s_add_u32 s41, s38, s39
  buffer_load_dwordx4 v[160:163], v11, s[48:51], s41 offen
  buffer_load_dwordx4 v10, s[48:51], s41 offen lds
  s_add_u32 s39, s39, 4096
  s_and_b32 s39, s39, 0xffff
  s_add_u32 m0, m0, 1024
  s_waitcnt vmcnt(2)
  s_add_u32 s41, s38, s39
  buffer_load_dwordx4 v[164:167], v11, s[48:51], s41 offen
  buffer_load_dwordx4 v10, s[48:51], s41 offen lds
  s_add_u32 s39, s39, 4096
  s_and_b32 s39, s39, 0xffff
  s_add_u32 m0, m0, 1024
L_h3w4:
  s_cmp_lg_u32 s53, 5
  s_cbranch_scc1 L_h3w5
  s_waitcnt vmcnt(2)
  s_add_u32 s41, s38, s39
  buffer_load_dwordx4 v[168:171], v11, s[48:51], s41 offen
  buffer_load_dwordx4 v10, s[48:51], s41 offen lds
  s_add_u32 s39, s39, 4096
  s_and_b32 s39, s39, 0xffff
  s_add_u32 m0, m0, 1024
  s_waitcnt vmcnt(2)
  s_add_u32 s41, s38, s39
  buffer_load_dwordx4 v[172:175], v11, s[48:51], s41 offen
  buffer_load_dwordx4 v10, s[48:51], s41 offen lds
  s_add_u32 s39, s39, 4096
  s_and_b32 s39, s39, 0xffff
  s_add_u32 m0, m0, 1024
L_h3w5:
  s_cmp_lg_u32 s53, 6
  s_cbranch_scc1 L_h3w6
  s_waitcnt vmcnt(2)
  s_add_u32 s41, s38, s39
  buffer_load_dwordx4 v[176:179], v11, s[48:51], s41 offen
  buffer_load_dwordx4 v10, s[48:51], s41 offen lds
  s_add_u32 s39, s39, 4096
  s_and_b32 s39, s39, 0xffff
  s_add_u32 m0, m0, 1024
  s_waitcnt vmcnt(2)
  s_add_u32 s41, s38, s39
  buffer_load_dwordx4 v[180:183], v11, s[48:51], s41 offen
  buffer_load_dwordx4 v10, s[48:51], s41 offen lds
  s_add_u32 s39, s39, 4096
  s_and_b32 s39, s39, 0xffff
  s_add_u32 m0, m0, 1024
L_h3w6:
  s_cmp_lg_u32 s53, 7
  s_cbranch_scc1 L_h3w7
  s_waitcnt vmcnt(2)
  s_add_u32 s41, s38, s39
  buffer_load_dwordx4 v[184:187], v11, s[48:51], s41 offen
  buffer_load_dwordx4 v10, s[48:51], s41 offen lds
  s_add_u32 s39, s39, 4096
  s_and_b32 s39, s39, 0xffff
  s_add_u32 m0, m0, 1024
  s_waitcnt vmcnt(2)
  s_add_u32 s41, s38, s39
  buffer_load_dwordx4 v[188:191], v11, s[48:51], s41 offen
  buffer_load_dwordx4 v10, s[48:51], s41 offen lds
  s_add_u32 s39, s39, 4096
  s_and_b32 s39, s39, 0xffff
  s_add_u32 m0, m0, 1024
  s_waitcnt vmcnt(0)
  s_waitcnt lgkmcnt(0)
  v_mov_b32 v13, 26908
  v_mov_b32 v14, 1
  s_mov_b64 exec, 1
  ds_add_u32 v13, v14
  s_mov_b64 exec, -1
L_h3w7:
  s_add_u32 s53, s53, 1
  s_add_u32 s52, s52, 1
  s_min_u32 s52, s52, 14
  s_branch L_h3l
L_h3a:
  s_cmp_gt_u32 s40, 15
  s_cbranch_scc1 L_cmp_done
  s_cmp_lt_u32 s42, 43
  s_cbranch_scc1 L_cmp_done
L_h3b:
  s_sub_u32 s41, s74, s54
  s_sub_u32 s60, s60, 1
  s_cmp_ge_u32 s60, 20479
  s_cselect_b32 s41, -1, s41
  s_cmp_lt_u32 s42, 43
  s_cselect_b32 s41, -1, s41
  s_cmp_ge_i32 s41, 0
  s_cbranch_scc1 L_h3p
  s_sleep 4
  s_branch L_h3l
L_h3p:
  s_or_b32 s54, s74, 127
  s_add_u32 s54, s54, 1
  s_bfe_u32 s69, s74, 0x60007
  s_lshl_b32 s69, s69, 10
  v_add_u32 v23, s69, v16
  s_mov_b32 exec_lo, -1
  s_mov_b32 exec_hi, 0x0
  global_load_dword v18, v23, s[30:31]
  s_waitcnt vmcnt(0)
  v_xor_b32 v19, s72, v18
  v_and_b32 v20, 63, v18
  v_bfe_u32 v21, v18, 6, 2
  v_cmp_gt_u32 vcc, 0x10000, v19
  v_cmp_lt_u32 s[64:65], v20, v21
  s_mov_b64 exec, -1
  s_nop 1
  s_and_b32 s64, s64, vcc_lo
  s_cbranch_scc0 L_h3l
  s_mov_b32 s65, s64
  s_lshr_b64 s[60:61], s[64:65], s68
  s_ff1_i32_b32 s60, s60
  s_add_u32 s60, s60, s68
  s_and_b32 s60, s60, 31
  s_lshl2_add_u32 s61, s60, s67
  s_add_u32 s61, s61, s69
  v_mov_b32 v19, s61
  s_mov_b64 exec, 1
  global_atomic_add v20, v19, v22, s[30:31] sc0 sc1
  s_waitcnt vmcnt(0)
  v_readfirstlane_b32 s61, v20
  s_mov_b64 exec, -1
  s_xor_b32 s62, s61, s72
  s_cmp_ge_u32 s62, 0x10000
  s_cbranch_scc1 L_h3l
  s_and_b32 s62, s61, 63
  s_bfe_u32 s63, s61, 0x20006
  s_cmp_ge_u32 s62, s63
  s_cbranch_scc1 L_h3l
  s_bfe_u32 s63, s61, 0x50008
  s_add_u32 s62, s62, s63
  s_cmp_gt_u32 s62, 31
  s_cbranch_scc1 L_h3l
  s_cmp_lt_u32 s62, 16
  s_cselect_b32 s56, s6, s8
  s_cselect_b32 s57, s7, s9
  s_lshr_b32 s61, s60, 2
  s_lshl3_add_u32 s61, s61, s66
  s_and_b32 s60, s60, 3
  s_lshl2_add_u32 s61, s61, s60
  s_lshl_b32 s61, s61, 20
  s_bfe_u32 s63, s62, 0x10000
  s_lshl_b32 s63, s63, 18
  s_or_b32 s61, s61, s63
  s_bfe_u32 s63, s62, 0x10001
  s_lshl_b32 s63, s63, 16
  s_or_b32 s61, s61, s63
  s_bfe_u32 s63, s62, 0x10002
  s_lshl_b32 s63, s63, 17
  s_or_b32 s61, s61, s63
  s_bfe_u32 s63, s62, 0x10003
  s_lshl_b32 s63, s63, 19
  s_or_b32 s61, s61, s63
  s_waitcnt vmcnt(1)
  buffer_load_dword v18, v17, s[56:59], s61 offen
  s_add_u32 s61, s61, 8192
  s_waitcnt vmcnt(1)
  buffer_load_dword v18, v17, s[56:59], s61 offen
  s_add_u32 s61, s61, 8192
  s_waitcnt vmcnt(1)
  buffer_load_dword v18, v17, s[56:59], s61 offen
  s_add_u32 s61, s61, 8192
  s_waitcnt vmcnt(1)
  buffer_load_dword v18, v17, s[56:59], s61 offen
  s_add_u32 s61, s61, 8192
  s_waitcnt vmcnt(1)
  buffer_load_dword v18, v17, s[56:59], s61 offen
  s_add_u32 s61, s61, 8192
  s_waitcnt vmcnt(1)
  buffer_load_dword v18, v17, s[56:59], s61 offen
  s_add_u32 s61, s61, 8192
  s_waitcnt vmcnt(1)
  buffer_load_dword v18, v17, s[56:59], s61 offen
  s_add_u32 s61, s61, 8192
  s_waitcnt vmcnt(1)
  buffer_load_dword v18, v17, s[56:59], s61 offen
  s_add_u32 s61, s61, 8192
  s_branch L_h3l
L_nh3:
  s_add_u32 s41, s38, s39
  s_waitcnt vmcnt(2)
  buffer_load_dwordx4 v[128:131], v11, s[48:51], s41 offen
  buffer_load_dwordx4 v10, s[48:51], s41 offen lds
  s_add_u32 s39, s39, 4096
  s_and_b32 s39, s39, 0xffff
  s_add_u32 m0, m0, 1024
  s_add_u32 s41, s38, s39
  s_waitcnt vmcnt(2)
  buffer_load_dwordx4 v[132:135], v11, s[48:51], s41 offen
  buffer_load_dwordx4 v10, s[48:51], s41 offen lds
  s_add_u32 s39, s39, 4096
  s_and_b32 s39, s39, 0xffff
  s_add_u32 m0, m0, 1024
  s_add_u32 s52, s52, 1
  s_min_u32 s52, s52, 14
L_wt63:
  ds_read_b32 v15, v12 offset:32
  s_sub_u32 s71, s71, 1
  s_waitcnt lgkmcnt(0)
  s_cbranch_scc1 L_wtd64
  v_readfirstlane_b32 s40, v15
  s_sleep 2
  s_cmp_lt_u32 s40, s52
  s_cbranch_scc1 L_wt63
L_wtd64:
  s_add_u32 s41, s38, s39
  s_waitcnt vmcnt(2)
  buffer_load_dwordx4 v[136:139], v11, s[48:51], s41 offen
  buffer_load_dwordx4 v10, s[48:51], s41 offen lds
  s_add_u32 s39, s39, 4096
  s_and_b32 s39, s39, 0xffff
  s_add_u32 m0, m0, 1024
  s_add_u32 s41, s38, s39
  s_waitcnt vmcnt(2)
  buffer_load_dwordx4 v[140:143], v11, s[48:51], s41 offen
  buffer_load_dwordx4 v10, s[48:51], s41 offen lds
  s_add_u32 s39, s39, 4096
  s_and_b32 s39, s39, 0xffff
  s_add_u32 m0, m0, 1024
  s_add_u32 s52, s52, 1
  s_min_u32 s52, s52, 14
L_wt65:
  ds_read_b32 v15, v12 offset:32
  s_sub_u32 s71, s71, 1
  s_waitcnt lgkmcnt(0)
  s_cbranch_scc1 L_wtd66
  v_readfirstlane_b32 s40, v15
  s_sleep 2
  s_cmp_lt_u32 s40, s52
  s_cbranch_scc1 L_wt65
L_wtd66:
  s_add_u32 s41, s38, s39
  s_waitcnt vmcnt(2)
  buffer_load_dwordx4 v[144:147], v11, s[48:51], s41 offen
  buffer_load_dwordx4 v10, s[48:51], s41 offen lds
  s_add_u32 s39, s39, 4096
  s_and_b32 s39, s39, 0xffff
  s_add_u32 m0, m0, 1024
  s_add_u32 s41, s38, s39
  s_waitcnt vmcnt(2)
  buffer_load_dwordx4 v[148:151], v11, s[48:51], s41 offen
  buffer_load_dwordx4 v10, s[48:51], s41 offen lds
  s_add_u32 s39, s39, 4096
  s_and_b32 s39, s39, 0xffff
  s_add_u32 m0, m0, 1024
  s_add_u32 s52, s52, 1
  s_min_u32 s52, s52, 14
L_wt67:
  ds_read_b32 v15, v12 offset:32
  s_sub_u32 s71, s71, 1
  s_waitcnt lgkmcnt(0)
  s_cbranch_scc1 L_wtd68
  v_readfirstlane_b32 s40, v15
  s_sleep 2
  s_cmp_lt_u32 s40, s52
  s_cbranch_scc1 L_wt67
L_wtd68:
  s_add_u32 s41, s38, s39
  s_waitcnt vmcnt(2)
  buffer_load_dwordx4 v[152:155], v11, s[48:51], s41 offen
  buffer_load_dwordx4 v10, s[48:51], s41 offen lds
  s_add_u32 s39, s39, 4096
  s_and_b32 s39, s39, 0xffff
  s_add_u32 m0, m0, 1024
  s_add_u32 s41, s38, s39
  s_waitcnt vmcnt(2)
  buffer_load_dwordx4 v[156:159], v11, s[48:51], s41 offen
  buffer_load_dwordx4 v10, s[48:51], s41 offen lds
  s_add_u32 s39, s39, 4096
  s_and_b32 s39, s39, 0xffff
  s_add_u32 m0, m0, 1024
  s_add_u32 s52, s52, 1
  s_min_u32 s52, s52, 14
L_wt69:
  ds_read_b32 v15, v12 offset:32
  s_sub_u32 s71, s71, 1
  s_waitcnt lgkmcnt(0)
  s_cbranch_scc1 L_wtd70
  v_readfirstlane_b32 s40, v15
  s_sleep 2
  s_cmp_lt_u32 s40, s52
  s_cbranch_scc1 L_wt69
L_wtd70:
  s_add_u32 s41, s38, s39
  s_waitcnt vmcnt(2)
  buffer_load_dwordx4 v[160:163], v11, s[48:51], s41 offen
  buffer_load_dwordx4 v10, s[48:51], s41 offen lds
  s_add_u32 s39, s39, 4096
  s_and_b32 s39, s39, 0xffff
  s_add_u32 m0, m0, 1024
  s_add_u32 s41, s38, s39
  s_waitcnt vmcnt(2)
  buffer_load_dwordx4 v[164:167], v11, s[48:51], s41 offen
  buffer_load_dwordx4 v10, s[48:51], s41 offen lds
  s_add_u32 s39, s39, 4096
  s_and_b32 s39, s39, 0xffff
  s_add_u32 m0, m0, 1024
  s_add_u32 s52, s52, 1
  s_min_u32 s52, s52, 14
L_wt71:
  ds_read_b32 v15, v12 offset:32
  s_sub_u32 s71, s71, 1
  s_waitcnt lgkmcnt(0)
  s_cbranch_scc1 L_wtd72
  v_readfirstlane_b32 s40, v15
  s_sleep 2
  s_cmp_lt_u32 s40, s52
  s_cbranch_scc1 L_wt71
L_wtd72:
  s_add_u32 s41, s38, s39
  s_waitcnt vmcnt(2)
  buffer_load_dwordx4 v[168:171], v11, s[48:51], s41 offen
  buffer_load_dwordx4 v10, s[48:51], s41 offen lds
  s_add_u32 s39, s39, 4096
  s_and_b32 s39, s39, 0xffff
  s_add_u32 m0, m0, 1024
  s_add_u32 s41, s38, s39
  s_waitcnt vmcnt(2)
  buffer_load_dwordx4 v[172:175], v11, s[48:51], s41 offen
  buffer_load_dwordx4 v10, s[48:51], s41 offen lds
  s_add_u32 s39, s39, 4096
  s_and_b32 s39, s39, 0xffff
  s_add_u32 m0, m0, 1024
  s_add_u32 s52, s52, 1
  s_min_u32 s52, s52, 14
L_wt73:
  ds_read_b32 v15, v12 offset:32
  s_sub_u32 s71, s71, 1
  s_waitcnt lgkmcnt(0)
  s_cbranch_scc1 L_wtd74
  v_readfirstlane_b32 s40, v15
  s_sleep 2
  s_cmp_lt_u32 s40, s52
  s_cbranch_scc1 L_wt73
L_wtd74:
  s_add_u32 s41, s38, s39
  s_waitcnt vmcnt(2)
  buffer_load_dwordx4 v[176:179], v11, s[48:51], s41 offen
  buffer_load_dwordx4 v10, s[48:51], s41 offen lds
  s_add_u32 s39, s39, 4096
  s_and_b32 s39, s39, 0xffff
  s_add_u32 m0, m0, 1024
  s_add_u32 s41, s38, s39
  s_waitcnt vmcnt(2)
  buffer_load_dwordx4 v[180:183], v11, s[48:51], s41 offen
  buffer_load_dwordx4 v10, s[48:51], s41 offen lds
  s_add_u32 s39, s39, 4096
  s_and_b32 s39, s39, 0xffff
  s_add_u32 m0, m0, 1024
  s_add_u32 s52, s52, 1
  s_min_u32 s52, s52, 14
L_wt75:
  ds_read_b32 v15, v12 offset:32
  s_sub_u32 s71, s71, 1
  s_waitcnt lgkmcnt(0)
  s_cbranch_scc1 L_wtd76
  v_readfirstlane_b32 s40, v15
  s_sleep 2
  s_cmp_lt_u32 s40, s52
  s_cbranch_scc1 L_wt75
L_wtd76:
  s_add_u32 s41, s38, s39
  s_waitcnt vmcnt(2)
  buffer_load_dwordx4 v[184:187], v11, s[48:51], s41 offen
  buffer_load_dwordx4 v10, s[48:51], s41 offen lds
  s_add_u32 s39, s39, 4096
  s_and_b32 s39, s39, 0xffff
  s_add_u32 m0, m0, 1024
  s_add_u32 s41, s38, s39
  s_waitcnt vmcnt(2)
  buffer_load_dwordx4 v[188:191], v11, s[48:51], s41 offen
  buffer_load_dwordx4 v10, s[48:51], s41 offen lds
  s_add_u32 s39, s39, 4096
  s_and_b32 s39, s39, 0xffff
  s_add_u32 m0, m0, 1024
  s_waitcnt vmcnt(0)
  s_waitcnt lgkmcnt(0)
  v_mov_b32 v13, 26908
  v_mov_b32 v14, 1
  s_mov_b64 exec, 1
  ds_add_u32 v13, v14
  s_mov_b64 exec, -1
  s_mov_b32 s70, 0x3fb8aa3b
  s_cmp_lg_u32 s36, 2
  s_cbranch_scc1 L_cmp_done
  s_mov_b32 s56, 43008
  v_lshlrev_b32 v13, 2, v1
  s_mov_b32 s57, 0xc2fd0000
  s_mov_b32 s58, 0
  v_mov_b32 v26, 0xff804000
  s_mov_b32 s71, 0x100000
L_wp77:
  ds_read_b128 v[16:19], v12 offset:32
  s_sub_u32 s71, s71, 1
  s_cbranch_scc1 L_wpd78
  s_waitcnt lgkmcnt(0)
  v_min3_u32 v16, v16, v17, v18
  v_min_u32 v16, v16, v19
  s_sleep 1
  v_readfirstlane_b32 s40, v16
  s_nop 0
  s_cmp_lt_u32 s40, 15
  s_cbranch_scc1 L_wp77
L_wpd78:
  s_waitcnt lgkmcnt(0)
  v_lshlrev_b32 v16, 4, v1
  ds_read_b128 v[16:19], v16 offset:24576
  s_waitcnt lgkmcnt(0)
  v_max3_f32 v16, v16, v17, v18
  v_max_f32 v16, v16, v19
  s_nop 1
  v_max_f32_dpp v16, v16, v16 row_ror:8 row_mask:0xf bank_mask:0xf
  s_nop 1
  v_max_f32_dpp v16, v16, v16 row_ror:4 row_mask:0xf bank_mask:0xf
  s_nop 1
  v_max_f32_dpp v16, v16, v16 row_ror:2 row_mask:0xf bank_mask:0xf
  s_nop 1
  v_max_f32_dpp v16, v16, v16 row_ror:1 row_mask:0xf bank_mask:0xf
  s_nop 1
  v_max_f32_dpp v16, v16, v16 row_bcast:15 row_mask:0xa bank_mask:0xf
  s_nop 1
  v_max_f32_dpp v16, v16, v16 row_bcast:31 row_mask:0xc bank_mask:0xf
  s_nop 0
  v_readlane_b32 s40, v16, 63
  s_nop 1
  v_mov_b32 v14, s70
  v_mul_f32 v14, s40, v14
  v_sub_f32 v14, 0, v14
L_cA:
  ds_read_b32 v16, v13 offset:0
  ds_read_b32 v17, v13 offset:256
  ds_read_b32 v18, v13 offset:512
  ds_read_b32 v19, v13 offset:768
  v_add_u32 v13, 1024, v13
  s_waitcnt lgkmcnt(3)
  v_and_b32 v20, 0xffff0000, v16
  v_fma_f32 v20, v20, s70, v14
  v_cmp_ngt_f32 vcc, s57, v20
  s_nop 1
  v_mbcnt_lo_u32_b32 v21, vcc_lo, 0
  v_mbcnt_hi_u32_b32 v21, vcc_hi, v21
  v_lshl_add_u32 v21, v21, 2, s56
  s_bcnt1_i32_b64 s40, vcc
  s_mov_b64 exec, vcc
  ds_write_b32 v21, v16
  s_mov_b64 exec, -1
  s_lshl2_add_u32 s56, s40, s56
  s_waitcnt lgkmcnt(2)
  v_and_b32 v20, 0xffff0000, v17
  v_fma_f32 v20, v20, s70, v14
  v_cmp_ngt_f32 vcc, s57, v20
  s_nop 1
  v_mbcnt_lo_u32_b32 v21, vcc_lo, 0
  v_mbcnt_hi_u32_b32 v21, vcc_hi, v21
  v_lshl_add_u32 v21, v21, 2, s56
  s_bcnt1_i32_b64 s40, vcc
  s_mov_b64 exec, vcc
  ds_write_b32 v21, v17
  s_mov_b64 exec, -1
  s_lshl2_add_u32 s56, s40, s56
  s_waitcnt lgkmcnt(1)
  v_and_b32 v20, 0xffff0000, v18
  v_fma_f32 v20, v20, s70, v14
  v_cmp_ngt_f32 vcc, s57, v20
  s_nop 1
  v_mbcnt_lo_u32_b32 v21, vcc_lo, 0
  v_mbcnt_hi_u32_b32 v21, vcc_hi, v21
  v_lshl_add_u32 v21, v21, 2, s56
  s_bcnt1_i32_b64 s40, vcc
  s_mov_b64 exec, vcc
  ds_write_b32 v21, v18
  s_mov_b64 exec, -1
  s_lshl2_add_u32 s56, s40, s56
  s_waitcnt lgkmcnt(0)
  v_and_b32 v20, 0xffff0000, v19
  v_fma_f32 v20, v20, s70, v14
  v_cmp_ngt_f32 vcc, s57, v20
  s_nop 1
  v_mbcnt_lo_u32_b32 v21, vcc_lo, 0
  v_mbcnt_hi_u32_b32 v21, vcc_hi, v21
  v_lshl_add_u32 v21, v21, 2, s56
  s_bcnt1_i32_b64 s40, vcc
  s_mov_b64 exec, vcc
  ds_write_b32 v21, v19
  s_mov_b64 exec, -1
  s_lshl2_add_u32 s56, s40, s56
  s_sub_u32 s40, s56, 26624
  s_lshr_b32 s40, s40, 10
  v_mov_b32 v21, s40
  ds_write_b32 v12, v21 offset:52
  s_add_u32 s58, s58, 1
  s_cmp_ge_u32 s56, 46080
  s_cbranch_scc1 L_cAd
  s_cmp_lt_u32 s58, 14
  s_cbranch_scc1 L_cA
L_cAd:
  s_mov_b32 s59, 44032
  s_cmp_ge_u32 s56, s59
  s_cbranch_scc1 L_cAp
  v_lshl_add_u32 v21, v1, 2, s56
  v_cmp_gt_u32 vcc, s59, v21
  s_nop 0
  s_mov_b64 exec, vcc
  ds_write_b32 v21, v26
  s_mov_b64 exec, -1
  v_add_u32 v21, 256, v21
  v_cmp_gt_u32 vcc, s59, v21
  s_nop 0
  s_mov_b64 exec, vcc
  ds_write_b32 v21, v26
  s_mov_b64 exec, -1
  v_add_u32 v21, 256, v21
  v_cmp_gt_u32 vcc, s59, v21
  s_nop 0
  s_mov_b64 exec, vcc
  ds_write_b32 v21, v26
  s_mov_b64 exec, -1
  v_add_u32 v21, 256, v21
  v_cmp_gt_u32 vcc, s59, v21
  s_nop 0
  s_mov_b64 exec, vcc
  ds_write_b32 v21, v26
  s_mov_b64 exec, -1
  v_add_u32 v21, 256, v21
  s_mov_b32 s56, s59
  v_mov_b32 v21, 17
  ds_write_b32 v12, v21 offset:52
L_cAp:
  s_mov_b32 s71, 0x100000
L_wp79:
  ds_read_b128 v[16:19], v12 offset:32
  s_sub_u32 s71, s71, 1
  s_cbranch_scc1 L_wpd80
  s_waitcnt lgkmcnt(0)
  v_min3_u32 v16, v16, v17, v18
  v_min_u32 v16, v16, v19
  s_sleep 1
  v_readfirstlane_b32 s40, v16
  s_nop 0
  s_cmp_lt_u32 s40, 17
  s_cbranch_scc1 L_wp79
L_wpd80:
  s_waitcnt lgkmcnt(0)
  v_lshlrev_b32 v16, 4, v1
  ds_read_b128 v[16:19], v16 offset:24576
  s_waitcnt lgkmcnt(0)
  v_max3_f32 v16, v16, v17, v18
  v_max_f32 v16, v16, v19
  s_nop 1
  v_max_f32_dpp v16, v16, v16 row_ror:8 row_mask:0xf bank_mask:0xf
  s_nop 1
  v_max_f32_dpp v16, v16, v16 row_ror:4 row_mask:0xf bank_mask:0xf
  s_nop 1
  v_max_f32_dpp v16, v16, v16 row_ror:2 row_mask:0xf bank_mask:0xf
  s_nop 1
  v_max_f32_dpp v16, v16, v16 row_ror:1 row_mask:0xf bank_mask:0xf
  s_nop 1
  v_max_f32_dpp v16, v16, v16 row_bcast:15 row_mask:0xa bank_mask:0xf
  s_nop 1
  v_max_f32_dpp v16, v16, v16 row_bcast:31 row_mask:0xc bank_mask:0xf
  s_nop 0
  v_readlane_b32 s40, v16, 63
  s_nop 1
  v_mov_b32 v14, s70
  v_mul_f32 v14, s40, v14
  v_sub_f32 v14, 0, v14
L_cB:
  ds_read_b32 v16, v13 offset:0
  ds_read_b32 v17, v13 offset:256
  ds_read_b32 v18, v13 offset:512
  ds_read_b32 v19, v13 offset:768
  v_add_u32 v13, 1024, v13
  s_waitcnt lgkmcnt(3)
  v_and_b32 v20, 0xffff0000, v16
  v_fma_f32 v20, v20, s70, v14
  v_cmp_ngt_f32 vcc, s57, v20
  s_nop 1
  v_mbcnt_lo_u32_b32 v21, vcc_lo, 0
  v_mbcnt_hi_u32_b32 v21, vcc_hi, v21
  v_lshl_add_u32 v21, v21, 2, s56
  s_bcnt1_i32_b64 s40, vcc
  s_mov_b64 exec, vcc
  ds_write_b32 v21, v16
  s_mov_b64 exec, -1
  s_lshl2_add_u32 s56, s40, s56
  s_waitcnt lgkmcnt(2)
  v_and_b32 v20, 0xffff0000, v17
  v_fma_f32 v20, v20, s70, v14
  v_cmp_ngt_f32 vcc, s57, v20
  s_nop 1
  v_mbcnt_lo_u32_b32 v21, vcc_lo, 0
  v_mbcnt_hi_u32_b32 v21, vcc_hi, v21
  v_lshl_add_u32 v21, v21, 2, s56
  s_bcnt1_i32_b64 s40, vcc
  s_mov_b64 exec, vcc
  ds_write_b32 v21, v17
  s_mov_b64 exec, -1
  s_lshl2_add_u32 s56, s40, s56
  s_waitcnt lgkmcnt(1)
  v_and_b32 v20, 0xffff0000, v18
  v_fma_f32 v20, v20, s70, v14
  v_cmp_ngt_f32 vcc, s57, v20
  s_nop 1
  v_mbcnt_lo_u32_b32 v21, vcc_lo, 0
  v_mbcnt_hi_u32_b32 v21, vcc_hi, v21
  v_lshl_add_u32 v21, v21, 2, s56
  s_bcnt1_i32_b64 s40, vcc
  s_mov_b64 exec, vcc
  ds_write_b32 v21, v18
  s_mov_b64 exec, -1
  s_lshl2_add_u32 s56, s40, s56
  s_waitcnt lgkmcnt(0)
  v_and_b32 v20, 0xffff0000, v19
  v_fma_f32 v20, v20, s70, v14
  v_cmp_ngt_f32 vcc, s57, v20
  s_nop 1
  v_mbcnt_lo_u32_b32 v21, vcc_lo, 0
  v_mbcnt_hi_u32_b32 v21, vcc_hi, v21
  v_lshl_add_u32 v21, v21, 2, s56
  s_bcnt1_i32_b64 s40, vcc
  s_mov_b64 exec, vcc
  ds_write_b32 v21, v19
  s_mov_b64 exec, -1
  s_lshl2_add_u32 s56, s40, s56
  s_sub_u32 s40, s56, 26624
  s_lshr_b32 s40, s40, 10
  v_mov_b32 v21, s40
  ds_write_b32 v12, v21 offset:52
  s_add_u32 s58, s58, 1
  s_cmp_lt_u32 s58, 16
  s_cbranch_scc1 L_cB
L_cBd:
  s_sub_u32 s60, s56, 43008
  s_add_u32 s59, s60, 1023
  s_and_b32 s59, s59, 0xfffffc00
  s_lshr_b32 s61, s59, 10
  s_add_u32 s59, s59, 43008
  v_lshl_add_u32 v21, v1, 2, s56
  v_cmp_gt_u32 vcc, s59, v21
  s_nop 0
  s_mov_b64 exec, vcc
  ds_write_b32 v21, v26
  s_mov_b64 exec, -1
  v_add_u32 v21, 256, v21
  v_cmp_gt_u32 vcc, s59, v21
  s_nop 0
  s_mov_b64 exec, vcc
  ds_write_b32 v21, v26
  s_mov_b64 exec, -1
  v_add_u32 v21, 256, v21
  v_cmp_gt_u32 vcc, s59, v21
  s_nop 0
  s_mov_b64 exec, vcc
  ds_write_b32 v21, v26
  s_mov_b64 exec, -1
  v_add_u32 v21, 256, v21
  v_cmp_gt_u32 vcc, s59, v21
  s_nop 0
  s_mov_b64 exec, vcc
  ds_write_b32 v21, v26
  s_mov_b64 exec, -1
  v_add_u32 v21, 256, v21
  s_mov_b32 s56, s59
  s_add_u32 s61, s61, 0x110
  s_lshr_b32 s60, s60, 2
  v_mov_b32 v20, s61
  v_mov_b32 v21, s60
  ds_write_b32 v12, v21 offset:56
  ds_write_b32 v12, v20 offset:52
  s_waitcnt lgkmcnt(0)
L_cmp_done:
  s_barrier
L_dry1:
  s_lshl_b32 s40, s34, 1
  v_add_u32 v12, s40, v3
  v_and_b32 v12, 15, v12
  v_lshlrev_b32 v12, 4, v12
  v_lshl_add_u32 v12, v2, 2, v12
  v_mov_b32 v13, 29184
  ds_read_b128 v[20:23], v13 offset:16
  ds_read_b32 v24, v12 offset:27392
  ds_read_b32 v25, v12 offset:27904
  ds_read_b32 v26, v12 offset:28416
  ds_read_b32 v27, v12 offset:28928
  s_waitcnt lgkmcnt(4)
  v_add_f32 v15, v20, v21
  v_add_f32 v16, v22, v23
  v_add_f32 v15, v15, v16
  v_rcp_f32 v15, v15
  s_waitcnt lgkmcnt(0)
  v_add_f32 v14, v24, v25
  v_add_f32 v16, v26, v27
  v_add_f32 v14, v14, v16
  v_mul_f32 v14, v14, v15
  v_cvt_pk_bf16_f32 v44, v14, v14
  s_waitcnt vmcnt(0)
  s_nop 0
  v_and_b32_dpp v36, v44, v32 row_newbcast:0 row_mask:0xf bank_mask:0xf
  v_and_b32_dpp v37, v44, v33 row_newbcast:0 row_mask:0xf bank_mask:0xf
  v_and_b32_dpp v38, v44, v34 row_newbcast:0 row_mask:0xf bank_mask:0xf
  v_and_b32_dpp v39, v44, v35 row_newbcast:0 row_mask:0xf bank_mask:0xf
  v_and_b32_dpp v40, v44, v32 row_newbcast:1 row_mask:0xf bank_mask:0xf
  v_and_b32_dpp v41, v44, v33 row_newbcast:1 row_mask:0xf bank_mask:0xf
  v_and_b32_dpp v42, v44, v34 row_newbcast:1 row_mask:0xf bank_mask:0xf
  v_and_b32_dpp v43, v44, v35 row_newbcast:1 row_mask:0xf bank_mask:0xf
  v_mfma_f32_16x16x32_bf16 v[48:51], v[36:39], v[128:131], 0
  v_and_b32_dpp v36, v44, v32 row_newbcast:2 row_mask:0xf bank_mask:0xf
  v_and_b32_dpp v37, v44, v33 row_newbcast:2 row_mask:0xf bank_mask:0xf
  v_and_b32_dpp v38, v44, v34 row_newbcast:2 row_mask:0xf bank_mask:0xf
  v_and_b32_dpp v39, v44, v35 row_newbcast:2 row_mask:0xf bank_mask:0xf
  v_mfma_f32_16x16x32_bf16 v[48:51], v[40:43], v[132:135], v[48:51]
  v_and_b32_dpp v40, v44, v32 row_newbcast:3 row_mask:0xf bank_mask:0xf
  v_and_b32_dpp v41, v44, v33 row_newbcast:3 row_mask:0xf bank_mask:0xf
  v_and_b32_dpp v42, v44, v34 row_newbcast:3 row_mask:0xf bank_mask:0xf
  v_and_b32_dpp v43, v44, v35 row_newbcast:3 row_mask:0xf bank_mask:0xf
  v_mfma_f32_16x16x32_bf16 v[48:51], v[36:39], v[136:139], v[48:51]
  v_and_b32_dpp v36, v44, v32 row_newbcast:4 row_mask:0xf bank_mask:0xf
  v_and_b32_dpp v37, v44, v33 row_newbcast:4 row_mask:0xf bank_mask:0xf
  v_and_b32_dpp v38, v44, v34 row_newbcast:4 row_mask:0xf bank_mask:0xf
  v_and_b32_dpp v39, v44, v35 row_newbcast:4 row_mask:0xf bank_mask:0xf
  v_mfma_f32_16x16x32_bf16 v[48:51], v[40:43], v[140:143], v[48:51]
  v_and_b32_dpp v40, v44, v32 row_newbcast:5 row_mask:0xf bank_mask:0xf
  v_and_b32_dpp v41, v44, v33 row_newbcast:5 row_mask:0xf bank_mask:0xf
  v_and_b32_dpp v42, v44, v34 row_newbcast:5 row_mask:0xf bank_mask:0xf
  v_and_b32_dpp v43, v44, v35 row_newbcast:5 row_mask:0xf bank_mask:0xf
  v_mfma_f32_16x16x32_bf16 v[48:51], v[36:39], v[144:147], v[48:51]
  v_and_b32_dpp v36, v44, v32 row_newbcast:6 row_mask:0xf bank_mask:0xf
  v_and_b32_dpp v37, v44, v33 row_newbcast:6 row_mask:0xf bank_mask:0xf
  v_and_b32_dpp v38, v44, v34 row_newbcast:6 row_mask:0xf bank_mask:0xf
  v_and_b32_dpp v39, v44, v35 row_newbcast:6 row_mask:0xf bank_mask:0xf
  v_mfma_f32_16x16x32_bf16 v[48:51], v[40:43], v[148:151], v[48:51]
  v_and_b32_dpp v40, v44, v32 row_newbcast:7 row_mask:0xf bank_mask:0xf
  v_and_b32_dpp v41, v44, v33 row_newbcast:7 row_mask:0xf bank_mask:0xf
  v_and_b32_dpp v42, v44, v34 row_newbcast:7 row_mask:0xf bank_mask:0xf
  v_and_b32_dpp v43, v44, v35 row_newbcast:7 row_mask:0xf bank_mask:0xf
  v_mfma_f32_16x16x32_bf16 v[48:51], v[36:39], v[152:155], v[48:51]
  v_and_b32_dpp v36, v44, v32 row_newbcast:8 row_mask:0xf bank_mask:0xf
  v_and_b32_dpp v37, v44, v33 row_newbcast:8 row_mask:0xf bank_mask:0xf
  v_and_b32_dpp v38, v44, v34 row_newbcast:8 row_mask:0xf bank_mask:0xf
  v_and_b32_dpp v39, v44, v35 row_newbcast:8 row_mask:0xf bank_mask:0xf
  v_mfma_f32_16x16x32_bf16 v[48:51], v[40:43], v[156:159], v[48:51]
  v_and_b32_dpp v40, v44, v32 row_newbcast:9 row_mask:0xf bank_mask:0xf
  v_and_b32_dpp v41, v44, v33 row_newbcast:9 row_mask:0xf bank_mask:0xf
  v_and_b32_dpp v42, v44, v34 row_newbcast:9 row_mask:0xf bank_mask:0xf
  v_and_b32_dpp v43, v44, v35 row_newbcast:9 row_mask:0xf bank_mask:0xf
  v_mfma_f32_16x16x32_bf16 v[48:51], v[36:39], v[160:163], v[48:51]
  v_and_b32_dpp v36, v44, v32 row_newbcast:10 row_mask:0xf bank_mask:0xf
  v_and_b32_dpp v37, v44, v33 row_newbcast:10 row_mask:0xf bank_mask:0xf
  v_and_b32_dpp v38, v44, v34 row_newbcast:10 row_mask:0xf bank_mask:0xf
  v_and_b32_dpp v39, v44, v35 row_newbcast:10 row_mask:0xf bank_mask:0xf
  v_mfma_f32_16x16x32_bf16 v[48:51], v[40:43], v[164:167], v[48:51]
  v_and_b32_dpp v40, v44, v32 row_newbcast:11 row_mask:0xf bank_mask:0xf
  v_and_b32_dpp v41, v44, v33 row_newbcast:11 row_mask:0xf bank_mask:0xf
  v_and_b32_dpp v42, v44, v34 row_newbcast:11 row_mask:0xf bank_mask:0xf
  v_and_b32_dpp v43, v44, v35 row_newbcast:11 row_mask:0xf bank_mask:0xf
  v_mfma_f32_16x16x32_bf16 v[48:51], v[36:39], v[168:171], v[48:51]
  v_and_b32_dpp v36, v44, v32 row_newbcast:12 row_mask:0xf bank_mask:0xf
  v_and_b32_dpp v37, v44, v33 row_newbcast:12 row_mask:0xf bank_mask:0xf
  v_and_b32_dpp v38, v44, v34 row_newbcast:12 row_mask:0xf bank_mask:0xf
  v_and_b32_dpp v39, v44, v35 row_newbcast:12 row_mask:0xf bank_mask:0xf
  v_mfma_f32_16x16x32_bf16 v[48:51], v[40:43], v[172:175], v[48:51]
  v_and_b32_dpp v40, v44, v32 row_newbcast:13 row_mask:0xf bank_mask:0xf
  v_and_b32_dpp v41, v44, v33 row_newbcast:13 row_mask:0xf bank_mask:0xf
  v_and_b32_dpp v42, v44, v34 row_newbcast:13 row_mask:0xf bank_mask:0xf
  v_and_b32_dpp v43, v44, v35 row_newbcast:13 row_mask:0xf bank_mask:0xf
  v_mfma_f32_16x16x32_bf16 v[48:51], v[36:39], v[176:179], v[48:51]
  v_and_b32_dpp v36, v44, v32 row_newbcast:14 row_mask:0xf bank_mask:0xf
  v_and_b32_dpp v37, v44, v33 row_newbcast:14 row_mask:0xf bank_mask:0xf
  v_and_b32_dpp v38, v44, v34 row_newbcast:14 row_mask:0xf bank_mask:0xf
  v_and_b32_dpp v39, v44, v35 row_newbcast:14 row_mask:0xf bank_mask:0xf
  v_mfma_f32_16x16x32_bf16 v[48:51], v[40:43], v[180:183], v[48:51]
  v_and_b32_dpp v40, v44, v32 row_newbcast:15 row_mask:0xf bank_mask:0xf
  v_and_b32_dpp v41, v44, v33 row_newbcast:15 row_mask:0xf bank_mask:0xf
  v_and_b32_dpp v42, v44, v34 row_newbcast:15 row_mask:0xf bank_mask:0xf
  v_and_b32_dpp v43, v44, v35 row_newbcast:15 row_mask:0xf bank_mask:0xf
  v_mfma_f32_16x16x32_bf16 v[48:51], v[36:39], v[184:187], v[48:51]
  s_nop 1
  v_mfma_f32_16x16x32_bf16 v[48:51], v[40:43], v[188:191], v[48:51]
  s_nop 7
  s_nop 1
  v_lshlrev_b32 v12, 5, v3
  v_lshl_add_u32 v12, v2, 4, v12
  s_lshl_b32 s40, s36, 9
  v_add_u32 v12, s40, v12
  s_mov_b32 exec_hi, 0x0
  ds_write_b128 v12, v[48:51] offset:31744
  s_mov_b64 exec, s[100:101]
  v_lshlrev_b32 v20, 2, v0
  v_lshrrev_b32 v21, 3, v0
  v_lshlrev_b32 v21, 4, v21
  v_bfe_u32 v22, v0, 1, 2
  v_lshl_add_u32 v21, v22, 10, v21
  v_and_b32 v22, 1, v0
  v_lshl_add_u32 v21, v22, 3, v21
  s_lshl_b32 s40, s34, 12
  s_add_u32 s40, s40, 131072
  v_add_u32 v21, s40, v21
  s_mov_b32 s56, 0x44800000
  s_mov_b32 s57, 0x3b800000
  s_mov_b32 s58, 0
  s_mov_b32 s59, 0x40f00000
  s_waitcnt lgkmcnt(0)
  s_cbranch_execz L_nb82
  s_barrier
L_nb82:
  ds_read_b32 v13, v20 offset:29696
  ds_read_b32 v14, v20 offset:31744
  s_waitcnt lgkmcnt(0)
  v_add_f32 v13, v13, v14
  v_cmp_gt_f32 vcc, s56, |v13|
  v_cmp_le_f32 s[40:41], s57, |v13|
  v_cvt_f64_f32 v[14:15], v13
  s_cmp_eq_u64 s[40:41], 0
  s_cselect_b64 vcc, 0, vcc
  v_add_f64 v[14:15], v[14:15], s[58:59]
  s_cmp_eq_u64 vcc, -1
  s_cbranch_scc1 L_opf1
  s_lshl_b32 s40, s34, 11
  s_add_u32 s40, s40, 163840
  v_add_u32 v20, s40, v20
  global_atomic_add_f32 v20, v13, s[30:31] sc1
  v_mov_b32 v14, 0
  v_mov_b32 v15, 0x41504000
  s_waitcnt vmcnt(0)
L_opf1:
  global_atomic_add_f64 v21, v[14:15], s[30:31] sc1
  s_cmp_ge_u32 s42, 43
  s_cbranch_scc1 L_hend
  v_lshlrev_b32 v128, 16, v96
  v_and_b32 v129, 0xffff0000, v96
  v_lshlrev_b32 v130, 16, v97
  v_and_b32 v131, 0xffff0000, v97
  v_lshlrev_b32 v132, 16, v98
  v_and_b32 v133, 0xffff0000, v98
  v_lshlrev_b32 v134, 16, v99
  v_and_b32 v135, 0xffff0000, v99
  v_lshlrev_b32 v136, 16, v100
  v_and_b32 v137, 0xffff0000, v100
  v_lshlrev_b32 v138, 16, v101
  v_and_b32 v139, 0xffff0000, v101
  v_lshlrev_b32 v140, 16, v102
  v_and_b32 v141, 0xffff0000, v102
  v_lshlrev_b32 v142, 16, v103
  v_and_b32 v143, 0xffff0000, v103
  v_lshlrev_b32 v144, 16, v104
  v_and_b32 v145, 0xffff0000, v104
  v_lshlrev_b32 v146, 16, v105
  v_and_b32 v147, 0xffff0000, v105
  v_lshlrev_b32 v148, 16, v106
  v_and_b32 v149, 0xffff0000, v106
  v_lshlrev_b32 v150, 16, v107
  v_and_b32 v151, 0xffff0000, v107
  v_lshlrev_b32 v152, 16, v108
  v_and_b32 v153, 0xffff0000, v108
  v_lshlrev_b32 v154, 16, v109
  v_and_b32 v155, 0xffff0000, v109
  v_lshlrev_b32 v156, 16, v110
  v_and_b32 v157, 0xffff0000, v110
  v_lshlrev_b32 v158, 16, v111
  v_and_b32 v159, 0xffff0000, v111
  v_add_f32 v152, 1.0, v152
  v_add_f32 v153, 1.0, v153
  v_cvt_pk_bf16_f32 v14, v152, v153
  v_lshlrev_b32 v152, 16, v14
  v_and_b32 v153, 0xffff0000, v14
  v_add_f32 v154, 1.0, v154
  v_add_f32 v155, 1.0, v155
  v_cvt_pk_bf16_f32 v14, v154, v155
  v_lshlrev_b32 v154, 16, v14
  v_and_b32 v155, 0xffff0000, v14
  v_add_f32 v156, 1.0, v156
  v_add_f32 v157, 1.0, v157
  v_cvt_pk_bf16_f32 v14, v156, v157
  v_lshlrev_b32 v156, 16, v14
  v_and_b32 v157, 0xffff0000, v14
  v_add_f32 v158, 1.0, v158
  v_add_f32 v159, 1.0, v159
  v_cvt_pk_bf16_f32 v14, v158, v159
  v_lshlrev_b32 v158, 16, v14
  v_and_b32 v159, 0xffff0000, v14
  v_lshlrev_b32 v160, 16, v112
  v_and_b32 v161, 0xffff0000, v112
  v_lshlrev_b32 v162, 16, v113
  v_and_b32 v163, 0xffff0000, v113
  v_lshlrev_b32 v164, 16, v114
  v_and_b32 v165, 0xffff0000, v114
  v_lshlrev_b32 v166, 16, v115
  v_and_b32 v167, 0xffff0000, v115
  v_lshlrev_b32 v168, 16, v116
  v_and_b32 v169, 0xffff0000, v116
  v_lshlrev_b32 v170, 16, v117
  v_and_b32 v171, 0xffff0000, v117
  v_lshlrev_b32 v172, 16, v118
  v_and_b32 v173, 0xffff0000, v118
  v_lshlrev_b32 v174, 16, v119
  v_and_b32 v175, 0xffff0000, v119
  v_lshlrev_b32 v176, 16, v120
  v_and_b32 v177, 0xffff0000, v120
  v_lshlrev_b32 v178, 16, v121
  v_and_b32 v179, 0xffff0000, v121
  v_lshlrev_b32 v180, 16, v122
  v_and_b32 v181, 0xffff0000, v122
  v_lshlrev_b32 v182, 16, v123
  v_and_b32 v183, 0xffff0000, v123
  v_lshlrev_b32 v184, 16, v124
  v_and_b32 v185, 0xffff0000, v124
  v_lshlrev_b32 v186, 16, v125
  v_and_b32 v187, 0xffff0000, v125
  v_lshlrev_b32 v188, 16, v126
  v_and_b32 v189, 0xffff0000, v126
  v_lshlrev_b32 v190, 16, v127
  v_and_b32 v191, 0xffff0000, v127
  v_add_f32 v184, 1.0, v184
  v_add_f32 v185, 1.0, v185
  v_cvt_pk_bf16_f32 v14, v184, v185
  v_lshlrev_b32 v184, 16, v14
  v_and_b32 v185, 0xffff0000, v14
  v_add_f32 v186, 1.0, v186
  v_add_f32 v187, 1.0, v187
  v_cvt_pk_bf16_f32 v14, v186, v187
  v_lshlrev_b32 v186, 16, v14
  v_and_b32 v187, 0xffff0000, v14
  v_add_f32 v188, 1.0, v188
  v_add_f32 v189, 1.0, v189
  v_cvt_pk_bf16_f32 v14, v188, v189
  v_lshlrev_b32 v188, 16, v14
  v_and_b32 v189, 0xffff0000, v14
  v_add_f32 v190, 1.0, v190
  v_add_f32 v191, 1.0, v191
  v_cvt_pk_bf16_f32 v14, v190, v191
  v_lshlrev_b32 v190, 16, v14
  v_and_b32 v191, 0xffff0000, v14
  v_lshlrev_b32 v4, 5, v1
  s_lshl_b32 s38, s36, 12
  v_add_u32 v5, s38, v4
  s_lshl_b32 s38, s36, 13
  s_add_u32 s38, s38, 131072
  v_lshl_add_u32 v4, v1, 4, s38
  v_add_u32 v7, 4096, v4
  v_lshlrev_b32 v6, 4, v1
  s_mul_i32 s38, s36, 2080
  v_add_u32 v6, s38, v6
  v_and_b32 v12, 7, v3
  v_mul_u32_u24 v52, 1040, v12
  v_lshl_add_u32 v52, v2, 4, v52
  v_lshrrev_b32 v13, 3, v3
  v_lshl_add_u32 v52, v13, 7, v52
  v_mul_u32_u24 v54, 80, v12
  v_lshl_add_u32 v54, v2, 4, v54
  v_and_b32 v12, 1, v2
  v_lshrrev_b32 v13, 1, v2
  v_lshl_add_u32 v12, v12, 1, v13
  v_mul_u32_u24 v12, 160, v12
  v_lshl_add_u32 v12, v3, 3, v12
  s_lshl_b32 s38, s36, 1
  v_add_u32 v53, s38, v12
  s_lshl_b32 s38, s42, 14
  s_lshl_b32 s39, s36, 12
  s_add_u32 s38, s38, s39
  s_add_u32 s38, s38, 262144
  v_lshl_add_u32 v55, v1, 4, s38
  s_mov_b32 s52, 0x3b000000
  s_mov_b32 s53, 0x3727c5ac
  s_mov_b32 s58, 0
  s_mov_b32 s59, 0xc1400000
  s_mov_b32 s60, 0x413f8000
  s_mov_b32 s61, 0x41404000
  s_mov_b32 s71, 0x40000
  s_and_b32 s38, s42, 31
  s_lshl_b32 s38, s38, 7
  s_lshl_b32 s39, s36, 13
  s_add_u32 s38, s38, s39
  s_add_u32 s38, s38, 131076
  v_lshl_add_u32 v12, v1, 12, s38
  s_mov_b32 s62, 0x413f8000
  s_and_b64 exec, s[100:101], 3
  global_load_dword v48, v12, s[30:31] sc1
  s_sleep 4
  global_load_dword v49, v12, s[30:31] sc1
L_sn:
  s_waitcnt vmcnt(1)
  v_cmp_gt_u32 vcc, s62, v48
  s_sub_u32 s71, s71, 1
  s_cselect_b64 s[40:41], 0, vcc
  s_mov_b64 exec, s[40:41]
  s_cbranch_execz L_snd
  global_load_dword v48, v12, s[30:31] sc1
  s_waitcnt vmcnt(1)
  v_cmp_gt_u32 vcc, s62, v49
  s_sub_u32 s71, s71, 1
  s_cselect_b64 s[40:41], 0, vcc
  s_mov_b64 exec, s[40:41]
  s_cbranch_execz L_snd
  global_load_dword v49, v12, s[30:31] sc1
  s_branch L_sn
L_snd:
  s_mov_b64 exec, s[100:101]
  global_load_dwordx4 v[16:19], v4, s[30:31] offset:0 sc1
  global_load_dwordx4 v[20:23], v4, s[30:31] offset:1024 sc1
  global_load_dwordx4 v[24:27], v4, s[30:31] offset:2048 sc1
  global_load_dwordx4 v[28:31], v4, s[30:31] offset:3072 sc1
  global_load_dwordx4 v[32:35], v7, s[30:31] offset:0 sc1
  global_load_dwordx4 v[36:39], v7, s[30:31] offset:1024 sc1
  global_load_dwordx4 v[40:43], v7, s[30:31] offset:2048 sc1
  global_load_dwordx4 v[44:47], v7, s[30:31] offset:3072 sc1
L_fl:
  s_waitcnt vmcnt(7)
  v_min_u32 v12, v17, v19
  v_mov_b32 v13, v17
  v_add_f64 v[16:17], v[16:17], s[58:59]
  v_add_f64 v[18:19], v[18:19], s[58:59]
  v_cvt_f32_f64 v16, v[16:17]
  v_cvt_f32_f64 v17, v[18:19]
  s_waitcnt vmcnt(6)
  v_min3_u32 v12, v12, v21, v23
  v_add_f64 v[20:21], v[20:21], s[58:59]
  v_add_f64 v[22:23], v[22:23], s[58:59]
  v_cvt_f32_f64 v18, v[20:21]
  v_cvt_f32_f64 v19, v[22:23]
  s_waitcnt vmcnt(5)
  v_min3_u32 v12, v12, v25, v27
  v_add_f64 v[24:25], v[24:25], s[58:59]
  v_add_f64 v[26:27], v[26:27], s[58:59]
  v_cvt_f32_f64 v20, v[24:25]
  v_cvt_f32_f64 v21, v[26:27]
  s_waitcnt vmcnt(4)
  v_min3_u32 v12, v12, v29, v31
  v_add_f64 v[28:29], v[28:29], s[58:59]
  v_add_f64 v[30:31], v[30:31], s[58:59]
  v_cvt_f32_f64 v22, v[28:29]
  v_cvt_f32_f64 v23, v[30:31]
  s_waitcnt vmcnt(3)
  v_min3_u32 v12, v12, v33, v35
  v_max_u32 v13, v13, v33
  v_add_f64 v[32:33], v[32:33], s[58:59]
  v_add_f64 v[34:35], v[34:35], s[58:59]
  v_cvt_f32_f64 v24, v[32:33]
  v_cvt_f32_f64 v25, v[34:35]
  s_waitcnt vmcnt(2)
  v_min3_u32 v12, v12, v37, v39
  v_add_f64 v[36:37], v[36:37], s[58:59]
  v_add_f64 v[38:39], v[38:39], s[58:59]
  v_cvt_f32_f64 v26, v[36:37]
  v_cvt_f32_f64 v27, v[38:39]
  s_waitcnt vmcnt(1)
  v_min3_u32 v12, v12, v41, v43
  v_add_f64 v[40:41], v[40:41], s[58:59]
  v_add_f64 v[42:43], v[42:43], s[58:59]
  v_cvt_f32_f64 v28, v[40:41]
  v_cvt_f32_f64 v29, v[42:43]
  s_waitcnt vmcnt(0)
  v_min3_u32 v12, v12, v45, v47
  v_add_f64 v[44:45], v[44:45], s[58:59]
  v_add_f64 v[46:47], v[46:47], s[58:59]
  v_cmp_gt_u32 vcc, s60, v12
  v_cmp_le_u32 s[40:41], s61, v13
  v_cvt_f32_f64 v30, v[44:45]
  v_cvt_f32_f64 v31, v[46:47]
  s_sub_u32 s71, s71, 1
  s_cselect_b64 vcc, 0, vcc
  s_cmp_lg_u64 s[40:41], 0
  s_cbranch_scc1 L_fslow
  s_cbranch_vccz L_ln0
  global_load_dwordx4 v[16:19], v4, s[30:31] offset:0 sc1
  global_load_dwordx4 v[20:23], v4, s[30:31] offset:1024 sc1
  global_load_dwordx4 v[24:27], v4, s[30:31] offset:2048 sc1
  global_load_dwordx4 v[28:31], v4, s[30:31] offset:3072 sc1
  global_load_dwordx4 v[32:35], v7, s[30:31] offset:0 sc1
  global_load_dwordx4 v[36:39], v7, s[30:31] offset:1024 sc1
  global_load_dwordx4 v[40:43], v7, s[30:31] offset:2048 sc1
  global_load_dwordx4 v[44:47], v7, s[30:31] offset:3072 sc1
  s_branch L_fl
L_fslow:
  s_waitcnt vmcnt(0)
  s_mov_b32 s59, 0x3ef00000
  s_mov_b32 s60, 0
  s_mov_b32 s61, 0xc0f00000
L_fs1:
  global_load_dwordx4 v[16:19], v4, s[30:31] offset:0 sc1
  global_load_dwordx4 v[20:23], v4, s[30:31] offset:1024 sc1
  global_load_dwordx4 v[24:27], v4, s[30:31] offset:2048 sc1
  global_load_dwordx4 v[28:31], v4, s[30:31] offset:3072 sc1
  global_load_dwordx4 v[32:35], v7, s[30:31] offset:0 sc1
  global_load_dwordx4 v[36:39], v7, s[30:31] offset:1024 sc1
  global_load_dwordx4 v[40:43], v7, s[30:31] offset:2048 sc1
  global_load_dwordx4 v[44:47], v7, s[30:31] offset:3072 sc1
  v_mov_b32 v12, 0
  s_waitcnt vmcnt(0)
  v_mul_f64 v[8:9], v[16:17], s[58:59]
  v_rndne_f64 v[8:9], v[8:9]
  v_cvt_u32_f64 v10, v[8:9]
  v_fma_f64 v[16:17], v[8:9], s[60:61], v[16:17]
  v_xor_b32 v10, 32, v10
  v_and_or_b32 v12, v10, 63, v12
  v_cvt_f32_f64 v16, v[16:17]
  v_mul_f64 v[8:9], v[18:19], s[58:59]
  v_rndne_f64 v[8:9], v[8:9]
  v_cvt_u32_f64 v10, v[8:9]
  v_fma_f64 v[18:19], v[8:9], s[60:61], v[18:19]
  v_xor_b32 v10, 32, v10
  v_and_or_b32 v12, v10, 63, v12
  v_cvt_f32_f64 v17, v[18:19]
  v_mul_f64 v[8:9], v[20:21], s[58:59]
  v_rndne_f64 v[8:9], v[8:9]
  v_cvt_u32_f64 v10, v[8:9]
  v_fma_f64 v[20:21], v[8:9], s[60:61], v[20:21]
  v_xor_b32 v10, 32, v10
  v_and_or_b32 v12, v10, 63, v12
  v_cvt_f32_f64 v18, v[20:21]
  v_mul_f64 v[8:9], v[22:23], s[58:59]
  v_rndne_f64 v[8:9], v[8:9]
  v_cvt_u32_f64 v10, v[8:9]
  v_fma_f64 v[22:23], v[8:9], s[60:61], v[22:23]
  v_xor_b32 v10, 32, v10
  v_and_or_b32 v12, v10, 63, v12
  v_cvt_f32_f64 v19, v[22:23]
  v_mul_f64 v[8:9], v[24:25], s[58:59]
  v_rndne_f64 v[8:9], v[8:9]
  v_cvt_u32_f64 v10, v[8:9]
  v_fma_f64 v[24:25], v[8:9], s[60:61], v[24:25]
  v_xor_b32 v10, 32, v10
  v_and_or_b32 v12, v10, 63, v12
  v_cvt_f32_f64 v20, v[24:25]
  v_mul_f64 v[8:9], v[26:27], s[58:59]
  v_rndne_f64 v[8:9], v[8:9]
  v_cvt_u32_f64 v10, v[8:9]
  v_fma_f64 v[26:27], v[8:9], s[60:61], v[26:27]
  v_xor_b32 v10, 32, v10
  v_and_or_b32 v12, v10, 63, v12
  v_cvt_f32_f64 v21, v[26:27]
  v_mul_f64 v[8:9], v[28:29], s[58:59]
  v_rndne_f64 v[8:9], v[8:9]
  v_cvt_u32_f64 v10, v[8:9]
  v_fma_f64 v[28:29], v[8:9], s[60:61], v[28:29]
  v_xor_b32 v10, 32, v10
  v_and_or_b32 v12, v10, 63, v12
  v_cvt_f32_f64 v22, v[28:29]
  v_mul_f64 v[8:9], v[30:31], s[58:59]
  v_rndne_f64 v[8:9], v[8:9]
  v_cvt_u32_f64 v10, v[8:9]
  v_fma_f64 v[30:31], v[8:9], s[60:61], v[30:31]
  v_xor_b32 v10, 32, v10
  v_and_or_b32 v12, v10, 63, v12
  v_cvt_f32_f64 v23, v[30:31]
  v_mul_f64 v[8:9], v[32:33], s[58:59]
  v_rndne_f64 v[8:9], v[8:9]
  v_cvt_u32_f64 v10, v[8:9]
  v_fma_f64 v[32:33], v[8:9], s[60:61], v[32:33]
  v_xor_b32 v10, 32, v10
  v_and_or_b32 v12, v10, 63, v12
  v_cvt_f32_f64 v24, v[32:33]
  v_mul_f64 v[8:9], v[34:35], s[58:59]
  v_rndne_f64 v[8:9], v[8:9]
  v_cvt_u32_f64 v10, v[8:9]
  v_fma_f64 v[34:35], v[8:9], s[60:61], v[34:35]
  v_xor_b32 v10, 32, v10
  v_and_or_b32 v12, v10, 63, v12
  v_cvt_f32_f64 v25, v[34:35]
  v_mul_f64 v[8:9], v[36:37], s[58:59]
  v_rndne_f64 v[8:9], v[8:9]
  v_cvt_u32_f64 v10, v[8:9]
  v_fma_f64 v[36:37], v[8:9], s[60:61], v[36:37]
  v_xor_b32 v10, 32, v10
  v_and_or_b32 v12, v10, 63, v12
  v_cvt_f32_f64 v26, v[36:37]
  v_mul_f64 v[8:9], v[38:39], s[58:59]
  v_rndne_f64 v[8:9], v[8:9]
  v_cvt_u32_f64 v10, v[8:9]
  v_fma_f64 v[38:39], v[8:9], s[60:61], v[38:39]
  v_xor_b32 v10, 32, v10
  v_and_or_b32 v12, v10, 63, v12
  v_cvt_f32_f64 v27, v[38:39]
  v_mul_f64 v[8:9], v[40:41], s[58:59]
  v_rndne_f64 v[8:9], v[8:9]
  v_cvt_u32_f64 v10, v[8:9]
  v_fma_f64 v[40:41], v[8:9], s[60:61], v[40:41]
  v_xor_b32 v10, 32, v10
  v_and_or_b32 v12, v10, 63, v12
  v_cvt_f32_f64 v28, v[40:41]
  v_mul_f64 v[8:9], v[42:43], s[58:59]
  v_rndne_f64 v[8:9], v[8:9]
  v_cvt_u32_f64 v10, v[8:9]
  v_fma_f64 v[42:43], v[8:9], s[60:61], v[42:43]
  v_xor_b32 v10, 32, v10
  v_and_or_b32 v12, v10, 63, v12
  v_cvt_f32_f64 v29, v[42:43]
  v_mul_f64 v[8:9], v[44:45], s[58:59]
  v_rndne_f64 v[8:9], v[8:9]
  v_cvt_u32_f64 v10, v[8:9]
  v_fma_f64 v[44:45], v[8:9], s[60:61], v[44:45]
  v_xor_b32 v10, 32, v10
  v_and_or_b32 v12, v10, 63, v12
  v_cvt_f32_f64 v30, v[44:45]
  v_mul_f64 v[8:9], v[46:47], s[58:59]
  v_rndne_f64 v[8:9], v[8:9]
  v_cvt_u32_f64 v10, v[8:9]
  v_fma_f64 v[46:47], v[8:9], s[60:61], v[46:47]
  v_xor_b32 v10, 32, v10
  v_and_or_b32 v12, v10, 63, v12
  v_cvt_f32_f64 v31, v[46:47]
  v_cmp_ne_u32 vcc, 0, v12
  s_sub_u32 s71, s71, 1
  s_cselect_b64 s[40:41], 0, vcc
  s_cmp_lg_u64 s[40:41], 0
  s_cbranch_scc1 L_fs1
  v_add_u32 v8, 163840, v5
  global_load_dwordx4 v[32:35], v8, s[30:31] offset:0 sc1
  global_load_dwordx4 v[36:39], v8, s[30:31] offset:16 sc1
  global_load_dwordx4 v[40:43], v8, s[30:31] offset:2048 sc1
  global_load_dwordx4 v[44:47], v8, s[30:31] offset:2064 sc1
  s_waitcnt vmcnt(0)
  v_add_f32 v16, v16, v32
  v_add_f32 v17, v17, v33
  v_add_f32 v18, v18, v34
  v_add_f32 v19, v19, v35
  v_add_f32 v20, v20, v36
  v_add_f32 v21, v21, v37
  v_add_f32 v22, v22, v38
  v_add_f32 v23, v23, v39
  v_add_f32 v24, v24, v40
  v_add_f32 v25, v25, v41
  v_add_f32 v26, v26, v42
  v_add_f32 v27, v27, v43
  v_add_f32 v28, v28, v44
  v_add_f32 v29, v29, v45
  v_add_f32 v30, v30, v46
  v_add_f32 v31, v31, v47
L_ln0:
  v_cvt_pk_bf16_f32 v8, v16, v17
  v_cvt_pk_bf16_f32 v9, v18, v19
  v_cvt_pk_bf16_f32 v10, v20, v21
  v_cvt_pk_bf16_f32 v11, v22, v23
  v_lshlrev_b32 v16, 16, v8
  v_and_b32 v17, 0xffff0000, v8
  v_lshlrev_b32 v18, 16, v9
  v_and_b32 v19, 0xffff0000, v9
  v_lshlrev_b32 v20, 16, v10
  v_and_b32 v21, 0xffff0000, v10
  v_lshlrev_b32 v22, 16, v11
  v_and_b32 v23, 0xffff0000, v11
  v_pk_mul_f32 v[16:17], v[16:17], v[136:137]
  v_pk_mul_f32 v[18:19], v[18:19], v[138:139]
  v_pk_mul_f32 v[20:21], v[20:21], v[140:141]
  v_pk_mul_f32 v[22:23], v[22:23], v[142:143]
  v_cvt_pk_bf16_f32 v8, v16, v17
  v_cvt_pk_bf16_f32 v9, v18, v19
  v_cvt_pk_bf16_f32 v10, v20, v21
  v_cvt_pk_bf16_f32 v11, v22, v23
  v_lshlrev_b32 v16, 16, v8
  v_and_b32 v17, 0xffff0000, v8
  v_lshlrev_b32 v18, 16, v9
  v_and_b32 v19, 0xffff0000, v9
  v_lshlrev_b32 v20, 16, v10
  v_and_b32 v21, 0xffff0000, v10
  v_lshlrev_b32 v22, 16, v11
  v_and_b32 v23, 0xffff0000, v11
  v_pk_add_f32 v[16:17], v[16:17], v[128:129]
  v_pk_add_f32 v[18:19], v[18:19], v[130:131]
  v_pk_add_f32 v[20:21], v[20:21], v[132:133]
  v_pk_add_f32 v[22:23], v[22:23], v[134:135]
  v_cvt_pk_bf16_f32 v8, v16, v17
  v_cvt_pk_bf16_f32 v9, v18, v19
  v_cvt_pk_bf16_f32 v10, v20, v21
  v_cvt_pk_bf16_f32 v11, v22, v23
  v_lshlrev_b32 v16, 16, v8
  v_and_b32 v17, 0xffff0000, v8
  v_lshlrev_b32 v18, 16, v9
  v_and_b32 v19, 0xffff0000, v9
  v_lshlrev_b32 v20, 16, v10
  v_and_b32 v21, 0xffff0000, v10
  v_lshlrev_b32 v22, 16, v11
  v_and_b32 v23, 0xffff0000, v11
  v_pk_add_f32 v[32:33], v[16:17], v[18:19]
  v_pk_mul_f32 v[34:35], v[16:17], v[16:17]
  v_pk_add_f32 v[8:9], v[20:21], v[22:23]
  v_pk_mul_f32 v[10:11], v[20:21], v[20:21]
  v_pk_fma_f32 v[34:35], v[18:19], v[18:19], v[34:35]
  v_pk_fma_f32 v[10:11], v[22:23], v[22:23], v[10:11]
  v_pk_add_f32 v[32:33], v[32:33], v[8:9]
  v_pk_add_f32 v[34:35], v[34:35], v[10:11]
  v_add_f32 v32, v32, v33
  v_add_f32 v34, v34, v35
  v_cvt_pk_bf16_f32 v8, v24, v25
  v_cvt_pk_bf16_f32 v9, v26, v27
  v_cvt_pk_bf16_f32 v10, v28, v29
  v_cvt_pk_bf16_f32 v11, v30, v31
  v_lshlrev_b32 v24, 16, v8
  v_and_b32 v25, 0xffff0000, v8
  v_lshlrev_b32 v26, 16, v9
  v_and_b32 v27, 0xffff0000, v9
  v_lshlrev_b32 v28, 16, v10
  v_and_b32 v29, 0xffff0000, v10
  v_lshlrev_b32 v30, 16, v11
  v_and_b32 v31, 0xffff0000, v11
  v_pk_mul_f32 v[24:25], v[24:25], v[168:169]
  v_pk_mul_f32 v[26:27], v[26:27], v[170:171]
  v_pk_mul_f32 v[28:29], v[28:29], v[172:173]
  v_pk_mul_f32 v[30:31], v[30:31], v[174:175]
  v_cvt_pk_bf16_f32 v8, v24, v25
  v_cvt_pk_bf16_f32 v9, v26, v27
  v_cvt_pk_bf16_f32 v10, v28, v29
  v_cvt_pk_bf16_f32 v11, v30, v31
  v_lshlrev_b32 v24, 16, v8
  v_and_b32 v25, 0xffff0000, v8
  v_lshlrev_b32 v26, 16, v9
  v_and_b32 v27, 0xffff0000, v9
  v_lshlrev_b32 v28, 16, v10
  v_and_b32 v29, 0xffff0000, v10
  v_lshlrev_b32 v30, 16, v11
  v_and_b32 v31, 0xffff0000, v11
  v_pk_add_f32 v[24:25], v[24:25], v[160:161]
  v_pk_add_f32 v[26:27], v[26:27], v[162:163]
  v_pk_add_f32 v[28:29], v[28:29], v[164:165]
  v_pk_add_f32 v[30:31], v[30:31], v[166:167]
  v_cvt_pk_bf16_f32 v8, v24, v25
  v_cvt_pk_bf16_f32 v9, v26, v27
  v_cvt_pk_bf16_f32 v10, v28, v29
  v_cvt_pk_bf16_f32 v11, v30, v31
  v_lshlrev_b32 v24, 16, v8
  v_and_b32 v25, 0xffff0000, v8
  v_lshlrev_b32 v26, 16, v9
  v_and_b32 v27, 0xffff0000, v9
  v_lshlrev_b32 v28, 16, v10
  v_and_b32 v29, 0xffff0000, v10
  v_lshlrev_b32 v30, 16, v11
  v_and_b32 v31, 0xffff0000, v11
  v_pk_add_f32 v[36:37], v[24:25], v[26:27]
  v_pk_mul_f32 v[38:39], v[24:25], v[24:25]
  v_pk_add_f32 v[8:9], v[28:29], v[30:31]
  v_pk_mul_f32 v[10:11], v[28:29], v[28:29]
  v_pk_fma_f32 v[38:39], v[26:27], v[26:27], v[38:39]
  v_pk_fma_f32 v[10:11], v[30:31], v[30:31], v[10:11]
  v_pk_add_f32 v[36:37], v[36:37], v[8:9]
  v_pk_add_f32 v[38:39], v[38:39], v[10:11]
  v_add_f32 v36, v36, v37
  v_add_f32 v38, v38, v39
  s_nop 1
  v_add_f32_dpp v32, v32, v32 row_ror:8 row_mask:0xf bank_mask:0xf
  v_add_f32_dpp v34, v34, v34 row_ror:8 row_mask:0xf bank_mask:0xf
  v_add_f32_dpp v36, v36, v36 row_ror:8 row_mask:0xf bank_mask:0xf
  v_add_f32_dpp v38, v38, v38 row_ror:8 row_mask:0xf bank_mask:0xf
  v_add_f32_dpp v32, v32, v32 row_ror:4 row_mask:0xf bank_mask:0xf
  v_add_f32_dpp v34, v34, v34 row_ror:4 row_mask:0xf bank_mask:0xf
  v_add_f32_dpp v36, v36, v36 row_ror:4 row_mask:0xf bank_mask:0xf
  v_add_f32_dpp v38, v38, v38 row_ror:4 row_mask:0xf bank_mask:0xf
  v_add_f32_dpp v32, v32, v32 row_ror:2 row_mask:0xf bank_mask:0xf
  v_add_f32_dpp v34, v34, v34 row_ror:2 row_mask:0xf bank_mask:0xf
  v_add_f32_dpp v36, v36, v36 row_ror:2 row_mask:0xf bank_mask:0xf
  v_add_f32_dpp v38, v38, v38 row_ror:2 row_mask:0xf bank_mask:0xf
  v_add_f32_dpp v32, v32, v32 row_ror:1 row_mask:0xf bank_mask:0xf
  v_add_f32_dpp v34, v34, v34 row_ror:1 row_mask:0xf bank_mask:0xf
  v_add_f32_dpp v36, v36, v36 row_ror:1 row_mask:0xf bank_mask:0xf
  v_add_f32_dpp v38, v38, v38 row_ror:1 row_mask:0xf bank_mask:0xf
  v_add_f32_dpp v32, v32, v32 row_bcast:15 row_mask:0xa bank_mask:0xf
  v_add_f32_dpp v34, v34, v34 row_bcast:15 row_mask:0xa bank_mask:0xf
  v_add_f32_dpp v36, v36, v36 row_bcast:15 row_mask:0xa bank_mask:0xf
  v_add_f32_dpp v38, v38, v38 row_bcast:15 row_mask:0xa bank_mask:0xf
  v_add_f32_dpp v32, v32, v32 row_bcast:31 row_mask:0xc bank_mask:0xf
  v_add_f32_dpp v34, v34, v34 row_bcast:31 row_mask:0xc bank_mask:0xf
  v_add_f32_dpp v36, v36, v36 row_bcast:31 row_mask:0xc bank_mask:0xf
  v_add_f32_dpp v38, v38, v38 row_bcast:31 row_mask:0xc bank_mask:0xf
  s_nop 0
  v_readlane_b32 s54, v32, 63
  v_readlane_b32 s55, v34, 63
  v_readlane_b32 s56, v36, 63
  v_readlane_b32 s57, v38, 63
  s_nop 1
  ds_write_b128 v5, v[16:19] offset:43008
  ds_write_b128 v5, v[20:23] offset:43024
  ds_write_b128 v5, v[24:27] offset:45056
  ds_write_b128 v5, v[28:31] offset:45072
  v_mov_b32 v8, s52
  v_mul_f32 v32, s54, v8
  v_mul_f32 v34, s55, v8
  v_mul_f32 v33, s56, v8
  v_mul_f32 v35, s57, v8
  v_fma_f32 v34, -v32, v32, v34
  v_fma_f32 v35, -v33, v33, v35
  v_max_f32 v34, 0, v34
  v_max_f32 v35, 0, v35
  v_cvt_pk_bf16_f32 v9, v34, v35
  v_lshlrev_b32 v34, 16, v9
  v_and_b32 v35, 0xffff0000, v9
  v_cvt_pk_bf16_f32 v8, v32, v33
  v_lshlrev_b32 v32, 16, v8
  v_and_b32 v33, 0xffff0000, v8
  v_add_f32 v34, s53, v34
  v_add_f32 v35, s53, v35
  v_cvt_pk_bf16_f32 v9, v34, v35
  v_lshlrev_b32 v34, 16, v9
  v_and_b32 v35, 0xffff0000, v9
  v_sqrt_f32 v34, v34
  v_sqrt_f32 v35, v35
  v_pk_add_f32 v[16:17], v[16:17], v[32:33] op_sel_hi:[1,0] neg_lo:[0,1] neg_hi:[0,1]
  v_pk_add_f32 v[18:19], v[18:19], v[32:33] op_sel_hi:[1,0] neg_lo:[0,1] neg_hi:[0,1]
  v_pk_add_f32 v[20:21], v[20:21], v[32:33] op_sel_hi:[1,0] neg_lo:[0,1] neg_hi:[0,1]
  v_pk_add_f32 v[22:23], v[22:23], v[32:33] op_sel_hi:[1,0] neg_lo:[0,1] neg_hi:[0,1]
  v_pk_add_f32 v[24:25], v[24:25], v[32:33] op_sel:[0,1] neg_lo:[0,1] neg_hi:[0,1]
  v_pk_add_f32 v[26:27], v[26:27], v[32:33] op_sel:[0,1] neg_lo:[0,1] neg_hi:[0,1]
  v_pk_add_f32 v[28:29], v[28:29], v[32:33] op_sel:[0,1] neg_lo:[0,1] neg_hi:[0,1]
  v_pk_add_f32 v[30:31], v[30:31], v[32:33] op_sel:[0,1] neg_lo:[0,1] neg_hi:[0,1]
  v_cvt_pk_bf16_f32 v9, v34, v35
  v_lshlrev_b32 v34, 16, v9
  v_and_b32 v35, 0xffff0000, v9
  v_rcp_f32 v34, v34
  v_rcp_f32 v35, v35
  v_cvt_pk_bf16_f32 v40, v16, v17
  v_cvt_pk_bf16_f32 v41, v18, v19
  v_cvt_pk_bf16_f32 v42, v20, v21
  v_cvt_pk_bf16_f32 v43, v22, v23
  v_cvt_pk_bf16_f32 v44, v24, v25
  v_cvt_pk_bf16_f32 v45, v26, v27
  v_cvt_pk_bf16_f32 v46, v28, v29
  v_cvt_pk_bf16_f32 v47, v30, v31
  v_lshlrev_b32 v16, 16, v40
  v_and_b32 v17, 0xffff0000, v40
  v_lshlrev_b32 v18, 16, v41
  v_and_b32 v19, 0xffff0000, v41
  v_lshlrev_b32 v20, 16, v42
  v_and_b32 v21, 0xffff0000, v42
  v_lshlrev_b32 v22, 16, v43
  v_and_b32 v23, 0xffff0000, v43
  v_lshlrev_b32 v24, 16, v44
  v_and_b32 v25, 0xffff0000, v44
  v_lshlrev_b32 v26, 16, v45
  v_and_b32 v27, 0xffff0000, v45
  v_lshlrev_b32 v28, 16, v46
  v_and_b32 v29, 0xffff0000, v46
  v_lshlrev_b32 v30, 16, v47
  v_and_b32 v31, 0xffff0000, v47
  v_pk_mul_f32 v[16:17], v[16:17], v[34:35] op_sel_hi:[1,0]
  v_pk_mul_f32 v[18:19], v[18:19], v[34:35] op_sel_hi:[1,0]
  v_pk_mul_f32 v[20:21], v[20:21], v[34:35] op_sel_hi:[1,0]
  v_pk_mul_f32 v[22:23], v[22:23], v[34:35] op_sel_hi:[1,0]
  v_pk_mul_f32 v[24:25], v[24:25], v[34:35] op_sel:[0,1]
  v_pk_mul_f32 v[26:27], v[26:27], v[34:35] op_sel:[0,1]
  v_pk_mul_f32 v[28:29], v[28:29], v[34:35] op_sel:[0,1]
  v_pk_mul_f32 v[30:31], v[30:31], v[34:35] op_sel:[0,1]
  v_cvt_pk_bf16_f32 v40, v16, v17
  v_cvt_pk_bf16_f32 v41, v18, v19
  v_cvt_pk_bf16_f32 v42, v20, v21
  v_cvt_pk_bf16_f32 v43, v22, v23
  v_cvt_pk_bf16_f32 v44, v24, v25
  v_cvt_pk_bf16_f32 v45, v26, v27
  v_cvt_pk_bf16_f32 v46, v28, v29
  v_cvt_pk_bf16_f32 v47, v30, v31
  v_lshlrev_b32 v16, 16, v40
  v_and_b32 v17, 0xffff0000, v40
  v_lshlrev_b32 v18, 16, v41
  v_and_b32 v19, 0xffff0000, v41
  v_lshlrev_b32 v20, 16, v42
  v_and_b32 v21, 0xffff0000, v42
  v_lshlrev_b32 v22, 16, v43
  v_and_b32 v23, 0xffff0000, v43
  v_lshlrev_b32 v24, 16, v44
  v_and_b32 v25, 0xffff0000, v44
  v_lshlrev_b32 v26, 16, v45
  v_and_b32 v27, 0xffff0000, v45
  v_lshlrev_b32 v28, 16, v46
  v_and_b32 v29, 0xffff0000, v46
  v_lshlrev_b32 v30, 16, v47
  v_and_b32 v31, 0xffff0000, v47
  v_pk_mul_f32 v[16:17], v[16:17], v[152:153]
  v_pk_mul_f32 v[18:19], v[18:19], v[154:155]
  v_pk_mul_f32 v[20:21], v[20:21], v[156:157]
  v_pk_mul_f32 v[22:23], v[22:23], v[158:159]
  v_pk_mul_f32 v[24:25], v[24:25], v[184:185]
  v_pk_mul_f32 v[26:27], v[26:27], v[186:187]
  v_pk_mul_f32 v[28:29], v[28:29], v[188:189]
  v_pk_mul_f32 v[30:31], v[30:31], v[190:191]
  v_cvt_pk_bf16_f32 v40, v16, v17
  v_cvt_pk_bf16_f32 v41, v18, v19
  v_cvt_pk_bf16_f32 v42, v20, v21
  v_cvt_pk_bf16_f32 v43, v22, v23
  v_cvt_pk_bf16_f32 v44, v24, v25
  v_cvt_pk_bf16_f32 v45, v26, v27
  v_cvt_pk_bf16_f32 v46, v28, v29
  v_cvt_pk_bf16_f32 v47, v30, v31
  v_lshlrev_b32 v16, 16, v40
  v_and_b32 v17, 0xffff0000, v40
  v_lshlrev_b32 v18, 16, v41
  v_and_b32 v19, 0xffff0000, v41
  v_lshlrev_b32 v20, 16, v42
  v_and_b32 v21, 0xffff0000, v42
  v_lshlrev_b32 v22, 16, v43
  v_and_b32 v23, 0xffff0000, v43
  v_lshlrev_b32 v24, 16, v44
  v_and_b32 v25, 0xffff0000, v44
  v_lshlrev_b32 v26, 16, v45
  v_and_b32 v27, 0xffff0000, v45
  v_lshlrev_b32 v28, 16, v46
  v_and_b32 v29, 0xffff0000, v46
  v_lshlrev_b32 v30, 16, v47
  v_and_b32 v31, 0xffff0000, v47
  v_pk_add_f32 v[16:17], v[16:17], v[144:145]
  v_pk_add_f32 v[18:19], v[18:19], v[146:147]
  v_pk_add_f32 v[20:21], v[20:21], v[148:149]
  v_pk_add_f32 v[22:23], v[22:23], v[150:151]
  v_pk_add_f32 v[24:25], v[24:25], v[176:177]
  v_pk_add_f32 v[26:27], v[26:27], v[178:179]
  v_pk_add_f32 v[28:29], v[28:29], v[180:181]
  v_pk_add_f32 v[30:31], v[30:31], v[182:183]
  v_cvt_pk_bf16_f32 v40, v16, v17
  v_cvt_pk_bf16_f32 v41, v18, v19
  v_cvt_pk_bf16_f32 v42, v20, v21
  v_cvt_pk_bf16_f32 v43, v22, v23
  v_cvt_pk_bf16_f32 v44, v24, v25
  v_cvt_pk_bf16_f32 v45, v26, v27
  v_cvt_pk_bf16_f32 v46, v28, v29
  v_cvt_pk_bf16_f32 v47, v30, v31
  ds_write_b128 v6, v[40:43] offset:33792
  ds_write_b128 v6, v[44:47] offset:34832
L_lnd:
  s_waitcnt lgkmcnt(0)
  s_cbranch_execz L_nb83
  s_barrier
L_nb83:
  ds_read_b128 v[128:131], v52 offset:33792
  ds_read_b128 v[132:135], v52 offset:33856
  ds_read_b128 v[136:139], v52 offset:34048
  ds_read_b128 v[140:143], v52 offset:34112
  ds_read_b128 v[144:147], v52 offset:34304
  ds_read_b128 v[148:151], v52 offset:34368
  ds_read_b128 v[152:155], v52 offset:34560
  ds_read_b128 v[156:159], v52 offset:34624
  s_waitcnt lgkmcnt(7)
  v_mfma_f32_16x16x32_bf16 v[16:19], v[128:131], v[192:195], 0
  v_mfma_f32_16x16x32_bf16 v[20:23], v[128:131], v[200:203], 0
  s_waitcnt lgkmcnt(6)
  v_mfma_f32_16x16x32_bf16 v[16:19], v[132:135], v[196:199], v[16:19]
  v_mfma_f32_16x16x32_bf16 v[20:23], v[132:135], v[204:207], v[20:23]
  s_waitcnt lgkmcnt(5)
  v_mfma_f32_16x16x32_bf16 v[16:19], v[136:139], v[208:211], v[16:19]
  v_mfma_f32_16x16x32_bf16 v[20:23], v[136:139], v[216:219], v[20:23]
  s_waitcnt lgkmcnt(4)
  v_mfma_f32_16x16x32_bf16 v[16:19], v[140:143], v[212:215], v[16:19]
  v_mfma_f32_16x16x32_bf16 v[20:23], v[140:143], v[220:223], v[20:23]
  s_waitcnt lgkmcnt(3)
  v_mfma_f32_16x16x32_bf16 v[16:19], v[144:147], v[224:227], v[16:19]
  v_mfma_f32_16x16x32_bf16 v[20:23], v[144:147], v[232:235], v[20:23]
  s_waitcnt lgkmcnt(2)
  v_mfma_f32_16x16x32_bf16 v[16:19], v[148:151], v[228:231], v[16:19]
  v_mfma_f32_16x16x32_bf16 v[20:23], v[148:151], v[236:239], v[20:23]
  s_waitcnt lgkmcnt(1)
  v_mfma_f32_16x16x32_bf16 v[16:19], v[152:155], v[240:243], v[16:19]
  v_mfma_f32_16x16x32_bf16 v[20:23], v[152:155], v[248:251], v[20:23]
  s_waitcnt lgkmcnt(0)
  v_mfma_f32_16x16x32_bf16 v[16:19], v[156:159], v[244:247], v[16:19]
  v_mfma_f32_16x16x32_bf16 v[20:23], v[156:159], v[252:255], v[20:23]
  s_nop 6
  v_permlane32_swap_b32 v16, v18
  v_permlane32_swap_b32 v17, v19
  s_nop 0
  v_permlane32_swap_b32 v20, v22
  v_permlane32_swap_b32 v21, v23
  s_nop 0
  v_pk_add_f32 v[16:17], v[16:17], v[22:23]
  v_cvt_pk_bf16_f32 v18, v16, v17
  v_lshlrev_b32 v16, 16, v18
  v_and_b32 v17, 0xffff0000, v18
  s_nop 1
  v_mov_b32_dpp v20, v16 row_ror:8 row_mask:0xf bank_mask:0xf
  v_mov_b32_dpp v21, v17 row_ror:8 row_mask:0xf bank_mask:0xf
  v_mul_f32 v24, 0xbfb8aa3b, v16
  v_mul_f32 v25, 0xbfb8aa3b, v17
  v_fma_f32 v26, v16, s73, -v24
  v_fma_f32 v27, v17, s73, -v25
  v_fmac_f32 v26, 0xb2a57060, v16
  v_min_f32 v24, 0x42fc0000, v24
  v_fmac_f32 v27, 0xb2a57060, v17
  v_min_f32 v25, 0x42fc0000, v25
  v_exp_f32 v24, v24
  v_exp_f32 v25, v25
  v_mul_f32 v26, 0x3f317218, v26
  v_mul_f32 v27, 0x3f317218, v27
  v_fmac_f32 v24, v24, v26
  v_fmac_f32 v25, v25, v27
  v_add_f32 v24, 1.0, v24
  v_add_f32 v25, 1.0, v25
  v_rcp_f32 v26, v24
  v_rcp_f32 v27, v25
  s_nop 0
  v_mul_f32 v28, v16, v26
  v_mul_f32 v29, v17, v27
  v_fma_f32 v16, -v28, v24, v16
  v_fma_f32 v17, -v29, v25, v17
  v_fma_f32 v16, v16, v26, v28
  v_fma_f32 v17, v17, v27, v29
  v_cvt_pk_bf16_f32 v18, v16, v17
  v_lshlrev_b32 v16, 16, v18
  v_and_b32 v17, 0xffff0000, v18
  v_pk_mul_f32 v[16:17], v[16:17], v[20:21]
  s_and_b32 exec_lo, s100, 0xff00ff
  s_and_b32 exec_hi, s100, 0xff00ff
  v_cvt_pk_bf16_f32 v16, v16, v17
  ds_write_b16 v53, v16 offset:42240
  ds_write_b16_d16_hi v53, v16 offset:42320
  s_mov_b64 exec, s[100:101]
  v_mov_b32 v13, s72
  s_mov_b32 s52, 0x7060500
  s_mov_b32 s53, 0x7060501
  s_mov_b32 s54, 0x7060502
  s_mov_b32 s55, 0x7060503
  s_waitcnt lgkmcnt(0)
  s_cbranch_execz L_nb84
  s_barrier
L_nb84:
  ds_read_b128 v[16:19], v54 offset:42240
  s_waitcnt lgkmcnt(0)
  s_mov_b32 exec_hi, 0x0
  v_mfma_f32_16x16x32_bf16 v[128:131], v[16:19], v[64:67], 0
  v_mfma_f32_16x16x32_bf16 v[132:135], v[16:19], v[68:71], 0
  v_mfma_f32_16x16x32_bf16 v[136:139], v[16:19], v[72:75], 0
  v_mfma_f32_16x16x32_bf16 v[140:143], v[16:19], v[76:79], 0
  s_nop 4
  v_perm_b32 v128, v128, v13, s52
  v_perm_b32 v129, v129, v13, s53
  v_perm_b32 v130, v130, v13, s54
  v_perm_b32 v131, v131, v13, s55
  global_store_dwordx4 v55, v[128:131], s[30:31] offset:0 sc1
  v_mfma_f32_16x16x32_bf16 v[144:147], v[16:19], v[80:83], 0
  v_perm_b32 v132, v132, v13, s52
  v_perm_b32 v133, v133, v13, s53
  v_perm_b32 v134, v134, v13, s54
  v_perm_b32 v135, v135, v13, s55
  global_store_dwordx4 v55, v[132:135], s[30:31] offset:512 sc1
  v_mfma_f32_16x16x32_bf16 v[148:151], v[16:19], v[84:87], 0
  v_perm_b32 v136, v136, v13, s52
  v_perm_b32 v137, v137, v13, s53
  v_perm_b32 v138, v138, v13, s54
  v_perm_b32 v139, v139, v13, s55
  global_store_dwordx4 v55, v[136:139], s[30:31] offset:1024 sc1
  v_mfma_f32_16x16x32_bf16 v[152:155], v[16:19], v[88:91], 0
  v_perm_b32 v140, v140, v13, s52
  v_perm_b32 v141, v141, v13, s53
  v_perm_b32 v142, v142, v13, s54
  v_perm_b32 v143, v143, v13, s55
  global_store_dwordx4 v55, v[140:143], s[30:31] offset:1536 sc1
  v_mfma_f32_16x16x32_bf16 v[156:159], v[16:19], v[92:95], 0
  v_perm_b32 v144, v144, v13, s52
  v_perm_b32 v145, v145, v13, s53
  v_perm_b32 v146, v146, v13, s54
  v_perm_b32 v147, v147, v13, s55
  global_store_dwordx4 v55, v[144:147], s[30:31] offset:2048 sc1
  v_perm_b32 v148, v148, v13, s52
  v_perm_b32 v149, v149, v13, s53
  v_perm_b32 v150, v150, v13, s54
  v_perm_b32 v151, v151, v13, s55
  global_store_dwordx4 v55, v[148:151], s[30:31] offset:2560 sc1
  v_perm_b32 v152, v152, v13, s52
  v_perm_b32 v153, v153, v13, s53
  v_perm_b32 v154, v154, v13, s54
  v_perm_b32 v155, v155, v13, s55
  global_store_dwordx4 v55, v[152:155], s[30:31] offset:3072 sc1
  v_perm_b32 v156, v156, v13, s52
  v_perm_b32 v157, v157, v13, s53
  v_perm_b32 v158, v158, v13, s54
  v_perm_b32 v159, v159, v13, s55
  global_store_dwordx4 v55, v[156:159], s[30:31] offset:3584 sc1
  s_mov_b64 exec, s[100:101]
  s_cmp_ge_u32 s42, 32
  s_cbranch_scc1 L_hend
  s_lshr_b32 s38, s36, 1
  s_lshl_b32 s38, s38, 13
  v_lshl_add_u32 v12, v60, 2, s38
  ds_read_b32 v24, v12 offset:43008
  ds_read_b32 v25, v12 offset:45056
  ds_read_b32 v26, v12 offset:47104
  ds_read_b32 v27, v12 offset:49152
  v_lshrrev_b32 v12, 3, v1
  v_lshlrev_b32 v12, 14, v12
  v_and_b32 v13, 7, v1
  v_lshl_add_u32 v12, v13, 4, v12
  s_lshl_b32 s38, s42, 9
  s_lshl_b32 s39, s36, 7
  s_add_u32 s38, s38, s39
  s_add_u32 s38, s38, 262144
  v_add_u32 v12, s38, v12
  v_add_u32 v13, 131072, v12
  v_add_u32 v14, 262144, v12
  v_add_u32 v15, 393216, v12
  v_add_u32 v16, 524288, v12
  v_add_u32 v17, 655360, v12
  s_bfe_u32 s38, s72, 0x80000
  v_mov_b32 v212, s38
  s_bfe_u32 s38, s72, 0x80008
  v_mov_b32 v213, s38
  s_bfe_u32 s38, s72, 0x80010
  v_mov_b32 v214, s38
  s_bfe_u32 s38, s72, 0x80018
  v_mov_b32 v215, s38
  s_mov_b32 s52, 0x0c0c0400
  s_mov_b32 s53, 0x04000c0c
  s_mov_b32 s71, 0x80000
  s_mov_b64 s[54:55], s[100:101]
  s_mov_b64 s[56:57], s[100:101]
  s_mov_b64 s[58:59], s[100:101]
  s_mov_b64 s[60:61], s[100:101]
  s_mov_b64 s[62:63], s[100:101]
  s_and_b64 s[64:65], s[100:101], 0xffffff
  s_sleep 7
L_fin:
  s_mov_b64 exec, s[54:55]
  global_load_dwordx4 v[192:195], v12, s[30:31] sc1
  s_mov_b64 exec, s[56:57]
  global_load_dwordx4 v[196:199], v13, s[30:31] sc1
  s_mov_b64 exec, s[58:59]
  global_load_dwordx4 v[200:203], v14, s[30:31] sc1
  s_mov_b64 exec, s[60:61]
  global_load_dwordx4 v[204:207], v15, s[30:31] sc1
  s_mov_b64 exec, s[62:63]
  global_load_dwordx4 v[208:211], v16, s[30:31] sc1
  s_mov_b64 exec, s[64:65]
  global_load_dwordx4 v[212:215], v17, s[30:31] sc1
  s_mov_b64 exec, s[100:101]
  s_waitcnt vmcnt(5)
  v_perm_b32 v18, v193, v192, s52
  v_perm_b32 v19, v195, v194, s53
  v_or_b32 v18, v18, v19
  v_cmp_ne_u32 s[54:55], s72, v18
  s_waitcnt vmcnt(4)
  v_perm_b32 v18, v197, v196, s52
  v_perm_b32 v19, v199, v198, s53
  v_or_b32 v18, v18, v19
  v_cmp_ne_u32 s[56:57], s72, v18
  s_waitcnt vmcnt(3)
  v_perm_b32 v18, v201, v200, s52
  v_perm_b32 v19, v203, v202, s53
  v_or_b32 v18, v18, v19
  v_cmp_ne_u32 s[58:59], s72, v18
  s_waitcnt vmcnt(2)
  v_perm_b32 v18, v205, v204, s52
  v_perm_b32 v19, v207, v206, s53
  v_or_b32 v18, v18, v19
  v_cmp_ne_u32 s[60:61], s72, v18
  s_waitcnt vmcnt(1)
  v_perm_b32 v18, v209, v208, s52
  v_perm_b32 v19, v211, v210, s53
  v_or_b32 v18, v18, v19
  v_cmp_ne_u32 s[62:63], s72, v18
  s_waitcnt vmcnt(0)
  v_perm_b32 v18, v213, v212, s52
  v_perm_b32 v19, v215, v214, s53
  v_or_b32 v18, v18, v19
  v_cmp_ne_u32 s[64:65], s72, v18
  s_or_b64 s[40:41], s[54:55], s[56:57]
  s_or_b64 s[38:39], s[58:59], s[60:61]
  s_or_b64 s[40:41], s[40:41], s[38:39]
  s_or_b64 s[38:39], s[62:63], s[64:65]
  s_sub_u32 s71, s71, 1
  s_cbranch_scc1 L_find
  s_or_b64 s[40:41], s[40:41], s[38:39]
  s_cbranch_scc1 L_fin
L_find:
  v_add_f32 v216, v192, v196
  v_add_f32 v224, v200, v204
  v_add_f32 v232, v208, v212
  v_add_f32 v217, v193, v197
  v_add_f32 v225, v201, v205
  v_add_f32 v233, v209, v213
  v_add_f32 v218, v194, v198
  v_add_f32 v226, v202, v206
  v_add_f32 v234, v210, v214
  v_add_f32 v219, v195, v199
  v_add_f32 v227, v203, v207
  v_add_f32 v235, v211, v215
  v_add_f32 v216, v216, v224
  v_add_f32 v217, v217, v225
  v_add_f32 v218, v218, v226
  v_add_f32 v219, v219, v227
  v_add_f32 v216, v216, v232
  v_add_f32 v217, v217, v233
  v_add_f32 v218, v218, v234
  v_add_f32 v219, v219, v235
  s_nop 0
  v_add_f32_dpp v216, v216, v216 row_ror:8 row_mask:0xf bank_mask:0xf
  v_add_f32_dpp v217, v217, v217 row_ror:8 row_mask:0xf bank_mask:0xf
  v_add_f32_dpp v218, v218, v218 row_ror:8 row_mask:0xf bank_mask:0xf
  v_add_f32_dpp v219, v219, v219 row_ror:8 row_mask:0xf bank_mask:0xf
  v_mov_b32 v16, v216
  v_mov_b32 v17, v217
  v_mov_b32 v18, v218
  v_mov_b32 v19, v219
  s_nop 0
  v_permlane16_swap_b32 v16, v216
  v_permlane16_swap_b32 v17, v217
  v_permlane16_swap_b32 v18, v218
  v_permlane16_swap_b32 v19, v219
  v_add_f32 v216, v216, v16
  v_add_f32 v217, v217, v17
  v_add_f32 v218, v218, v18
  v_add_f32 v219, v219, v19
  v_mov_b32 v16, v216
  v_mov_b32 v17, v217
  v_mov_b32 v18, v218
  v_mov_b32 v19, v219
  s_nop 0
  v_permlane32_swap_b32 v16, v216
  v_permlane32_swap_b32 v17, v217
  v_permlane32_swap_b32 v18, v218
  v_permlane32_swap_b32 v19, v219
  s_lshr_b32 s38, s36, 1
  s_lshl_b32 s38, s38, 12
  v_lshl_add_u32 v12, v60, 1, s38
  s_waitcnt lgkmcnt(0)
  v_add_f32 v16, v16, v216
  v_cvt_pk_bf16_f32 v16, v16, v16
  v_and_b32 v16, 0xffff0000, v16
  v_mul_f32 v16, v16, v56
  v_cvt_pk_bf16_f32 v16, v16, v16
  v_and_b32 v16, 0xffff0000, v16
  v_add_f32 v16, v16, v24
  v_cvt_pk_bf16_f32 v16, v16, v16
  v_add_f32 v17, v17, v217
  v_cvt_pk_bf16_f32 v17, v17, v17
  v_and_b32 v17, 0xffff0000, v17
  v_mul_f32 v17, v17, v57
  v_cvt_pk_bf16_f32 v17, v17, v17
  v_and_b32 v17, 0xffff0000, v17
  v_add_f32 v17, v17, v25
  v_cvt_pk_bf16_f32 v17, v17, v17
  v_add_f32 v18, v18, v218
  v_cvt_pk_bf16_f32 v18, v18, v18
  v_and_b32 v18, 0xffff0000, v18
  v_mul_f32 v18, v18, v58
  v_cvt_pk_bf16_f32 v18, v18, v18
  v_and_b32 v18, 0xffff0000, v18
  v_add_f32 v18, v18, v26
  v_cvt_pk_bf16_f32 v18, v18, v18
  v_add_f32 v19, v19, v219
  v_cvt_pk_bf16_f32 v19, v19, v19
  v_and_b32 v19, 0xffff0000, v19
  v_mul_f32 v19, v19, v59
  v_cvt_pk_bf16_f32 v19, v19, v19
  v_and_b32 v19, 0xffff0000, v19
  v_add_f32 v19, v19, v27
  v_cvt_pk_bf16_f32 v19, v19, v19
  s_and_b32 exec_lo, s100, 0xff
  s_mov_b32 exec_hi, 0x0
  global_store_short v12, v16, s[26:27] offset:0
  global_store_short v12, v17, s[26:27] offset:1024
  global_store_short v12, v18, s[26:27] offset:2048
  global_store_short v12, v19, s[26:27] offset:3072
  s_add_u32 s38, s42, s36
  s_cmp_lg_u32 s38, 0
  s_cbranch_scc1 L_noep
  v_mov_b32 v12, 0
  v_mov_b32 v13, s72
  s_and_b64 exec, s[100:101], 1
  global_store_dword v12, v13, s[30:31] offset:0 sc1
L_noep:
  s_mov_b64 exec, s[100:101]
L_hend:
  s_cbranch_execz L_dryret
L_end:
  s_endpgm
.section .rodata,"a"
.p2align 6
.amdhsa_kernel adaLN_cond__mha_block_cached__swiglu_ffn__decode_kernel
  .amdhsa_next_free_vgpr 256
  .amdhsa_next_free_sgpr 102
  .amdhsa_accum_offset 256
  .amdhsa_group_segment_fixed_size 0
  .amdhsa_kernarg_size 112
  .amdhsa_user_sgpr_count 2
  .amdhsa_user_sgpr_kernarg_segment_ptr 1
  .amdhsa_system_sgpr_workgroup_id_x 1
.end_amdhsa_kernel
```
